```python
import torch

def _softmax(x, axis=-1):
    return torch.softmax(x, dim=axis)

def _gelu(x):
    return torch.nn.functional.gelu(x, approximate='tanh')

def _silu(x):
    return torch.nn.functional.silu(x)

def _sigmoid(x):
    return torch.sigmoid(x)

def _layernorm(x, axis=-1, eps=1e-05):
    m = x.mean(dim=axis, keepdim=True)
    v = x.var(dim=axis, keepdim=True, unbiased=False)
    return (x - m) / torch.sqrt(v + eps)

def _scatter_add(tgt, idx, src, axis=0):
    return tgt.clone().index_add_(axis, idx, src)

def _segment_sum(src, seg, n):
    out = torch.zeros((n,) + src.shape[1:], dtype=src.dtype)
    return out.index_add_(0, seg, src)

def _pad(x, pw):
    flat = tuple((v for pair in reversed(pw) for v in pair))
    return torch.nn.functional.pad(x, flat)
kernel_name = 'standalone__conformer_family_branchformer__speech'

def setup_inputs():

    _w = lambda a: (lambda t: t.to(torch.bfloat16) if t.is_floating_point() else t)(torch.as_tensor(a))
    B, T, D, K = (2, 4000, 256, 15)
    s = float(D) ** (-0.5)
    return {'x': _w((lambda *s: torch.randn(*s, dtype=torch.bfloat16) * 0.05)(B, T, D)), 'w_q': _w((lambda *s: torch.randn(*s, dtype=torch.bfloat16) * 1.6)(D, D) * s), 'w_k': _w((lambda *s: torch.randn(*s, dtype=torch.bfloat16) * 1.6)(D, D) * s), 'w_v': _w((lambda *s: torch.randn(*s, dtype=torch.bfloat16) * 0.4)(D, D) * s), 'w_ao': _w((lambda *s: torch.randn(*s, dtype=torch.bfloat16) * 0.4)(D, D) * s), 'w_up': _w((lambda *s: torch.randn(*s, dtype=torch.bfloat16) * 0.8)(D, 2 * D) * s), 'dw': _w((lambda *s: torch.randn(*s, dtype=torch.bfloat16) * 0.8)(K, D) * (1.0 / K)), 'w_dn': _w((lambda *s: torch.randn(*s, dtype=torch.bfloat16) * 0.4)(D, D) * s), 'w_merge': _w((lambda *s: torch.randn(*s, dtype=torch.bfloat16) * 0.4)(2 * D, D) * s)}

def reference(x, w_q, w_k, w_v, w_ao, w_up, dw, w_dn, w_merge):
    B, T, D = x.shape
    K = dw.shape[0]
    xa = _layernorm(x, axis=-1)
    q = torch.einsum('btd,de->bte', xa, w_q)
    k = torch.einsum('btd,de->bte', xa, w_k)
    v = torch.einsum('btd,de->bte', xa, w_v)
    logits = torch.einsum('btd,bsd->bts', q, k) * float(D) ** (-0.5)
    attn = _softmax(logits, axis=-1)
    ya = torch.einsum('bts,bsd->btd', attn, v)
    ya = torch.einsum('btd,de->bte', ya, w_ao)
    xc = _layernorm(x, axis=-1)
    h = _gelu(torch.einsum('btd,de->bte', xc, w_up))
    u = h[..., :D].clone()
    g = _layernorm(h[..., D:], axis=-1)
    pad = K // 2
    gp = _pad(g, ((0, 0), (pad, pad), (0, 0)))
    conv = torch.zeros_like(g)
    for i in range(K):
        conv = conv + gp[:, i:i + T, :] * dw[i][None, None, :]
    yc = torch.einsum('btd,de->bte', u * conv, w_dn)
    merged = torch.concatenate([ya, yc], axis=-1)
    out = torch.einsum('btf,fd->btd', merged, w_merge)
    return x + out
```

```asm
; @launch grid=(256,1,1) block=(256,1,1) lds=163840
.amdgcn_target "amdgcn-amd-amdhsa--gfx950"
.text
.globl standalone__conformer_family_branchformer__speech_kernel
.p2align 12
.p2align 8
.type standalone__conformer_family_branchformer__speech_kernel,@function
standalone__conformer_family_branchformer__speech_kernel:
    s_cmp_ge_u32 s2, 256
    s_cbranch_scc1 L_end
    s_load_dwordx16 s[36:51], s[0:1], 0
    s_load_dwordx8 s[52:59], s[0:1], 64
    s_getpc_b64 s[68:69]
    s_lshr_b32 s35, s2, 3
    s_mul_i32 s70, s35, 1280
    v_mad_u32_u24 v1, v0, 5, s70
    v_and_b32 v1, -4, v1
    global_load_dword v255, v1, s[68:69]
    v_lshrrev_b32 v2, 6, v0
    s_lshr_b32 s32, s2, 4
    v_readfirstlane_b32 s3, v2
    s_lshl_b32 s32, s32, 2
    s_bfe_u32 s70, s2, 0x20001
    s_add_u32 s32, s32, s70
    s_and_b32 s6, s2, 1
    s_bfe_u32 s7, s2, 0x10003
    s_lshr_b32 s71, s70, 1
    s_xor_b32 s72, s71, s7
    s_add_u32 s72, s72, 62
    s_add_u32 s71, s71, 60
    s_xor_b32 s70, s70, s6
    s_bitcmp1_b32 s70, 0
    s_cselect_b32 s71, s71, s72
    s_cmp_ge_u32 s32, 60
    s_cselect_b32 s32, s71, s32
    s_mov_b32 s5, 0
    s_mov_b32 s101, 0xffff0000
    s_mov_b32 s10, 268435456
    s_mov_b32 s11, 0x20000
    s_mov_b32 s14, 2048000
    s_mov_b32 s15, 0x20000
    s_mov_b32 s18, 2048000
    s_mov_b32 s19, 0x20000
    s_mov_b32 s22, 262144
    s_mov_b32 s23, 0x20000
    s_mov_b32 s30, 131072
    s_mov_b32 s31, 0x20000
    s_mov_b32 s26, 131072
    s_mov_b32 s27, 0x20000
    s_lshl_b32 s73, s3, 15
    s_lshl_b32 s74, s3, 13
    s_add_u32 s74, s74, 131072
    s_lshl_b32 s75, s32, 15
    s_xor_b32 s79, s6, 1
    s_cmp_eq_u32 s3, 0
    s_cselect_b32 s71, 1, 0
    s_lshl_b32 s79, s79, s71
L_restart:
    v_mbcnt_lo_u32_b32 v64, -1, 0
    v_mbcnt_hi_u32_b32 v64, -1, v64
    v_lshrrev_b32 v65, 2, v64
    v_and_b32 v66, 3, v64
    v_lshlrev_b32 v250, 4, v64
    v_lshrrev_b32 v69, 3, v65
    v_lshlrev_b32 v69, 1, v69
    v_xor_b32 v69, v69, v66
    v_lshrrev_b32 v73, 2, v65
    v_lshlrev_b32 v73, 3, v73
    v_and_b32 v68, 3, v65
    v_add_lshl_u32 v73, v73, v68, 9
    v_lshl_add_u32 v67, v66, 4, v73
    v_lshl_add_u32 v73, v69, 4, v73
    s_lshr_b32 s35, s3, 1
    s_xor_b32 s35, s35, s7
    s_xor_b32 s35, s35, 1
    s_lshl_b32 s35, s35, 14
    s_add_u32 s71, s35, s75
    s_and_b32 s35, s3, 1
    s_lshl_b32 s35, s35, 11
    s_add_u32 s71, s71, s35
    s_add_u32 s76, s32, s3
    s_lshl_b32 s76, s76, 1
    s_add_u32 s76, s76, s7
    s_lshr_b32 s68, s76, 4
    s_lshl_b32 s68, s68, 14
    s_bfe_u32 s69, s76, 0x10003
    s_lshl_b32 s69, s69, 11
    s_add_u32 s68, s68, s69
    s_and_b32 s69, s76, 7
    s_lshl_b32 s69, s69, 14
    v_lshrrev_b32 v99, 4, v64
    v_lshlrev_b32 v99, 8, v99
    v_add_lshl_u32 v99, v99, v250, 1
    s_lshr_b32 s34, s2, 4
    s_lshl_b32 s34, s34, 2
    s_add_u32 s34, s34, s3
    s_lshl_b32 s34, s34, 12
    s_lshl_b32 s72, s7, 9
    s_add_u32 s34, s34, s72
    s_lshl_b32 s35, s3, 6
    s_add_u32 s72, s72, s35
    s_cmp_eq_u32 s5, 0
    s_cbranch_scc0 L_r2
    s_mul_i32 s35, s6, 2048000
    s_waitcnt lgkmcnt(0)
    s_mov_b64 s[28:29], s[40:41]
    s_mov_b64 s[24:25], s[38:39]
    s_add_u32 s12, s36, s35
    s_addc_u32 s13, s37, 0
    s_mov_b64 s[20:21], s[46:47]
    s_mov_b64 s[8:9], s[58:59]
    s_add_u32 s16, s54, s35
    s_addc_u32 s17, s55, 0
    s_load_dword s100, s[58:59], 0
L_r2:
    s_cmp_eq_u32 s79, 2
    s_cbranch_scc0 L_nom1
    s_mov_b32 m0, s73
    s_mov_b32 s35, 130560
    buffer_load_dwordx4 v250, s[28:31], s35 offen lds
    s_mov_b32 s35, 0
L_mst:
    s_add_u32 m0, s35, s74
    s_add_u32 s70, s35, s73
    buffer_load_dwordx4 v73, s[28:31], s68 offen lds
    s_add_u32 m0, s70, 16384
    s_add_u32 s68, s68, 64
    buffer_load_dwordx4 v73, s[24:27], s69 offen lds
    s_add_u32 m0, s70, 22528
    s_addk_i32 s35, 1024
    buffer_load_dwordx4 v73, s[24:27], s69 offen offset:2048 lds
    s_addk_i32 s69, 64
    s_cmp_lt_u32 s35, 8192
    s_cbranch_scc1 L_mst
    s_barrier
L_nom1:
    s_cmp_eq_u32 s32, 63
    s_cbranch_scc1 L_spare
    buffer_load_dword v99, v99, s[20:23], s34 offen
    s_cmp_eq_u32 s79, 0
    s_cbranch_scc0 L_misc
    s_nop 0
    buffer_load_dwordx4 v[128:131], v67, s[12:15], s71 offen offset:0
    buffer_load_dwordx4 v[132:135], v67, s[12:15], s71 offen offset:64
    buffer_load_dwordx4 v[136:139], v67, s[12:15], s71 offen offset:128
    buffer_load_dwordx4 v[140:143], v67, s[12:15], s71 offen offset:192
    buffer_load_dwordx4 v[144:147], v67, s[12:15], s71 offen offset:256
    buffer_load_dwordx4 v[148:151], v67, s[12:15], s71 offen offset:320
    buffer_load_dwordx4 v[152:155], v67, s[12:15], s71 offen offset:384
    buffer_load_dwordx4 v[156:159], v67, s[12:15], s71 offen offset:448
L_misc:
    v_and_b32 v71, 15, v64
    v_lshrrev_b32 v72, 4, v64
    v_lshrrev_b32 v70, 3, v71
    v_lshlrev_b32 v70, 1, v70
    v_xor_b32 v70, v70, v72
    v_lshlrev_b32 v70, 4, v70
    v_lshl_add_u32 v70, v71, 6, v70
    v_add_u32 v96, s74, v70
    v_lshlrev_b32 v68, 10, v65
    v_lshl_add_u32 v68, v69, 4, v68
    v_add_u32 v74, 0, v68
    v_add_u32 v75, 15360, v68
    v_add_u32 v76, 30720, v68
    v_add_u32 v77, 46080, v68
    v_bfe_u32 v68, v64, 2, 2
    v_and_b32 v254, 1, v72
    v_lshl_add_u32 v68, v254, 3, v68
    v_lshlrev_b32 v68, 6, v68
    v_lshl_add_u32 v68, v254, 5, v68
    v_lshrrev_b32 v254, 1, v72
    v_lshl_add_u32 v68, v254, 10, v68
    v_lshl_add_u32 v68, v66, 3, v68
    v_add_u32 v78, s73, v68
    v_xor_b32 v79, 32, v78
    v_lshlrev_b32 v97, 6, v65
    v_lshl_add_u32 v97, v69, 4, v97
    v_add_u32 v97, s74, v97
    v_add_u32 v98, 131072, v70
    s_lshl_b32 s47, s6, 1
    s_add_u32 s47, s47, s7
    s_lshl_b32 s47, s47, 12
    s_lshl_b32 s46, s3, 10
    s_add_u32 s47, s47, s46
    s_add_u32 s47, s47, 65536
    s_add_u32 s46, s46, 131072
    v_and_b32 v254, 31, v64
    v_lshlrev_b32 v254, 5, v254
    s_lshl_b32 s69, s6, 7
    s_mul_i32 s68, s7, 63
    s_add_u32 s69, s69, s68
    s_add_u32 s69, s69, s32
    s_mov_b32 s68, s32
    s_lshl_b32 s42, s7, 2
    s_lshl_b32 s69, s69, 1
    s_and_b32 s70, s3, 1
    s_add_u32 s69, s69, s70
    s_lshl_b32 s69, s69, 13
    s_add_u32 s69, s69, 2097152
    s_cmp_lt_u32 s3, 2
    s_cselect_b32 s69, 0x7fff0000, s69
    s_cselect_b32 s43, s69, 65536
    s_sub_u32 s50, 0, s68
    s_and_b32 s50, s50, 3
    s_lshl_b32 s50, s50, 11
    s_add_u32 s50, s50, s69
    s_sub_u32 s51, 1, s68
    s_and_b32 s51, s51, 3
    s_lshl_b32 s51, s51, 11
    s_add_u32 s51, s51, s69
    s_sub_u32 s52, 2, s68
    s_and_b32 s52, s52, 3
    s_lshl_b32 s52, s52, 11
    s_add_u32 s52, s52, s69
    s_sub_u32 s53, 3, s68
    s_and_b32 s53, s53, 3
    s_lshl_b32 s53, s53, 11
    s_add_u32 s53, s53, s69
    s_lshl_b32 s69, s6, 3
    s_add_u32 s42, s42, s69
    s_and_b32 s69, s68, 3
    s_add_u32 s42, s42, s69
    s_lshl_b32 s42, s42, 5
    s_lshr_b32 s68, s68, 2
    s_lshl_b32 s68, s68, 1
    s_add_u32 s42, s42, s68
    s_add_u32 s42, s42, s70
    s_lshl_b32 s42, s42, 5
    s_add_u32 s42, s42, s43
    v_lshrrev_b32 v68, 1, v72
    v_lshlrev_b32 v68, 3, v68
    v_xor_b32 v68, v68, v71
    v_lshlrev_b32 v68, 4, v68
    v_lshl_add_u32 v248, v72, 8, v68
    v_lshrrev_b32 v73, 1, v66
    v_lshlrev_b32 v68, 3, v73
    v_xor_b32 v68, v68, v65
    v_lshlrev_b32 v68, 4, v68
    v_lshl_add_u32 v73, v73, 9, v68
    v_and_b32 v249, 1, v64
    v_lshl_add_u32 v249, v249, 3, v73
    v_add_u32 v251, 4096, v250
    v_add_u32 v252, 8192, v250
    v_add_u32 v253, 12288, v250
    v_mov_b32 v160, 0xc0135761
    v_mov_b32 v162, 0xbdd2d3e8
    v_mov_b32 v164, 1.0
    v_lshlrev_b32 v68, 2, v72
    v_sub_u32 v68, v71, v68
    v_mov_b32 v73, 0x3f80
    v_mov_b32 v103, 0x3f800000
    v_mov_b32 v168, 0
    v_mov_b32 v169, 0
    v_mov_b32 v172, 0
    v_mov_b32 v173, 0
    v_cmp_eq_u32 vcc, 0, v68
    v_cmp_eq_u32 s[68:69], 1, v68
    s_nop 0
    v_cndmask_b32 v170, 0, v73, vcc
    v_cndmask_b32 v170, v170, v103, s[68:69]
    v_cmp_eq_u32 vcc, 2, v68
    v_cmp_eq_u32 s[68:69], 3, v68
    s_nop 0
    v_cndmask_b32 v171, 0, v73, vcc
    v_cndmask_b32 v171, v171, v103, s[68:69]
    s_add_u32 s68, s3, s7
    s_cmp_ge_u32 s68, 3
    s_cselect_b32 s33, 15, 16
    s_cselect_b32 s78, 0xc0000000, 0
    s_cselect_b32 s60, 2, 0
    s_cselect_b32 s61, 3, 1
    s_cselect_b32 s62, 1, 2
    s_cselect_b32 s63, 0, 3
    s_lshl_b32 s60, s60, 13
    s_add_u32 s60, s60, s73
    s_lshl_b32 s61, s61, 13
    s_add_u32 s61, s61, s73
    s_lshl_b32 s62, s62, 13
    s_add_u32 s62, s62, s73
    s_lshl_b32 s63, s63, 13
    s_add_u32 s63, s63, s73
    s_mov_b32 s64, s74
    s_lshl_b32 s68, s6, 7
    s_mul_i32 s69, s7, 63
    s_add_u32 s68, s68, s69
    s_add_u32 s68, s68, s3
    s_lshl_b32 s66, s68, 14
    s_add_u32 s66, s66, 2097152
    s_lshl_b32 s68, s33, 16
    s_add_u32 s67, s66, s68
    s_mov_b32 s65, s66
    s_add_u32 s68, s3, 0
    s_and_b32 s68, s68, 3
    s_lshl_b32 s68, s68, 11
    s_add_u32 s68, s68, 131072
    v_add_u32 v240, s68, v250
    s_add_u32 s68, s3, 1
    s_and_b32 s68, s68, 3
    s_lshl_b32 s68, s68, 11
    s_add_u32 s68, s68, 131072
    v_add_u32 v241, s68, v250
    s_add_u32 s68, s3, 2
    s_and_b32 s68, s68, 3
    s_lshl_b32 s68, s68, 11
    s_add_u32 s68, s68, 131072
    v_add_u32 v242, s68, v250
    s_add_u32 s68, s3, 3
    s_and_b32 s68, s68, 3
    s_lshl_b32 s68, s68, 11
    s_add_u32 s68, s68, 131072
    v_add_u32 v243, s68, v250
    v_lshlrev_b32 v246, 5, v71
    v_add_u32 v245, s63, v246
    v_lshl_add_u32 v246, v72, 3, v246
    v_add_u32 v247, 0x10000, v246
    s_sub_u32 s36, s3, 1
    s_and_b32 s36, s36, 3
    s_lshl_b32 s36, s36, 15
    s_sub_u32 s37, s3, 2
    s_and_b32 s37, s37, 3
    s_lshl_b32 s37, s37, 15
    s_sub_u32 s54, s3, 3
    s_and_b32 s54, s54, 3
    s_lshl_b32 s54, s54, 15
    s_lshl_b32 s68, s6, 6
    s_add_u32 s69, s68, s32
    s_lshl_b32 s69, s69, 1
    s_add_u32 s69, s69, s7
    s_lshl_b32 s69, s69, 2
    s_add_u32 s69, s69, s3
    s_mov_b32 s57, s69
    s_lshl_b32 s43, s69, 4
    s_add_u32 s43, s43, 196608
    s_add_u32 s69, s32, s7
    s_max_u32 s69, s69, 1
    s_min_u32 s69, s69, 62
    s_add_u32 s69, s69, s68
    s_lshl_b32 s56, s69, 7
    s_add_u32 s56, s56, 196480
    s_lshl_b32 s70, s7, 14
    s_add_u32 s70, s70, s75
    s_mul_i32 s55, s6, 2097152
    s_lshl_b32 s69, s3, 10
    s_add_u32 s55, s55, s69
    s_lshr_b32 s68, s69, 1
    s_lshl_b32 s69, s7, 22
    s_add_u32 s69, s69, s55
    s_sub_u32 s69, s69, s68
    s_add_u32 s69, s69, 6291456
    s_add_u32 s59, s69, s70
    s_xor_b32 s44, s70, 0x4000
    s_add_u32 s44, s44, s69
    s_add_u32 s55, s55, s70
    s_add_u32 s58, s55, 10481664
    s_cmp_eq_u32 s70, 0
    s_cselect_b32 s58, 0x7fff0000, s58
    s_lshl_b32 s45, s3, 7
    s_add_u32 s45, s45, s70
    s_cmp_eq_u32 s79, 1
    s_cbranch_scc0 L_nomb
    s_barrier
L_nomb:
    s_mov_b64 exec, 0
    s_cmp_eq_u32 s3, 0
    s_cbranch_scc1 L_pad3
    s_cmp_eq_u32 s3, 1
    s_cbranch_scc1 L_pad0
    s_cmp_eq_u32 s3, 2
    s_cbranch_scc1 L_pad1
    s_branch L_pad2
L_padret:
    s_mov_b64 exec, -1
    s_waitcnt lgkmcnt(0)
    s_add_u32 s4, s100, 0x9e3779b9
    s_cmp_eq_u32 s79, 0
    s_cbranch_scc1 L_xdone
    s_cmp_eq_u32 s79, 1
    s_cbranch_scc1 L_xb
    v_add_u32 v68, s73, v70
    v_lshl_add_u32 v102, v72, 4, s73
    s_waitcnt vmcnt(1)
    ds_read_b128 a[128:131], v96 offset:0
    ds_read_b128 a[140:143], v102 offset:0
    ds_read_b128 a[132:135], v68 offset:16384
    ds_read_b128 a[136:139], v68 offset:24576
    ds_read_b128 a[144:147], v96 offset:1024
    ds_read_b128 a[156:159], v102 offset:64
    ds_read_b128 a[148:151], v68 offset:17408
    ds_read_b128 a[152:155], v68 offset:25600
    ds_read_b128 a[160:163], v96 offset:2048
    ds_read_b128 a[172:175], v102 offset:128
    ds_read_b128 a[164:167], v68 offset:18432
    ds_read_b128 a[168:171], v68 offset:26624
    s_waitcnt lgkmcnt(8)
    v_mfma_f32_16x16x32_bf16 v[80:83], a[132:135], a[128:131], 0
    v_mfma_f32_16x16x32_bf16 v[84:87], a[136:139], a[128:131], 0
    v_mfma_f32_16x16x32_bf16 v[104:107], a[132:135], a[140:143], 0
    v_mfma_f32_16x16x32_bf16 v[108:111], a[136:139], a[140:143], 0
    ds_read_b128 a[176:179], v96 offset:3072
    ds_read_b128 a[188:191], v102 offset:192
    ds_read_b128 a[180:183], v68 offset:19456
    ds_read_b128 a[184:187], v68 offset:27648
    s_waitcnt lgkmcnt(8)
    v_mfma_f32_16x16x32_bf16 v[80:83], a[148:151], a[144:147], v[80:83]
    v_mfma_f32_16x16x32_bf16 v[84:87], a[152:155], a[144:147], v[84:87]
    v_mfma_f32_16x16x32_bf16 v[104:107], a[148:151], a[156:159], v[104:107]
    v_mfma_f32_16x16x32_bf16 v[108:111], a[152:155], a[156:159], v[108:111]
    ds_read_b128 a[192:195], v96 offset:4096
    ds_read_b128 a[204:207], v102 offset:256
    ds_read_b128 a[196:199], v68 offset:20480
    ds_read_b128 a[200:203], v68 offset:28672
    s_waitcnt lgkmcnt(8)
    v_mfma_f32_16x16x32_bf16 v[80:83], a[164:167], a[160:163], v[80:83]
    v_mfma_f32_16x16x32_bf16 v[84:87], a[168:171], a[160:163], v[84:87]
    v_mfma_f32_16x16x32_bf16 v[104:107], a[164:167], a[172:175], v[104:107]
    v_mfma_f32_16x16x32_bf16 v[108:111], a[168:171], a[172:175], v[108:111]
    ds_read_b128 a[208:211], v96 offset:5120
    ds_read_b128 a[220:223], v102 offset:320
    ds_read_b128 a[212:215], v68 offset:21504
    ds_read_b128 a[216:219], v68 offset:29696
    s_waitcnt lgkmcnt(8)
    v_mfma_f32_16x16x32_bf16 v[80:83], a[180:183], a[176:179], v[80:83]
    v_mfma_f32_16x16x32_bf16 v[84:87], a[184:187], a[176:179], v[84:87]
    v_mfma_f32_16x16x32_bf16 v[104:107], a[180:183], a[188:191], v[104:107]
    v_mfma_f32_16x16x32_bf16 v[108:111], a[184:187], a[188:191], v[108:111]
    ds_read_b128 a[224:227], v96 offset:6144
    ds_read_b128 a[236:239], v102 offset:384
    ds_read_b128 a[228:231], v68 offset:22528
    ds_read_b128 a[232:235], v68 offset:30720
    s_waitcnt lgkmcnt(8)
    v_mfma_f32_16x16x32_bf16 v[80:83], a[196:199], a[192:195], v[80:83]
    v_mfma_f32_16x16x32_bf16 v[84:87], a[200:203], a[192:195], v[84:87]
    v_mfma_f32_16x16x32_bf16 v[104:107], a[196:199], a[204:207], v[104:107]
    v_mfma_f32_16x16x32_bf16 v[108:111], a[200:203], a[204:207], v[108:111]
    ds_read_b128 a[240:243], v96 offset:7168
    ds_read_b128 a[252:255], v102 offset:448
    ds_read_b128 a[244:247], v68 offset:23552
    ds_read_b128 a[248:251], v68 offset:31744
    s_waitcnt lgkmcnt(8)
    v_mfma_f32_16x16x32_bf16 v[80:83], a[212:215], a[208:211], v[80:83]
    v_mfma_f32_16x16x32_bf16 v[84:87], a[216:219], a[208:211], v[84:87]
    v_mfma_f32_16x16x32_bf16 v[104:107], a[212:215], a[220:223], v[104:107]
    v_mfma_f32_16x16x32_bf16 v[108:111], a[216:219], a[220:223], v[108:111]
    s_waitcnt lgkmcnt(4)
    v_mfma_f32_16x16x32_bf16 v[80:83], a[228:231], a[224:227], v[80:83]
    v_mfma_f32_16x16x32_bf16 v[84:87], a[232:235], a[224:227], v[84:87]
    v_mfma_f32_16x16x32_bf16 v[104:107], a[228:231], a[236:239], v[104:107]
    v_mfma_f32_16x16x32_bf16 v[108:111], a[232:235], a[236:239], v[108:111]
    s_waitcnt lgkmcnt(0)
    v_mfma_f32_16x16x32_bf16 v[80:83], a[244:247], a[240:243], v[80:83]
    v_mfma_f32_16x16x32_bf16 v[84:87], a[248:251], a[240:243], v[84:87]
    v_mfma_f32_16x16x32_bf16 v[104:107], a[244:247], a[252:255], v[104:107]
    v_mfma_f32_16x16x32_bf16 v[108:111], a[248:251], a[252:255], v[108:111]
    s_mov_b32 s69, 0x3db8aa3b
    s_lshl_b32 s68, s76, 10
    s_add_u32 s68, s68, 524288
    s_nop 4
    v_sub_f32 v80, v80, v104
    v_sub_f32 v81, v81, v105
    v_sub_f32 v82, v82, v106
    v_sub_f32 v83, v83, v107
    v_sub_f32 v84, v84, v108
    v_sub_f32 v85, v85, v109
    v_sub_f32 v86, v86, v110
    v_sub_f32 v87, v87, v111
    v_mul_f32 v80, s69, v80
    v_mul_f32 v81, s69, v81
    v_mul_f32 v82, s69, v82
    v_mul_f32 v83, s69, v83
    v_mul_f32 v84, s69, v84
    v_mul_f32 v85, s69, v85
    v_mul_f32 v86, s69, v86
    v_mul_f32 v87, s69, v87
    v_cvt_pk_bf16_f32 v92, v80, v81
    v_cvt_pk_bf16_f32 v93, v82, v83
    v_cvt_pk_bf16_f32 v94, v84, v85
    v_cvt_pk_bf16_f32 v95, v86, v87
    buffer_store_dwordx4 v[92:95], v250, s[8:11], s68 offen sc1
L_xb:
    buffer_load_dwordx4 v[128:131], v67, s[12:15], s71 offen offset:0
    buffer_load_dwordx4 v[132:135], v67, s[12:15], s71 offen offset:64
    buffer_load_dwordx4 v[136:139], v67, s[12:15], s71 offen offset:128
    buffer_load_dwordx4 v[140:143], v67, s[12:15], s71 offen offset:192
    buffer_load_dwordx4 v[144:147], v67, s[12:15], s71 offen offset:256
    buffer_load_dwordx4 v[148:151], v67, s[12:15], s71 offen offset:320
    buffer_load_dwordx4 v[152:155], v67, s[12:15], s71 offen offset:384
    buffer_load_dwordx4 v[156:159], v67, s[12:15], s71 offen offset:448
L_xdone:
L_xtlb:
    v_lshl_add_u32 v100, v64, 2, s3
    v_min_u32 v100, 0x80, v100
    v_cmp_gt_u32 vcc, 9, v100
    v_lshlrev_b32 v100, 21, v100
    v_mov_b32 v101, 0x7f000000
    s_mov_b32 s35, 0x1fc000
    v_cndmask_b32 v100, v101, v100, vcc
    buffer_load_dword v100, v100, s[8:11], s35 offen
    buffer_load_dword v101, off, s[16:19], s71
    s_cmp_eq_u32 s79, 2
    s_cbranch_scc0 L_nom3
    s_lshl_b32 s34, s76, 5
    s_add_u32 s34, s34, 131072
    s_waitcnt vmcnt(10)
    v_mov_b32 v68, s4
    s_mov_b64 exec, 1
    buffer_store_dword v68, v250, s[8:11], s34 offen sc1
    s_mov_b64 exec, -1
L_nom3:
    s_mov_b32 s68, 0x3f803f80
    v_mov_b64 v[80:81], 0
    s_waitcnt vmcnt(9)
    v_dot2c_f32_bf16 v80, s68, v128
    v_dot2c_f32_bf16 v81, v128, v128
    v_dot2c_f32_bf16 v80, s68, v129
    v_dot2c_f32_bf16 v81, v129, v129
    v_dot2c_f32_bf16 v80, s68, v130
    v_dot2c_f32_bf16 v81, v130, v130
    v_dot2c_f32_bf16 v80, s68, v131
    v_dot2c_f32_bf16 v81, v131, v131
    s_waitcnt vmcnt(8)
    v_dot2c_f32_bf16 v80, s68, v132
    v_dot2c_f32_bf16 v81, v132, v132
    v_dot2c_f32_bf16 v80, s68, v133
    v_dot2c_f32_bf16 v81, v133, v133
    v_dot2c_f32_bf16 v80, s68, v134
    v_dot2c_f32_bf16 v81, v134, v134
    v_dot2c_f32_bf16 v80, s68, v135
    v_dot2c_f32_bf16 v81, v135, v135
    s_waitcnt vmcnt(7)
    v_dot2c_f32_bf16 v80, s68, v136
    v_dot2c_f32_bf16 v81, v136, v136
    v_dot2c_f32_bf16 v80, s68, v137
    v_dot2c_f32_bf16 v81, v137, v137
    v_dot2c_f32_bf16 v80, s68, v138
    v_dot2c_f32_bf16 v81, v138, v138
    v_dot2c_f32_bf16 v80, s68, v139
    v_dot2c_f32_bf16 v81, v139, v139
    s_waitcnt vmcnt(6)
    v_dot2c_f32_bf16 v80, s68, v140
    v_dot2c_f32_bf16 v81, v140, v140
    v_dot2c_f32_bf16 v80, s68, v141
    v_dot2c_f32_bf16 v81, v141, v141
    v_dot2c_f32_bf16 v80, s68, v142
    v_dot2c_f32_bf16 v81, v142, v142
    v_dot2c_f32_bf16 v80, s68, v143
    v_dot2c_f32_bf16 v81, v143, v143
    s_waitcnt vmcnt(5)
    v_dot2c_f32_bf16 v80, s68, v144
    v_dot2c_f32_bf16 v81, v144, v144
    v_dot2c_f32_bf16 v80, s68, v145
    v_dot2c_f32_bf16 v81, v145, v145
    v_dot2c_f32_bf16 v80, s68, v146
    v_dot2c_f32_bf16 v81, v146, v146
    v_dot2c_f32_bf16 v80, s68, v147
    v_dot2c_f32_bf16 v81, v147, v147
    s_waitcnt vmcnt(4)
    v_dot2c_f32_bf16 v80, s68, v148
    v_dot2c_f32_bf16 v81, v148, v148
    v_dot2c_f32_bf16 v80, s68, v149
    v_dot2c_f32_bf16 v81, v149, v149
    v_dot2c_f32_bf16 v80, s68, v150
    v_dot2c_f32_bf16 v81, v150, v150
    v_dot2c_f32_bf16 v80, s68, v151
    v_dot2c_f32_bf16 v81, v151, v151
    s_waitcnt vmcnt(3)
    v_dot2c_f32_bf16 v80, s68, v152
    v_dot2c_f32_bf16 v81, v152, v152
    v_dot2c_f32_bf16 v80, s68, v153
    v_dot2c_f32_bf16 v81, v153, v153
    v_dot2c_f32_bf16 v80, s68, v154
    v_dot2c_f32_bf16 v81, v154, v154
    v_dot2c_f32_bf16 v80, s68, v155
    v_dot2c_f32_bf16 v81, v155, v155
    s_waitcnt vmcnt(2)
    v_dot2c_f32_bf16 v80, s68, v156
    v_dot2c_f32_bf16 v81, v156, v156
    v_dot2c_f32_bf16 v80, s68, v157
    v_dot2c_f32_bf16 v81, v157, v157
    v_dot2c_f32_bf16 v80, s68, v158
    v_dot2c_f32_bf16 v81, v158, v158
    v_dot2c_f32_bf16 v80, s68, v159
    v_dot2c_f32_bf16 v81, v159, v159
    s_nop 0
    s_add_u32 m0, s73, 0
    s_add_u32 s35, s72, 0
    buffer_load_dwordx4 v74, s[20:23], s35 offen offset:0 lds
    buffer_load_dwordx4 v75, s[20:23], s35 offen offset:1024 lds
    v_lshlrev_b32 v0, 16, v128
    v_and_b32 v1, s101, v128
    v_add_f32_dpp v80, v80, v80 quad_perm:[1,0,3,2] row_mask:0xf bank_mask:0xf
    v_add_f32_dpp v81, v81, v81 quad_perm:[1,0,3,2] row_mask:0xf bank_mask:0xf
    v_lshlrev_b32 v2, 16, v129
    v_and_b32 v3, s101, v129
    v_add_f32_dpp v80, v80, v80 quad_perm:[2,3,0,1] row_mask:0xf bank_mask:0xf
    v_add_f32_dpp v81, v81, v81 quad_perm:[2,3,0,1] row_mask:0xf bank_mask:0xf
    v_lshlrev_b32 v4, 16, v130
    v_and_b32 v5, s101, v130
    v_mul_f32 v80, 0xbb800000, v80
    v_mul_f32 v81, 0x3b800000, v81
    v_fma_f32 v81, -v80, v80, v81
    v_max_f32 v81, 0, v81
    v_add_f32 v81, 0x3727c5ac, v81
    v_rsq_f32 v81, v81
    v_lshlrev_b32 v6, 16, v131
    v_and_b32 v7, s101, v131
    v_mul_f32_e64 v80, v80, v81
    v_pk_fma_f32 v[0:1], v[0:1], v[80:81], v[80:81] op_sel:[0,1,0] op_sel_hi:[1,1,0]
    v_pk_fma_f32 v[2:3], v[2:3], v[80:81], v[80:81] op_sel:[0,1,0] op_sel_hi:[1,1,0]
    v_pk_fma_f32 v[4:5], v[4:5], v[80:81], v[80:81] op_sel:[0,1,0] op_sel_hi:[1,1,0]
    v_pk_fma_f32 v[6:7], v[6:7], v[80:81], v[80:81] op_sel:[0,1,0] op_sel_hi:[1,1,0]
    v_cvt_pk_bf16_f32 v128, v0, v1
    v_cvt_pk_bf16_f32 v129, v2, v3
    v_cvt_pk_bf16_f32 v130, v4, v5
    v_cvt_pk_bf16_f32 v131, v6, v7
    ds_write_b128 v97, v[128:131] offset:0
    buffer_load_dwordx4 v76, s[20:23], s35 offen offset:2048 lds
    v_lshlrev_b32 v8, 16, v132
    v_and_b32 v9, s101, v132
    v_lshlrev_b32 v10, 16, v133
    v_and_b32 v11, s101, v133
    v_lshlrev_b32 v12, 16, v134
    v_and_b32 v13, s101, v134
    v_lshlrev_b32 v14, 16, v135
    v_and_b32 v15, s101, v135
    v_pk_fma_f32 v[8:9], v[8:9], v[80:81], v[80:81] op_sel:[0,1,0] op_sel_hi:[1,1,0]
    v_pk_fma_f32 v[10:11], v[10:11], v[80:81], v[80:81] op_sel:[0,1,0] op_sel_hi:[1,1,0]
    v_pk_fma_f32 v[12:13], v[12:13], v[80:81], v[80:81] op_sel:[0,1,0] op_sel_hi:[1,1,0]
    v_pk_fma_f32 v[14:15], v[14:15], v[80:81], v[80:81] op_sel:[0,1,0] op_sel_hi:[1,1,0]
    v_cvt_pk_bf16_f32 v132, v8, v9
    v_cvt_pk_bf16_f32 v133, v10, v11
    v_cvt_pk_bf16_f32 v134, v12, v13
    v_cvt_pk_bf16_f32 v135, v14, v15
    ds_write_b128 v97, v[132:135] offset:1024
    buffer_load_dwordx4 v77, s[20:23], s35 offen offset:3072 lds
    s_add_u32 m0, s73, 4096
    s_add_u32 s35, s72, 65536
    buffer_load_dwordx4 v74, s[20:23], s35 offen offset:0 lds
    v_lshlrev_b32 v16, 16, v136
    v_and_b32 v17, s101, v136
    v_lshlrev_b32 v18, 16, v137
    v_and_b32 v19, s101, v137
    v_lshlrev_b32 v20, 16, v138
    v_and_b32 v21, s101, v138
    v_lshlrev_b32 v22, 16, v139
L_pad0:
    s_cbranch_execz L_pad4
    s_nop 0
    v_and_b32 v23, s101, v139
    v_pk_fma_f32 v[16:17], v[16:17], v[80:81], v[80:81] op_sel:[0,1,0] op_sel_hi:[1,1,0]
    v_pk_fma_f32 v[18:19], v[18:19], v[80:81], v[80:81] op_sel:[0,1,0] op_sel_hi:[1,1,0]
    v_pk_fma_f32 v[20:21], v[20:21], v[80:81], v[80:81] op_sel:[0,1,0] op_sel_hi:[1,1,0]
    v_pk_fma_f32 v[22:23], v[22:23], v[80:81], v[80:81] op_sel:[0,1,0] op_sel_hi:[1,1,0]
    v_cvt_pk_bf16_f32 v136, v16, v17
    v_cvt_pk_bf16_f32 v137, v18, v19
    v_cvt_pk_bf16_f32 v138, v20, v21
    v_cvt_pk_bf16_f32 v139, v22, v23
    ds_write_b128 v97, v[136:139] offset:2048
    buffer_load_dwordx4 v75, s[20:23], s35 offen offset:1024 lds
    v_lshlrev_b32 v24, 16, v140
    v_and_b32 v25, s101, v140
    v_lshlrev_b32 v26, 16, v141
    v_and_b32 v27, s101, v141
    v_lshlrev_b32 v28, 16, v142
    v_and_b32 v29, s101, v142
    v_lshlrev_b32 v30, 16, v143
    v_and_b32 v31, s101, v143
    v_pk_fma_f32 v[24:25], v[24:25], v[80:81], v[80:81] op_sel:[0,1,0] op_sel_hi:[1,1,0]
    v_pk_fma_f32 v[26:27], v[26:27], v[80:81], v[80:81] op_sel:[0,1,0] op_sel_hi:[1,1,0]
    v_pk_fma_f32 v[28:29], v[28:29], v[80:81], v[80:81] op_sel:[0,1,0] op_sel_hi:[1,1,0]
    v_pk_fma_f32 v[30:31], v[30:31], v[80:81], v[80:81] op_sel:[0,1,0] op_sel_hi:[1,1,0]
    v_cvt_pk_bf16_f32 v140, v24, v25
    v_cvt_pk_bf16_f32 v141, v26, v27
    v_cvt_pk_bf16_f32 v142, v28, v29
    v_cvt_pk_bf16_f32 v143, v30, v31
    ds_write_b128 v97, v[140:143] offset:3072
    buffer_load_dwordx4 v76, s[20:23], s35 offen offset:2048 lds
    buffer_load_dwordx4 v77, s[20:23], s35 offen offset:3072 lds
    v_lshlrev_b32 v32, 16, v144
    v_and_b32 v33, s101, v144
    v_lshlrev_b32 v34, 16, v145
    v_and_b32 v35, s101, v145
    v_lshlrev_b32 v36, 16, v146
    v_and_b32 v37, s101, v146
    v_lshlrev_b32 v38, 16, v147
    v_and_b32 v39, s101, v147
    v_pk_fma_f32 v[32:33], v[32:33], v[80:81], v[80:81] op_sel:[0,1,0] op_sel_hi:[1,1,0]
    v_pk_fma_f32 v[34:35], v[34:35], v[80:81], v[80:81] op_sel:[0,1,0] op_sel_hi:[1,1,0]
    v_pk_fma_f32 v[36:37], v[36:37], v[80:81], v[80:81] op_sel:[0,1,0] op_sel_hi:[1,1,0]
    v_pk_fma_f32 v[38:39], v[38:39], v[80:81], v[80:81] op_sel:[0,1,0] op_sel_hi:[1,1,0]
    v_cvt_pk_bf16_f32 v144, v32, v33
    v_cvt_pk_bf16_f32 v145, v34, v35
    v_cvt_pk_bf16_f32 v146, v36, v37
    v_cvt_pk_bf16_f32 v147, v38, v39
    s_add_u32 m0, s73, 8192
    s_add_u32 s35, s72, 131072
    ds_write_b128 v97, v[144:147] offset:4096
    buffer_load_dwordx4 v74, s[20:23], s35 offen offset:0 lds
    v_lshlrev_b32 v40, 16, v148
    v_and_b32 v41, s101, v148
    v_lshlrev_b32 v42, 16, v149
    v_and_b32 v43, s101, v149
    v_lshlrev_b32 v44, 16, v150
    v_and_b32 v45, s101, v150
    v_lshlrev_b32 v46, 16, v151
    v_and_b32 v47, s101, v151
    v_pk_fma_f32 v[40:41], v[40:41], v[80:81], v[80:81] op_sel:[0,1,0] op_sel_hi:[1,1,0]
    v_pk_fma_f32 v[42:43], v[42:43], v[80:81], v[80:81] op_sel:[0,1,0] op_sel_hi:[1,1,0]
    v_pk_fma_f32 v[44:45], v[44:45], v[80:81], v[80:81] op_sel:[0,1,0] op_sel_hi:[1,1,0]
    v_pk_fma_f32 v[46:47], v[46:47], v[80:81], v[80:81] op_sel:[0,1,0] op_sel_hi:[1,1,0]
    v_cvt_pk_bf16_f32 v148, v40, v41
    v_cvt_pk_bf16_f32 v149, v42, v43
    v_cvt_pk_bf16_f32 v150, v44, v45
    v_cvt_pk_bf16_f32 v151, v46, v47
    ds_write_b128 v97, v[148:151] offset:5120
    buffer_load_dwordx4 v75, s[20:23], s35 offen offset:1024 lds
    buffer_load_dwordx4 v76, s[20:23], s35 offen offset:2048 lds
    v_lshlrev_b32 v48, 16, v152
    v_and_b32 v49, s101, v152
    v_lshlrev_b32 v50, 16, v153
    v_and_b32 v51, s101, v153
    v_lshlrev_b32 v52, 16, v154
    v_and_b32 v53, s101, v154
    v_lshlrev_b32 v54, 16, v155
    v_and_b32 v55, s101, v155
    v_pk_fma_f32 v[48:49], v[48:49], v[80:81], v[80:81] op_sel:[0,1,0] op_sel_hi:[1,1,0]
    v_pk_fma_f32 v[50:51], v[50:51], v[80:81], v[80:81] op_sel:[0,1,0] op_sel_hi:[1,1,0]
    v_pk_fma_f32 v[52:53], v[52:53], v[80:81], v[80:81] op_sel:[0,1,0] op_sel_hi:[1,1,0]
    v_pk_fma_f32 v[54:55], v[54:55], v[80:81], v[80:81] op_sel:[0,1,0] op_sel_hi:[1,1,0]
    v_cvt_pk_bf16_f32 v152, v48, v49
    v_cvt_pk_bf16_f32 v153, v50, v51
    v_cvt_pk_bf16_f32 v154, v52, v53
    v_cvt_pk_bf16_f32 v155, v54, v55
    ds_write_b128 v97, v[152:155] offset:6144
    buffer_load_dwordx4 v77, s[20:23], s35 offen offset:3072 lds
    v_lshlrev_b32 v56, 16, v156
    v_and_b32 v57, s101, v156
    v_lshlrev_b32 v58, 16, v157
    v_and_b32 v59, s101, v157
    v_lshlrev_b32 v60, 16, v158
    v_and_b32 v61, s101, v158
    v_lshlrev_b32 v62, 16, v159
    v_and_b32 v63, s101, v159
    v_pk_fma_f32 v[56:57], v[56:57], v[80:81], v[80:81] op_sel:[0,1,0] op_sel_hi:[1,1,0]
    v_pk_fma_f32 v[58:59], v[58:59], v[80:81], v[80:81] op_sel:[0,1,0] op_sel_hi:[1,1,0]
    v_pk_fma_f32 v[60:61], v[60:61], v[80:81], v[80:81] op_sel:[0,1,0] op_sel_hi:[1,1,0]
    v_pk_fma_f32 v[62:63], v[62:63], v[80:81], v[80:81] op_sel:[0,1,0] op_sel_hi:[1,1,0]
    v_cvt_pk_bf16_f32 v156, v56, v57
    v_cvt_pk_bf16_f32 v157, v58, v59
    v_cvt_pk_bf16_f32 v158, v60, v61
    v_cvt_pk_bf16_f32 v159, v62, v63
    s_add_u32 m0, s73, 12288
    s_add_u32 s35, s72, 196608
    ds_write_b128 v97, v[156:159] offset:7168
    buffer_load_dwordx4 v74, s[20:23], s35 offen offset:0 lds
    buffer_load_dwordx4 v75, s[20:23], s35 offen offset:1024 lds
    s_waitcnt vmcnt(10)
    s_nop 0
    ds_read_b64_tr_b16 v[208:209], v78 offset:0
    ds_read_b64_tr_b16 v[210:211], v78 offset:256
    ds_read_b64_tr_b16 v[212:213], v79 offset:0
    ds_read_b64_tr_b16 v[214:215], v79 offset:256
    ds_read_b64_tr_b16 v[216:217], v78 offset:2048
    ds_read_b64_tr_b16 v[218:219], v78 offset:2304
    ds_read_b64_tr_b16 v[220:221], v79 offset:2048
    ds_read_b64_tr_b16 v[222:223], v79 offset:2304
    s_waitcnt lgkmcnt(8)
    s_barrier
    ds_read_b128 a[0:3], v98 offset:0
    ds_read_b128 a[32:35], v98 offset:8192
    ds_read_b128 a[64:67], v98 offset:16384
    ds_read_b128 a[96:99], v98 offset:24576
    ds_read_b128 a[4:7], v98 offset:1024
    ds_read_b128 a[36:39], v98 offset:9216
    s_waitcnt lgkmcnt(2)
    v_mfma_f32_16x16x32_bf16 v[0:3], v[208:211], a[0:3], 0
    ds_read_b128 a[68:71], v98 offset:17408
    v_min_u32 v68, 1, v250
    v_mfma_f32_16x16x32_bf16 v[4:7], v[208:211], a[32:35], 0
    ds_read_b128 a[100:103], v98 offset:25600
    v_lshlrev_b32 v68, 30, v68
    v_mfma_f32_16x16x32_bf16 v[8:11], v[208:211], a[64:67], 0
    buffer_load_dwordx4 v76, s[20:23], s35 offen offset:2048 lds
    v_mfma_f32_16x16x32_bf16 v[12:15], v[208:211], a[96:99], 0
    ds_read_b128 a[8:11], v98 offset:2048
    v_mov_b32 v73, s4
    v_mfma_f32_16x16x32_bf16 v[28:31], v[212:215], a[96:99], 0
    s_waitcnt vmcnt(9)
    ds_read_b64_tr_b16 v[224:225], v78 offset:4096
    ds_read_b64_tr_b16 v[226:227], v78 offset:4352
    v_mfma_f32_16x16x32_bf16 v[24:27], v[212:215], a[64:67], 0
    ds_read_b64_tr_b16 v[228:229], v79 offset:4096
    ds_read_b64_tr_b16 v[230:231], v79 offset:4352
    v_mfma_f32_16x16x32_bf16 v[20:23], v[212:215], a[32:35], 0
    buffer_load_dwordx4 v77, s[20:23], s35 offen offset:3072 lds
    v_mfma_f32_16x16x32_bf16 v[16:19], v[212:215], a[0:3], 0
    s_waitcnt lgkmcnt(5)
    ds_read_b128 a[40:43], v98 offset:10240
    v_mfma_f32_16x16x32_bf16 v[0:3], v[216:219], a[4:7], v[0:3]
    s_add_u32 m0, s73, 16384
    ds_read_b128 a[72:75], v98 offset:18432
    v_lshrrev_b32 v67, 1, v72
    v_mfma_f32_16x16x32_bf16 v[4:7], v[216:219], a[36:39], v[4:7]
    s_add_u32 s35, s72, 256
    ds_read_b128 a[104:107], v98 offset:26624
    v_and_b32 v67, v67, v72
    v_mfma_f32_16x16x32_bf16 v[8:11], v[216:219], a[68:71], v[8:11]
    buffer_load_dwordx4 v74, s[20:23], s35 offen offset:0 lds
    v_mfma_f32_16x16x32_bf16 v[12:15], v[216:219], a[100:103], v[12:15]
    ds_read_b128 a[12:15], v98 offset:3072
    v_mul_u32_u24 v67, 0xffff, v67
    v_mfma_f32_16x16x32_bf16 v[28:31], v[220:223], a[100:103], v[28:31]
    s_waitcnt vmcnt(9)
    ds_read_b64_tr_b16 v[232:233], v78 offset:6144
    ds_read_b64_tr_b16 v[234:235], v78 offset:6400
    v_mfma_f32_16x16x32_bf16 v[24:27], v[220:223], a[68:71], v[24:27]
    ds_read_b64_tr_b16 v[236:237], v79 offset:6144
    ds_read_b64_tr_b16 v[238:239], v79 offset:6400
    v_mfma_f32_16x16x32_bf16 v[20:23], v[220:223], a[36:39], v[20:23]
    buffer_load_dwordx4 v75, s[20:23], s35 offen offset:1024 lds
    v_mfma_f32_16x16x32_bf16 v[16:19], v[220:223], a[4:7], v[16:19]
    s_waitcnt lgkmcnt(5)
    ds_read_b128 a[44:47], v98 offset:11264
    v_lshlrev_b32 v67, 16, v67
    v_mfma_f32_16x16x32_bf16 v[0:3], v[224:227], a[8:11], v[0:3]
    ds_read_b128 a[76:79], v98 offset:19456
    v_mfma_f32_16x16x32_bf16 v[4:7], v[224:227], a[40:43], v[4:7]
    ds_read_b128 a[108:111], v98 offset:27648
    v_mfma_f32_16x16x32_bf16 v[8:11], v[224:227], a[72:75], v[8:11]
    buffer_load_dwordx4 v76, s[20:23], s35 offen offset:2048 lds
    v_mfma_f32_16x16x32_bf16 v[12:15], v[224:227], a[104:107], v[12:15]
    ds_read_b128 a[16:19], v98 offset:4096
    v_mfma_f32_16x16x32_bf16 v[28:31], v[228:231], a[104:107], v[28:31]
    s_waitcnt vmcnt(9)
    ds_read_b64_tr_b16 v[208:209], v78 offset:8192
    ds_read_b64_tr_b16 v[210:211], v78 offset:8448
    v_mfma_f32_16x16x32_bf16 v[24:27], v[228:231], a[72:75], v[24:27]
    ds_read_b64_tr_b16 v[212:213], v79 offset:8192
    ds_read_b64_tr_b16 v[214:215], v79 offset:8448
    v_mfma_f32_16x16x32_bf16 v[20:23], v[228:231], a[40:43], v[20:23]
    buffer_load_dwordx4 v77, s[20:23], s35 offen offset:3072 lds
    v_mfma_f32_16x16x32_bf16 v[16:19], v[228:231], a[8:11], v[16:19]
    s_waitcnt lgkmcnt(5)
    ds_read_b128 a[48:51], v98 offset:12288
    v_mfma_f32_16x16x32_bf16 v[0:3], v[232:235], a[12:15], v[0:3]
    s_add_u32 m0, s73, 20480
    ds_read_b128 a[80:83], v98 offset:20480
    v_mfma_f32_16x16x32_bf16 v[4:7], v[232:235], a[44:47], v[4:7]
    s_add_u32 s35, s72, 65792
    ds_read_b128 a[112:115], v98 offset:28672
    v_mfma_f32_16x16x32_bf16 v[8:11], v[232:235], a[76:79], v[8:11]
    buffer_load_dwordx4 v74, s[20:23], s35 offen offset:0 lds
    v_mfma_f32_16x16x32_bf16 v[12:15], v[232:235], a[108:111], v[12:15]
    ds_read_b128 a[20:23], v98 offset:5120
    v_mfma_f32_16x16x32_bf16 v[28:31], v[236:239], a[108:111], v[28:31]
    s_waitcnt vmcnt(9)
    ds_read_b64_tr_b16 v[216:217], v78 offset:10240
    ds_read_b64_tr_b16 v[218:219], v78 offset:10496
    v_mfma_f32_16x16x32_bf16 v[24:27], v[236:239], a[76:79], v[24:27]
    ds_read_b64_tr_b16 v[220:221], v79 offset:10240
    ds_read_b64_tr_b16 v[222:223], v79 offset:10496
    v_mfma_f32_16x16x32_bf16 v[20:23], v[236:239], a[44:47], v[20:23]
    buffer_load_dwordx4 v75, s[20:23], s35 offen offset:1024 lds
    v_mfma_f32_16x16x32_bf16 v[16:19], v[236:239], a[12:15], v[16:19]
    s_waitcnt lgkmcnt(5)
    ds_read_b128 a[52:55], v98 offset:13312
    v_mfma_f32_16x16x32_bf16 v[0:3], v[208:211], a[16:19], v[0:3]
    ds_read_b128 a[84:87], v98 offset:21504
    v_mfma_f32_16x16x32_bf16 v[4:7], v[208:211], a[48:51], v[4:7]
    ds_read_b128 a[116:119], v98 offset:29696
    v_mfma_f32_16x16x32_bf16 v[8:11], v[208:211], a[80:83], v[8:11]
    buffer_load_dwordx4 v76, s[20:23], s35 offen offset:2048 lds
    v_mfma_f32_16x16x32_bf16 v[12:15], v[208:211], a[112:115], v[12:15]
    ds_read_b128 a[24:27], v98 offset:6144
    v_mfma_f32_16x16x32_bf16 v[28:31], v[212:215], a[112:115], v[28:31]
    s_waitcnt vmcnt(9)
    ds_read_b64_tr_b16 v[224:225], v78 offset:12288
    ds_read_b64_tr_b16 v[226:227], v78 offset:12544
    v_mfma_f32_16x16x32_bf16 v[24:27], v[212:215], a[80:83], v[24:27]
    ds_read_b64_tr_b16 v[228:229], v79 offset:12288
    ds_read_b64_tr_b16 v[230:231], v79 offset:12544
    v_mfma_f32_16x16x32_bf16 v[20:23], v[212:215], a[48:51], v[20:23]
    buffer_load_dwordx4 v77, s[20:23], s35 offen offset:3072 lds
    v_mfma_f32_16x16x32_bf16 v[16:19], v[212:215], a[16:19], v[16:19]
    s_waitcnt lgkmcnt(5)
    ds_read_b128 a[56:59], v98 offset:14336
    v_mfma_f32_16x16x32_bf16 v[0:3], v[216:219], a[20:23], v[0:3]
    s_add_u32 m0, s73, 24576
    ds_read_b128 a[88:91], v98 offset:22528
    v_mfma_f32_16x16x32_bf16 v[4:7], v[216:219], a[52:55], v[4:7]
    s_add_u32 s35, s72, 131328
    ds_read_b128 a[120:123], v98 offset:30720
    v_mfma_f32_16x16x32_bf16 v[8:11], v[216:219], a[84:87], v[8:11]
    buffer_load_dwordx4 v74, s[20:23], s35 offen offset:0 lds
    v_mfma_f32_16x16x32_bf16 v[12:15], v[216:219], a[116:119], v[12:15]
    ds_read_b128 a[28:31], v98 offset:7168
    v_mfma_f32_16x16x32_bf16 v[28:31], v[220:223], a[116:119], v[28:31]
    s_waitcnt vmcnt(9)
    ds_read_b64_tr_b16 v[232:233], v78 offset:14336
    ds_read_b64_tr_b16 v[234:235], v78 offset:14592
    v_mfma_f32_16x16x32_bf16 v[24:27], v[220:223], a[84:87], v[24:27]
    ds_read_b64_tr_b16 v[236:237], v79 offset:14336
    ds_read_b64_tr_b16 v[238:239], v79 offset:14592
    v_mfma_f32_16x16x32_bf16 v[20:23], v[220:223], a[52:55], v[20:23]
    buffer_load_dwordx4 v75, s[20:23], s35 offen offset:1024 lds
    v_mfma_f32_16x16x32_bf16 v[16:19], v[220:223], a[20:23], v[16:19]
    s_waitcnt lgkmcnt(5)
    ds_read_b128 a[60:63], v98 offset:15360
    v_mfma_f32_16x16x32_bf16 v[0:3], v[224:227], a[24:27], v[0:3]
    ds_read_b128 a[92:95], v98 offset:23552
    v_mfma_f32_16x16x32_bf16 v[4:7], v[224:227], a[56:59], v[4:7]
    ds_read_b128 a[124:127], v98 offset:31744
    v_mfma_f32_16x16x32_bf16 v[8:11], v[224:227], a[88:91], v[8:11]
    buffer_load_dwordx4 v76, s[20:23], s35 offen offset:2048 lds
    v_mfma_f32_16x16x32_bf16 v[12:15], v[224:227], a[120:123], v[12:15]
    ds_read_b128 v[128:131], v96 offset:0
    v_mfma_f32_16x16x32_bf16 v[28:31], v[228:231], a[120:123], v[28:31]
    s_waitcnt vmcnt(9)
    ds_read_b64_tr_b16 v[208:209], v78 offset:16384
    ds_read_b64_tr_b16 v[210:211], v78 offset:16640
    v_mfma_f32_16x16x32_bf16 v[24:27], v[228:231], a[88:91], v[24:27]
    ds_read_b64_tr_b16 v[212:213], v79 offset:16384
    ds_read_b64_tr_b16 v[214:215], v79 offset:16640
    v_mfma_f32_16x16x32_bf16 v[20:23], v[228:231], a[56:59], v[20:23]
    buffer_load_dwordx4 v77, s[20:23], s35 offen offset:3072 lds
    v_mfma_f32_16x16x32_bf16 v[16:19], v[228:231], a[24:27], v[16:19]
    s_waitcnt lgkmcnt(5)
    ds_read_b128 v[132:135], v96 offset:1024
    v_mfma_f32_16x16x32_bf16 v[0:3], v[232:235], a[28:31], v[0:3]
    s_add_u32 m0, s73, 28672
    ds_read_b128 v[136:139], v96 offset:2048
    v_mfma_f32_16x16x32_bf16 v[4:7], v[232:235], a[60:63], v[4:7]
    s_add_u32 s35, s72, 196864
    ds_read_b128 v[140:143], v96 offset:3072
    v_mfma_f32_16x16x32_bf16 v[8:11], v[232:235], a[92:95], v[8:11]
    buffer_load_dwordx4 v74, s[20:23], s35 offen offset:0 lds
    v_mfma_f32_16x16x32_bf16 v[12:15], v[232:235], a[124:127], v[12:15]
    ds_read_b128 v[144:147], v96 offset:4096
    v_mfma_f32_16x16x32_bf16 v[28:31], v[236:239], a[124:127], v[28:31]
    s_waitcnt vmcnt(9)
    ds_read_b64_tr_b16 v[216:217], v78 offset:18432
    ds_read_b64_tr_b16 v[218:219], v78 offset:18688
    v_mfma_f32_16x16x32_bf16 v[24:27], v[236:239], a[92:95], v[24:27]
    s_add_u32 s71, s73, 524288
    ds_read_b64_tr_b16 v[220:221], v79 offset:18432
    ds_read_b64_tr_b16 v[222:223], v79 offset:18688
    v_mfma_f32_16x16x32_bf16 v[20:23], v[236:239], a[60:63], v[20:23]
    buffer_load_dwordx4 v75, s[20:23], s35 offen offset:1024 lds
    v_mfma_f32_16x16x32_bf16 v[16:19], v[236:239], a[28:31], v[16:19]
    s_waitcnt lgkmcnt(8)
    ds_read_b128 v[148:151], v96 offset:5120
    s_add_u32 s72, s71, 16384
    v_mfma_f32_16x16x32_bf16 v[32:35], v[208:211], a[0:3], 0
    ds_read_b128 v[152:155], v96 offset:6144
    v_mul_f32 v104, v0, v0
    v_mfma_f32_16x16x32_bf16 v[36:39], v[208:211], a[32:35], 0
    ds_read_b128 v[156:159], v96 offset:7168
    v_fma_f32 v104, v104, v162, v160
    v_mfma_f32_16x16x32_bf16 v[40:43], v[208:211], a[64:67], 0
    buffer_load_dwordx4 v76, s[20:23], s35 offen offset:2048 lds
    v_mfma_f32_16x16x32_bf16 v[44:47], v[208:211], a[96:99], 0
    v_mul_f32 v104, v104, v0
    v_mul_f32 v105, v1, v1
    v_mfma_f32_16x16x32_bf16 v[60:63], v[212:215], a[96:99], 0
    s_waitcnt vmcnt(9)
    ds_read_b64_tr_b16 v[224:225], v78 offset:20480
    v_fma_f32 v105, v105, v162, v160
    v_mfma_f32_16x16x32_bf16 v[56:59], v[212:215], a[64:67], 0
    ds_read_b64_tr_b16 v[226:227], v78 offset:20736
    ds_read_b64_tr_b16 v[228:229], v79 offset:20480
    v_mfma_f32_16x16x32_bf16 v[52:55], v[212:215], a[32:35], 0
    buffer_load_dwordx4 v77, s[20:23], s35 offen offset:3072 lds
    v_mfma_f32_16x16x32_bf16 v[48:51], v[212:215], a[0:3], 0
    s_waitcnt lgkmcnt(6)
    ds_read_b64_tr_b16 v[230:231], v79 offset:20736
    v_mul_f32 v105, v105, v1
    v_mfma_f32_16x16x32_bf16 v[32:35], v[216:219], a[4:7], v[32:35]
    buffer_load_dword v255, v254, s[8:11], s46 offen sc1
    v_mfma_f32_16x16x32_bf16 v[36:39], v[216:219], a[36:39], v[36:39]
    v_exp_f32 v104, v104
    v_mfma_f32_16x16x32_bf16 v[40:43], v[216:219], a[68:71], v[40:43]
    v_exp_f32 v105, v105
    v_mfma_f32_16x16x32_bf16 v[44:47], v[216:219], a[100:103], v[44:47]
    v_add_f32 v104, 1.0, v104
    v_add_f32 v105, 1.0, v105
    v_mfma_f32_16x16x32_bf16 v[60:63], v[220:223], a[100:103], v[60:63]
    s_waitcnt vmcnt(9)
    ds_read_b64_tr_b16 v[232:233], v78 offset:22528
    v_mul_f32 v106, v2, v2
    v_mfma_f32_16x16x32_bf16 v[56:59], v[220:223], a[68:71], v[56:59]
    ds_read_b64_tr_b16 v[234:235], v78 offset:22784
    ds_read_b64_tr_b16 v[236:237], v79 offset:22528
    v_mfma_f32_16x16x32_bf16 v[52:55], v[220:223], a[36:39], v[52:55]
    buffer_store_dwordx4 v[128:131], v248, s[8:11], s50 offen offset:0 sc1
    v_mfma_f32_16x16x32_bf16 v[48:51], v[220:223], a[4:7], v[48:51]
    s_waitcnt lgkmcnt(3)
    ds_read_b64_tr_b16 v[238:239], v79 offset:22784
    v_fma_f32 v106, v106, v162, v160
    v_mfma_f32_16x16x32_bf16 v[32:35], v[224:227], a[8:11], v[32:35]
    v_bfi_b32 v159, v67, 1.0, v159
    v_mul_f32 v106, v106, v2
    v_mfma_f32_16x16x32_bf16 v[36:39], v[224:227], a[40:43], v[36:39]
    v_rcp_f32 v104, v104
    v_mfma_f32_16x16x32_bf16 v[40:43], v[224:227], a[72:75], v[40:43]
    buffer_store_dwordx4 v[132:135], v248, s[8:11], s50 offen offset:1024 sc1
    v_mfma_f32_16x16x32_bf16 v[44:47], v[224:227], a[104:107], v[44:47]
    v_rcp_f32 v105, v105
    v_mfma_f32_16x16x32_bf16 v[60:63], v[228:231], a[104:107], v[60:63]
    s_waitcnt vmcnt(9)
    ds_read_b64_tr_b16 v[208:209], v78 offset:24576
    v_mul_f32 v0, v0, v104
    v_mfma_f32_16x16x32_bf16 v[56:59], v[228:231], a[72:75], v[56:59]
    ds_read_b64_tr_b16 v[210:211], v78 offset:24832
    ds_read_b64_tr_b16 v[212:213], v79 offset:24576
    v_mfma_f32_16x16x32_bf16 v[52:55], v[228:231], a[40:43], v[52:55]
    buffer_store_dwordx4 v[136:139], v248, s[8:11], s51 offen offset:0 sc1
    v_mfma_f32_16x16x32_bf16 v[48:51], v[228:231], a[8:11], v[48:51]
    s_waitcnt lgkmcnt(3)
    ds_read_b64_tr_b16 v[214:215], v79 offset:24832
    v_mul_f32 v1, v1, v105
    v_mfma_f32_16x16x32_bf16 v[32:35], v[232:235], a[12:15], v[32:35]
    v_exp_f32 v106, v106
    v_mfma_f32_16x16x32_bf16 v[36:39], v[232:235], a[44:47], v[36:39]
    v_add_f32 v106, 1.0, v106
    v_mul_f32 v107, v3, v3
    v_mfma_f32_16x16x32_bf16 v[40:43], v[232:235], a[76:79], v[40:43]
    buffer_store_dwordx4 v[140:143], v248, s[8:11], s51 offen offset:1024 sc1
    v_mfma_f32_16x16x32_bf16 v[44:47], v[232:235], a[108:111], v[44:47]
    v_rcp_f32 v106, v106
    v_mfma_f32_16x16x32_bf16 v[60:63], v[236:239], a[108:111], v[60:63]
    s_waitcnt vmcnt(9)
    ds_read_b64_tr_b16 v[216:217], v78 offset:26624
    v_mul_f32 v2, v2, v106
    v_mfma_f32_16x16x32_bf16 v[56:59], v[236:239], a[76:79], v[56:59]
    ds_read_b64_tr_b16 v[218:219], v78 offset:26880
    ds_read_b64_tr_b16 v[220:221], v79 offset:26624
    v_mfma_f32_16x16x32_bf16 v[52:55], v[236:239], a[44:47], v[52:55]
    buffer_store_dwordx4 v[144:147], v248, s[8:11], s52 offen offset:0 sc1
    v_mfma_f32_16x16x32_bf16 v[48:51], v[236:239], a[12:15], v[48:51]
    s_waitcnt lgkmcnt(3)
    ds_read_b64_tr_b16 v[222:223], v79 offset:26880
    v_fma_f32 v107, v107, v162, v160
    v_mfma_f32_16x16x32_bf16 v[32:35], v[208:211], a[16:19], v[32:35]
    v_mul_f32 v107, v107, v3
    v_mul_f32 v108, v4, v4
    v_mfma_f32_16x16x32_bf16 v[36:39], v[208:211], a[48:51], v[36:39]
    v_exp_f32 v107, v107
    v_mfma_f32_16x16x32_bf16 v[40:43], v[208:211], a[80:83], v[40:43]
    buffer_store_dwordx4 v[148:151], v248, s[8:11], s52 offen offset:1024 sc1
    v_mfma_f32_16x16x32_bf16 v[44:47], v[208:211], a[112:115], v[44:47]
    v_add_f32 v107, 1.0, v107
    v_fma_f32 v108, v108, v162, v160
    v_mfma_f32_16x16x32_bf16 v[60:63], v[212:215], a[112:115], v[60:63]
    s_waitcnt vmcnt(9)
    ds_read_b64_tr_b16 v[224:225], v78 offset:28672
    v_mul_f32 v108, v108, v4
    v_mfma_f32_16x16x32_bf16 v[56:59], v[212:215], a[80:83], v[56:59]
    ds_read_b64_tr_b16 v[226:227], v78 offset:28928
    ds_read_b64_tr_b16 v[228:229], v79 offset:28672
    v_mfma_f32_16x16x32_bf16 v[52:55], v[212:215], a[48:51], v[52:55]
    buffer_store_dwordx4 v[152:155], v248, s[8:11], s53 offen offset:0 sc1
    v_mfma_f32_16x16x32_bf16 v[48:51], v[212:215], a[16:19], v[48:51]
    s_waitcnt lgkmcnt(3)
    ds_read_b64_tr_b16 v[230:231], v79 offset:28928
    v_mul_f32 v109, v5, v5
    v_mfma_f32_16x16x32_bf16 v[32:35], v[216:219], a[20:23], v[32:35]
    v_rcp_f32 v107, v107
    v_mfma_f32_16x16x32_bf16 v[36:39], v[216:219], a[52:55], v[36:39]
    v_exp_f32 v108, v108
    v_mfma_f32_16x16x32_bf16 v[40:43], v[216:219], a[84:87], v[40:43]
    buffer_store_dwordx4 v[156:159], v248, s[8:11], s53 offen offset:1024 sc1
    v_mfma_f32_16x16x32_bf16 v[44:47], v[216:219], a[116:119], v[44:47]
    v_mul_f32 v3, v3, v107
    v_add_f32 v108, 1.0, v108
    v_mfma_f32_16x16x32_bf16 v[60:63], v[220:223], a[116:119], v[60:63]
    s_waitcnt vmcnt(9)
    ds_read_b64_tr_b16 v[232:233], v78 offset:30720
    v_fma_f32 v109, v109, v162, v160
    v_mfma_f32_16x16x32_bf16 v[56:59], v[220:223], a[84:87], v[56:59]
    ds_read_b64_tr_b16 v[234:235], v78 offset:30976
    ds_read_b64_tr_b16 v[236:237], v79 offset:30720
    v_mfma_f32_16x16x32_bf16 v[52:55], v[220:223], a[52:55], v[52:55]
    v_rcp_f32 v108, v108
    v_mfma_f32_16x16x32_bf16 v[48:51], v[220:223], a[20:23], v[48:51]
    s_waitcnt lgkmcnt(3)
    ds_read_b64_tr_b16 v[238:239], v79 offset:30976
    v_mul_f32 v4, v4, v108
    v_mfma_f32_16x16x32_bf16 v[32:35], v[224:227], a[24:27], v[32:35]
    v_mul_f32 v109, v109, v5
    v_mul_f32 v110, v6, v6
    v_mfma_f32_16x16x32_bf16 v[36:39], v[224:227], a[56:59], v[36:39]
    v_exp_f32 v109, v109
    v_mfma_f32_16x16x32_bf16 v[40:43], v[224:227], a[88:91], v[40:43]
    v_add_f32 v109, 1.0, v109
    v_fma_f32 v110, v110, v162, v160
    v_mfma_f32_16x16x32_bf16 v[44:47], v[224:227], a[120:123], v[44:47]
    v_rcp_f32 v109, v109
    v_mfma_f32_16x16x32_bf16 v[60:63], v[228:231], a[120:123], v[60:63]
    v_mul_f32 v5, v5, v109
    v_mul_f32 v110, v110, v6
    v_mfma_f32_16x16x32_bf16 v[56:59], v[228:231], a[88:91], v[56:59]
    v_exp_f32 v110, v110
    v_mfma_f32_16x16x32_bf16 v[52:55], v[228:231], a[56:59], v[52:55]
    v_add_f32 v110, 1.0, v110
    v_mul_f32 v111, v7, v7
    v_mfma_f32_16x16x32_bf16 v[48:51], v[228:231], a[24:27], v[48:51]
    s_waitcnt lgkmcnt(0)
    v_rcp_f32 v110, v110
    v_mfma_f32_16x16x32_bf16 v[32:35], v[232:235], a[28:31], v[32:35]
    v_mul_f32 v6, v6, v110
    v_fma_f32 v111, v111, v162, v160
    s_barrier
    v_mfma_f32_16x16x32_bf16 v[36:39], v[232:235], a[60:63], v[36:39]
    v_mul_f32 v111, v111, v7
    v_mfma_f32_16x16x32_bf16 v[40:43], v[232:235], a[92:95], v[40:43]
    v_exp_f32 v111, v111
    v_mfma_f32_16x16x32_bf16 v[44:47], v[232:235], a[124:127], v[44:47]
    v_add_f32 v111, 1.0, v111
    v_mfma_f32_16x16x32_bf16 v[60:63], v[236:239], a[124:127], v[60:63]
    s_waitcnt vmcnt(8)
    v_cmp_eq_u32 vcc, s4, v255
    v_mfma_f32_16x16x32_bf16 v[56:59], v[236:239], a[92:95], v[56:59]
    v_rcp_f32 v111, v111
    v_mfma_f32_16x16x32_bf16 v[52:55], v[236:239], a[60:63], v[52:55]
    s_cmp_eq_u32 vcc_lo, -1
    v_mul_f32 v7, v7, v111
    v_mfma_f32_16x16x32_bf16 v[48:51], v[236:239], a[28:31], v[48:51]
    s_cbranch_scc0 L_mlate
    s_nop 0
    buffer_load_dwordx4 a[128:131], v250, s[8:11], s71 offen offset:0 sc1
    buffer_load_dwordx4 a[132:135], v250, s[8:11], s71 offen offset:1024 sc1
    v_pk_mul_f32 v[112:113], v[8:9], v[8:9]
    v_pk_mul_f32 v[114:115], v[10:11], v[10:11]
    v_pk_mul_f32 v[116:117], v[12:13], v[12:13]
    v_pk_mul_f32 v[118:119], v[14:15], v[14:15]
    v_pk_mul_f32 v[104:105], v[16:17], v[16:17]
    v_pk_mul_f32 v[106:107], v[18:19], v[18:19]
    v_pk_mul_f32 v[108:109], v[20:21], v[20:21]
    v_pk_fma_f32 v[112:113], v[112:113], v[162:163], v[160:161] op_sel_hi:[1,0,0]
    v_pk_fma_f32 v[114:115], v[114:115], v[162:163], v[160:161] op_sel_hi:[1,0,0]
    v_pk_fma_f32 v[116:117], v[116:117], v[162:163], v[160:161] op_sel_hi:[1,0,0]
    v_pk_fma_f32 v[118:119], v[118:119], v[162:163], v[160:161] op_sel_hi:[1,0,0]
    v_pk_fma_f32 v[104:105], v[104:105], v[162:163], v[160:161] op_sel_hi:[1,0,0]
    v_pk_fma_f32 v[106:107], v[106:107], v[162:163], v[160:161] op_sel_hi:[1,0,0]
    v_pk_fma_f32 v[108:109], v[108:109], v[162:163], v[160:161] op_sel_hi:[1,0,0]
    v_pk_mul_f32 v[112:113], v[112:113], v[8:9]
    v_pk_mul_f32 v[114:115], v[114:115], v[10:11]
    v_pk_mul_f32 v[116:117], v[116:117], v[12:13]
    v_pk_mul_f32 v[118:119], v[118:119], v[14:15]
    v_pk_mul_f32 v[104:105], v[104:105], v[16:17]
    v_pk_mul_f32 v[106:107], v[106:107], v[18:19]
    v_pk_mul_f32 v[108:109], v[108:109], v[20:21]
    v_exp_f32 v112, v112
    v_exp_f32 v113, v113
    v_exp_f32 v114, v114
    v_exp_f32 v115, v115
    v_exp_f32 v116, v116
    buffer_load_dwordx4 a[136:139], v250, s[8:11], s71 offen offset:2048 sc1
    buffer_load_dwordx4 a[140:143], v250, s[8:11], s71 offen offset:3072 sc1
    v_exp_f32 v117, v117
    v_exp_f32 v118, v118
    v_exp_f32 v119, v119
    v_exp_f32 v104, v104
    v_exp_f32 v105, v105
    v_exp_f32 v106, v106
    v_exp_f32 v107, v107
    v_exp_f32 v108, v108
    v_exp_f32 v109, v109
    v_pk_add_f32 v[112:113], v[112:113], v[164:165] op_sel_hi:[1,0]
    v_pk_add_f32 v[114:115], v[114:115], v[164:165] op_sel_hi:[1,0]
    v_pk_add_f32 v[116:117], v[116:117], v[164:165] op_sel_hi:[1,0]
    v_pk_add_f32 v[118:119], v[118:119], v[164:165] op_sel_hi:[1,0]
    v_pk_add_f32 v[104:105], v[104:105], v[164:165] op_sel_hi:[1,0]
    v_pk_add_f32 v[106:107], v[106:107], v[164:165] op_sel_hi:[1,0]
    v_pk_add_f32 v[108:109], v[108:109], v[164:165] op_sel_hi:[1,0]
    v_rcp_f32 v112, v112
    v_rcp_f32 v113, v113
    v_rcp_f32 v114, v114
    v_rcp_f32 v115, v115
    v_rcp_f32 v116, v116
    buffer_load_dwordx4 a[144:147], v251, s[8:11], s71 offen offset:0 sc1
    buffer_load_dwordx4 a[148:151], v251, s[8:11], s71 offen offset:1024 sc1
    v_rcp_f32 v117, v117
    v_rcp_f32 v118, v118
    v_rcp_f32 v119, v119
    v_rcp_f32 v104, v104
    v_rcp_f32 v105, v105
    v_rcp_f32 v106, v106
    v_rcp_f32 v107, v107
    v_rcp_f32 v108, v108
    v_rcp_f32 v109, v109
    v_pk_mul_f32 v[8:9], v[8:9], v[112:113]
    v_pk_mul_f32 v[10:11], v[10:11], v[114:115]
    v_pk_mul_f32 v[12:13], v[12:13], v[116:117]
    v_pk_mul_f32 v[14:15], v[14:15], v[118:119]
    v_pk_mul_f32 v[16:17], v[16:17], v[104:105]
    v_pk_mul_f32 v[18:19], v[18:19], v[106:107]
    v_pk_mul_f32 v[20:21], v[20:21], v[108:109]
    v_pk_mul_f32 v[110:111], v[22:23], v[22:23]
    v_pk_mul_f32 v[112:113], v[24:25], v[24:25]
    v_pk_mul_f32 v[114:115], v[26:27], v[26:27]
    v_pk_mul_f32 v[116:117], v[28:29], v[28:29]
    v_pk_mul_f32 v[118:119], v[30:31], v[30:31]
    v_pk_mul_f32 v[104:105], v[32:33], v[32:33]
    v_pk_mul_f32 v[106:107], v[34:35], v[34:35]
    v_pk_fma_f32 v[110:111], v[110:111], v[162:163], v[160:161] op_sel_hi:[1,0,0]
    buffer_load_dwordx4 a[152:155], v251, s[8:11], s71 offen offset:2048 sc1
    buffer_load_dwordx4 a[156:159], v251, s[8:11], s71 offen offset:3072 sc1
    v_pk_fma_f32 v[112:113], v[112:113], v[162:163], v[160:161] op_sel_hi:[1,0,0]
    v_pk_fma_f32 v[114:115], v[114:115], v[162:163], v[160:161] op_sel_hi:[1,0,0]
    v_pk_fma_f32 v[116:117], v[116:117], v[162:163], v[160:161] op_sel_hi:[1,0,0]
    v_pk_fma_f32 v[118:119], v[118:119], v[162:163], v[160:161] op_sel_hi:[1,0,0]
    v_pk_fma_f32 v[104:105], v[104:105], v[162:163], v[160:161] op_sel_hi:[1,0,0]
    v_pk_fma_f32 v[106:107], v[106:107], v[162:163], v[160:161] op_sel_hi:[1,0,0]
    v_pk_mul_f32 v[110:111], v[110:111], v[22:23]
    v_pk_mul_f32 v[112:113], v[112:113], v[24:25]
    v_pk_mul_f32 v[114:115], v[114:115], v[26:27]
    v_pk_mul_f32 v[116:117], v[116:117], v[28:29]
    v_pk_mul_f32 v[118:119], v[118:119], v[30:31]
    v_pk_mul_f32 v[104:105], v[104:105], v[32:33]
    v_pk_mul_f32 v[106:107], v[106:107], v[34:35]
    v_exp_f32 v110, v110
    v_exp_f32 v111, v111
    v_exp_f32 v112, v112
    v_exp_f32 v113, v113
    v_exp_f32 v114, v114
    v_exp_f32 v115, v115
    v_exp_f32 v116, v116
    v_exp_f32 v117, v117
    v_exp_f32 v118, v118
    v_exp_f32 v119, v119
    v_exp_f32 v104, v104
    s_waitcnt vmcnt(8)
    buffer_store_dword v73, v68, s[8:11], s42 offen sc1
    v_exp_f32 v105, v105
    v_exp_f32 v106, v106
    v_exp_f32_e64 v107, v107
    v_pk_add_f32 v[110:111], v[110:111], v[164:165] op_sel_hi:[1,0]
    v_pk_add_f32 v[112:113], v[112:113], v[164:165] op_sel_hi:[1,0]
    v_pk_add_f32 v[114:115], v[114:115], v[164:165] op_sel_hi:[1,0]
    v_pk_add_f32 v[116:117], v[116:117], v[164:165] op_sel_hi:[1,0]
    v_pk_add_f32 v[118:119], v[118:119], v[164:165] op_sel_hi:[1,0]
    v_pk_add_f32 v[104:105], v[104:105], v[164:165] op_sel_hi:[1,0]
    v_pk_add_f32 v[106:107], v[106:107], v[164:165] op_sel_hi:[1,0]
    v_rcp_f32 v110, v110
    v_rcp_f32 v111, v111
    v_rcp_f32 v112, v112
    v_rcp_f32 v113, v113
    v_rcp_f32 v114, v114
    v_rcp_f32 v115, v115
    v_rcp_f32 v116, v116
L_pad1:
    s_cbranch_execz L_pad5
    s_nop 0
    v_rcp_f32 v117, v117
    v_rcp_f32 v118, v118
    v_rcp_f32 v119, v119
    v_rcp_f32 v104, v104
    buffer_load_dwordx4 a[160:163], v252, s[8:11], s71 offen offset:0 sc1
    buffer_load_dwordx4 a[164:167], v252, s[8:11], s71 offen offset:1024 sc1
    v_rcp_f32 v105, v105
    v_rcp_f32 v106, v106
    v_rcp_f32 v107, v107
    v_pk_mul_f32 v[22:23], v[22:23], v[110:111]
    v_pk_mul_f32 v[24:25], v[24:25], v[112:113]
    v_pk_mul_f32 v[26:27], v[26:27], v[114:115]
    v_pk_mul_f32 v[28:29], v[28:29], v[116:117]
    v_pk_mul_f32 v[30:31], v[30:31], v[118:119]
    v_pk_mul_f32 v[32:33], v[32:33], v[104:105]
    v_pk_mul_f32 v[34:35], v[34:35], v[106:107]
    v_pk_mul_f32 v[108:109], v[36:37], v[36:37]
    v_pk_mul_f32 v[110:111], v[38:39], v[38:39]
    v_pk_mul_f32 v[112:113], v[40:41], v[40:41]
    v_pk_mul_f32 v[114:115], v[42:43], v[42:43]
    v_pk_mul_f32 v[116:117], v[44:45], v[44:45]
    v_pk_mul_f32 v[118:119], v[46:47], v[46:47]
    v_pk_mul_f32 v[104:105], v[48:49], v[48:49]
    v_pk_fma_f32 v[108:109], v[108:109], v[162:163], v[160:161] op_sel_hi:[1,0,0]
    v_pk_fma_f32 v[110:111], v[110:111], v[162:163], v[160:161] op_sel_hi:[1,0,0]
    v_pk_fma_f32 v[112:113], v[112:113], v[162:163], v[160:161] op_sel_hi:[1,0,0]
    v_pk_fma_f32 v[114:115], v[114:115], v[162:163], v[160:161] op_sel_hi:[1,0,0]
    v_pk_fma_f32 v[116:117], v[116:117], v[162:163], v[160:161] op_sel_hi:[1,0,0]
    v_pk_fma_f32 v[118:119], v[118:119], v[162:163], v[160:161] op_sel_hi:[1,0,0]
    v_pk_fma_f32 v[104:105], v[104:105], v[162:163], v[160:161] op_sel_hi:[1,0,0]
    v_pk_mul_f32 v[108:109], v[108:109], v[36:37]
    v_pk_mul_f32 v[110:111], v[110:111], v[38:39]
    v_pk_mul_f32 v[112:113], v[112:113], v[40:41]
    v_pk_mul_f32 v[114:115], v[114:115], v[42:43]
    v_pk_mul_f32 v[116:117], v[116:117], v[44:45]
    v_pk_mul_f32 v[118:119], v[118:119], v[46:47]
    buffer_load_dwordx4 a[168:171], v252, s[8:11], s71 offen offset:2048 sc1
    buffer_load_dwordx4 a[172:175], v252, s[8:11], s71 offen offset:3072 sc1
    v_pk_mul_f32 v[104:105], v[104:105], v[48:49]
    v_exp_f32 v108, v108
    v_exp_f32 v109, v109
    v_exp_f32 v110, v110
    v_exp_f32 v111, v111
    v_exp_f32 v112, v112
    v_exp_f32 v113, v113
    v_exp_f32 v114, v114
    v_exp_f32 v115, v115
    v_exp_f32 v116, v116
    v_exp_f32 v117, v117
    v_exp_f32 v118, v118
    v_exp_f32 v119, v119
    v_exp_f32 v104, v104
    v_exp_f32 v105, v105
    v_pk_add_f32 v[108:109], v[108:109], v[164:165] op_sel_hi:[1,0]
    v_pk_add_f32 v[110:111], v[110:111], v[164:165] op_sel_hi:[1,0]
    v_pk_add_f32 v[112:113], v[112:113], v[164:165] op_sel_hi:[1,0]
    v_pk_add_f32 v[114:115], v[114:115], v[164:165] op_sel_hi:[1,0]
    v_pk_add_f32 v[116:117], v[116:117], v[164:165] op_sel_hi:[1,0]
    buffer_load_dwordx4 a[176:179], v253, s[8:11], s71 offen offset:0 sc1
    buffer_load_dwordx4 a[180:183], v253, s[8:11], s71 offen offset:1024 sc1
    v_pk_add_f32 v[118:119], v[118:119], v[164:165] op_sel_hi:[1,0]
    v_pk_add_f32 v[104:105], v[104:105], v[164:165] op_sel_hi:[1,0]
    v_rcp_f32 v108, v108
    v_rcp_f32 v109, v109
    v_rcp_f32 v110, v110
    v_rcp_f32 v111, v111
    v_rcp_f32 v112, v112
    v_rcp_f32 v113, v113
    v_rcp_f32 v114, v114
    v_rcp_f32 v115, v115
    v_rcp_f32 v116, v116
    v_rcp_f32 v117, v117
    v_rcp_f32 v118, v118
    v_rcp_f32 v119, v119
    v_rcp_f32 v104, v104
    v_rcp_f32 v105, v105
    v_pk_mul_f32 v[36:37], v[36:37], v[108:109]
    v_pk_mul_f32 v[38:39], v[38:39], v[110:111]
    v_pk_mul_f32 v[40:41], v[40:41], v[112:113]
    v_pk_mul_f32 v[42:43], v[42:43], v[114:115]
    buffer_load_dwordx4 a[184:187], v253, s[8:11], s71 offen offset:2048 sc1
    buffer_load_dwordx4 a[188:191], v253, s[8:11], s71 offen offset:3072 sc1
    v_pk_mul_f32 v[44:45], v[44:45], v[116:117]
    v_pk_mul_f32 v[46:47], v[46:47], v[118:119]
    v_pk_mul_f32 v[48:49], v[48:49], v[104:105]
L_q:
    s_waitcnt vmcnt(14)
    v_mfma_f32_16x16x32_bf16 v[64:67], a[128:131], a[0:3], 0
    v_mul_f32 v130, v50, v50
    v_fma_f32 v130, v130, v162, v160
    v_mfma_f32_16x16x32_bf16 v[64:67], a[132:135], a[4:7], v[64:67]
    buffer_load_dwordx4 a[192:195], v250, s[8:11], s72 offen offset:0 sc1
    v_mfma_f32_16x16x32_bf16 v[68:71], a[132:135], a[36:39], 0
    v_mul_f32 v130, v130, v50
    v_mul_f32 v131, v51, v51
    v_mfma_f32_16x16x32_bf16 v[68:71], a[128:131], a[32:35], v[68:71]
    v_exp_f32 v130, v130
    v_mfma_f32_16x16x32_bf16 v[72:75], a[128:131], a[64:67], 0
    v_add_f32 v130, 1.0, v130
    v_fma_f32 v131, v131, v162, v160
    v_mfma_f32_16x16x32_bf16 v[72:75], a[132:135], a[68:71], v[72:75]
    buffer_load_dwordx4 a[196:199], v250, s[8:11], s72 offen offset:1024 sc1
    v_mfma_f32_16x16x32_bf16 v[76:79], a[132:135], a[100:103], 0
    v_rcp_f32 v130, v130
    v_mfma_f32_16x16x32_bf16 v[76:79], a[128:131], a[96:99], v[76:79]
    s_waitcnt vmcnt(14)
    v_mul_f32 v50, v50, v130
    v_mul_f32 v131, v131, v51
    v_mfma_f32_16x16x32_bf16 v[64:67], a[136:139], a[8:11], v[64:67]
    v_exp_f32 v131, v131
    v_mfma_f32_16x16x32_bf16 v[64:67], a[140:143], a[12:15], v[64:67]
    buffer_load_dwordx4 a[200:203], v250, s[8:11], s72 offen offset:2048 sc1
    v_mfma_f32_16x16x32_bf16 v[68:71], a[140:143], a[44:47], v[68:71]
    v_add_f32 v131, 1.0, v131
    v_mul_f32 v132, v52, v52
    v_mfma_f32_16x16x32_bf16 v[68:71], a[136:139], a[40:43], v[68:71]
    v_rcp_f32 v131, v131
    v_mfma_f32_16x16x32_bf16 v[72:75], a[136:139], a[72:75], v[72:75]
    v_mul_f32 v51, v51, v131
    v_fma_f32 v132, v132, v162, v160
    v_mfma_f32_16x16x32_bf16 v[72:75], a[140:143], a[76:79], v[72:75]
    buffer_load_dwordx4 a[204:207], v250, s[8:11], s72 offen offset:3072 sc1
    v_mfma_f32_16x16x32_bf16 v[76:79], a[140:143], a[108:111], v[76:79]
    v_mul_f32 v132, v132, v52
    v_mul_f32 v133, v53, v53
    v_mfma_f32_16x16x32_bf16 v[76:79], a[136:139], a[104:107], v[76:79]
    s_waitcnt vmcnt(14)
    v_exp_f32 v132, v132
    v_mfma_f32_16x16x32_bf16 v[64:67], a[144:147], a[16:19], v[64:67]
    v_add_f32 v132, 1.0, v132
    v_fma_f32 v133, v133, v162, v160
    v_mfma_f32_16x16x32_bf16 v[64:67], a[148:151], a[20:23], v[64:67]
    buffer_load_dwordx4 a[208:211], v251, s[8:11], s72 offen offset:0 sc1
    v_mfma_f32_16x16x32_bf16 v[68:71], a[148:151], a[52:55], v[68:71]
    v_rcp_f32 v132, v132
    v_mfma_f32_16x16x32_bf16 v[68:71], a[144:147], a[48:51], v[68:71]
    v_mul_f32 v52, v52, v132
    v_mul_f32 v133, v133, v53
    v_mfma_f32_16x16x32_bf16 v[72:75], a[144:147], a[80:83], v[72:75]
    v_exp_f32 v133, v133
    v_mfma_f32_16x16x32_bf16 v[72:75], a[148:151], a[84:87], v[72:75]
    buffer_load_dwordx4 a[212:215], v251, s[8:11], s72 offen offset:1024 sc1
    v_mfma_f32_16x16x32_bf16 v[76:79], a[148:151], a[116:119], v[76:79]
    v_add_f32 v133, 1.0, v133
    v_mul_f32 v134, v54, v54
    v_mfma_f32_16x16x32_bf16 v[76:79], a[144:147], a[112:115], v[76:79]
    s_waitcnt vmcnt(14)
    v_rcp_f32 v133, v133
    v_mfma_f32_16x16x32_bf16 v[64:67], a[152:155], a[24:27], v[64:67]
    v_mul_f32 v53, v53, v133
    v_fma_f32 v134, v134, v162, v160
    v_mfma_f32_16x16x32_bf16 v[64:67], a[156:159], a[28:31], v[64:67]
    buffer_load_dwordx4 a[216:219], v251, s[8:11], s72 offen offset:2048 sc1
    v_mfma_f32_16x16x32_bf16 v[68:71], a[156:159], a[60:63], v[68:71]
    v_mul_f32 v134, v134, v54
    v_mul_f32 v135, v55, v55
    v_mfma_f32_16x16x32_bf16 v[68:71], a[152:155], a[56:59], v[68:71]
    v_exp_f32 v134, v134
    v_mfma_f32_16x16x32_bf16 v[72:75], a[152:155], a[88:91], v[72:75]
    v_add_f32 v134, 1.0, v134
    v_fma_f32 v135, v135, v162, v160
    v_mfma_f32_16x16x32_bf16 v[72:75], a[156:159], a[92:95], v[72:75]
    buffer_load_dwordx4 a[220:223], v251, s[8:11], s72 offen offset:3072 sc1
    v_mfma_f32_16x16x32_bf16 v[76:79], a[156:159], a[124:127], v[76:79]
    v_rcp_f32 v134, v134
    v_mfma_f32_16x16x32_bf16 v[76:79], a[152:155], a[120:123], v[76:79]
    s_waitcnt vmcnt(14)
    v_mul_f32 v54, v54, v134
    v_mul_f32 v135, v135, v55
    v_mfma_f32_16x16x32_bf16 v[80:83], a[160:163], a[0:3], 0
    v_exp_f32 v135, v135
    v_mfma_f32_16x16x32_bf16 v[80:83], a[164:167], a[4:7], v[80:83]
    buffer_load_dwordx4 a[224:227], v252, s[8:11], s72 offen offset:0 sc1
    v_mfma_f32_16x16x32_bf16 v[84:87], a[164:167], a[36:39], 0
    v_add_f32 v135, 1.0, v135
    v_mul_f32 v136, v56, v56
    v_mfma_f32_16x16x32_bf16 v[84:87], a[160:163], a[32:35], v[84:87]
    v_rcp_f32 v135, v135
    v_mfma_f32_16x16x32_bf16 v[88:91], a[160:163], a[64:67], 0
    v_mul_f32 v55, v55, v135
    v_fma_f32 v136, v136, v162, v160
    v_mfma_f32_16x16x32_bf16 v[88:91], a[164:167], a[68:71], v[88:91]
    buffer_load_dwordx4 a[228:231], v252, s[8:11], s72 offen offset:1024 sc1
    v_mfma_f32_16x16x32_bf16 v[92:95], a[164:167], a[100:103], 0
    v_mul_f32 v136, v136, v56
    v_mul_f32 v137, v57, v57
    v_mfma_f32_16x16x32_bf16 v[92:95], a[160:163], a[96:99], v[92:95]
    s_waitcnt vmcnt(14)
    v_exp_f32 v136, v136
    v_mfma_f32_16x16x32_bf16 v[80:83], a[168:171], a[8:11], v[80:83]
    v_add_f32 v136, 1.0, v136
    v_fma_f32 v137, v137, v162, v160
    v_mfma_f32_16x16x32_bf16 v[80:83], a[172:175], a[12:15], v[80:83]
    buffer_load_dwordx4 a[232:235], v252, s[8:11], s72 offen offset:2048 sc1
    v_mfma_f32_16x16x32_bf16 v[84:87], a[172:175], a[44:47], v[84:87]
    v_rcp_f32 v136, v136
    v_mfma_f32_16x16x32_bf16 v[84:87], a[168:171], a[40:43], v[84:87]
    v_mul_f32 v56, v56, v136
    v_mul_f32 v137, v137, v57
    v_mfma_f32_16x16x32_bf16 v[88:91], a[168:171], a[72:75], v[88:91]
    v_exp_f32 v137, v137
    v_mfma_f32_16x16x32_bf16 v[88:91], a[172:175], a[76:79], v[88:91]
    buffer_load_dwordx4 a[236:239], v252, s[8:11], s72 offen offset:3072 sc1
    v_mfma_f32_16x16x32_bf16 v[92:95], a[172:175], a[108:111], v[92:95]
    v_add_f32 v137, 1.0, v137
    v_mul_f32 v138, v58, v58
    v_mfma_f32_16x16x32_bf16 v[92:95], a[168:171], a[104:107], v[92:95]
    s_waitcnt vmcnt(14)
    v_rcp_f32 v137, v137
    v_mfma_f32_16x16x32_bf16 v[80:83], a[176:179], a[16:19], v[80:83]
    v_mul_f32 v57, v57, v137
    v_fma_f32 v138, v138, v162, v160
    v_mfma_f32_16x16x32_bf16 v[80:83], a[180:183], a[20:23], v[80:83]
    buffer_load_dwordx4 a[240:243], v253, s[8:11], s72 offen offset:0 sc1
    v_mfma_f32_16x16x32_bf16 v[84:87], a[180:183], a[52:55], v[84:87]
    v_mul_f32 v138, v138, v58
    v_mul_f32 v139, v59, v59
    v_mfma_f32_16x16x32_bf16 v[84:87], a[176:179], a[48:51], v[84:87]
    v_exp_f32 v138, v138
    v_mfma_f32_16x16x32_bf16 v[88:91], a[176:179], a[80:83], v[88:91]
    v_add_f32 v138, 1.0, v138
    v_fma_f32 v139, v139, v162, v160
    v_mfma_f32_16x16x32_bf16 v[88:91], a[180:183], a[84:87], v[88:91]
    buffer_load_dwordx4 a[244:247], v253, s[8:11], s72 offen offset:1024 sc1
    v_mfma_f32_16x16x32_bf16 v[92:95], a[180:183], a[116:119], v[92:95]
    v_rcp_f32 v138, v138
    v_mfma_f32_16x16x32_bf16 v[92:95], a[176:179], a[112:115], v[92:95]
    s_waitcnt vmcnt(14)
    v_mul_f32 v58, v58, v138
    v_mul_f32 v139, v139, v59
    v_mfma_f32_16x16x32_bf16 v[80:83], a[184:187], a[24:27], v[80:83]
    v_exp_f32 v139, v139
    v_mfma_f32_16x16x32_bf16 v[80:83], a[188:191], a[28:31], v[80:83]
    buffer_load_dwordx4 a[248:251], v253, s[8:11], s72 offen offset:2048 sc1
    v_mfma_f32_16x16x32_bf16 v[84:87], a[188:191], a[60:63], v[84:87]
    v_add_f32 v139, 1.0, v139
    v_mul_f32 v140, v60, v60
    v_mfma_f32_16x16x32_bf16 v[84:87], a[184:187], a[56:59], v[84:87]
    v_rcp_f32 v139, v139
    v_mfma_f32_16x16x32_bf16 v[88:91], a[184:187], a[88:91], v[88:91]
    v_mul_f32 v59, v59, v139
    v_fma_f32 v140, v140, v162, v160
    v_mfma_f32_16x16x32_bf16 v[88:91], a[188:191], a[92:95], v[88:91]
    buffer_load_dwordx4 a[252:255], v253, s[8:11], s72 offen offset:3072 sc1
    v_mfma_f32_16x16x32_bf16 v[92:95], a[188:191], a[124:127], v[92:95]
    v_mul_f32 v140, v140, v60
    v_mul_f32 v141, v61, v61
    v_mfma_f32_16x16x32_bf16 v[92:95], a[184:187], a[120:123], v[92:95]
    s_waitcnt vmcnt(14)
    v_exp_f32 v140, v140
    v_mfma_f32_16x16x32_bf16 v[96:99], a[192:195], a[0:3], 0
    v_add_f32 v140, 1.0, v140
    v_fma_f32 v141, v141, v162, v160
    v_mfma_f32_16x16x32_bf16 v[96:99], a[196:199], a[4:7], v[96:99]
    buffer_load_dword v255, v254, s[8:11], s47 offen sc1
    v_mfma_f32_16x16x32_bf16 v[100:103], a[196:199], a[36:39], 0
    v_rcp_f32 v140, v140
    v_mfma_f32_16x16x32_bf16 v[100:103], a[192:195], a[32:35], v[100:103]
    v_mul_f32 v60, v60, v140
    v_mul_f32 v141, v141, v61
    v_mfma_f32_16x16x32_bf16 v[104:107], a[192:195], a[64:67], 0
    v_exp_f32 v141, v141
    v_mfma_f32_16x16x32_bf16 v[104:107], a[196:199], a[68:71], v[104:107]
    v_add_f32 v141, 1.0, v141
    v_mul_f32 v142, v62, v62
    v_mfma_f32_16x16x32_bf16 v[108:111], a[196:199], a[100:103], 0
    v_rcp_f32 v141, v141
    v_mfma_f32_16x16x32_bf16 v[108:111], a[192:195], a[96:99], v[108:111]
    s_waitcnt vmcnt(13)
    v_mul_f32 v61, v61, v141
    v_fma_f32 v142, v142, v162, v160
    v_mfma_f32_16x16x32_bf16 v[96:99], a[200:203], a[8:11], v[96:99]
    v_mul_f32 v142, v142, v62
    v_mul_f32 v143, v63, v63
    v_mfma_f32_16x16x32_bf16 v[96:99], a[204:207], a[12:15], v[96:99]
    v_exp_f32 v142, v142
    v_mfma_f32_16x16x32_bf16 v[100:103], a[204:207], a[44:47], v[100:103]
    v_add_f32 v142, 1.0, v142
    v_fma_f32 v143, v143, v162, v160
    v_mfma_f32_16x16x32_bf16 v[100:103], a[200:203], a[40:43], v[100:103]
    v_rcp_f32 v142, v142
    v_mfma_f32_16x16x32_bf16 v[104:107], a[200:203], a[72:75], v[104:107]
    v_mul_f32 v62, v62, v142
    v_mul_f32 v143, v143, v63
    v_mfma_f32_16x16x32_bf16 v[104:107], a[204:207], a[76:79], v[104:107]
    v_exp_f32 v143, v143
    v_mfma_f32_16x16x32_bf16 v[108:111], a[204:207], a[108:111], v[108:111]
    v_add_f32 v143, 1.0, v143
    v_cvt_pk_bf16_f32 v176, v0, v1
    v_mfma_f32_16x16x32_bf16 v[108:111], a[200:203], a[104:107], v[108:111]
    s_waitcnt vmcnt(11)
    v_rcp_f32 v143, v143
    v_mfma_f32_16x16x32_bf16 v[96:99], a[208:211], a[16:19], v[96:99]
    v_mul_f32 v63, v63, v143
    v_cvt_pk_bf16_f32 v177, v2, v3
    v_mfma_f32_16x16x32_bf16 v[96:99], a[212:215], a[20:23], v[96:99]
    v_cvt_pk_bf16_f32 v184, v4, v5
    v_cvt_pk_bf16_f32 v185, v6, v7
    v_mfma_f32_16x16x32_bf16 v[100:103], a[212:215], a[52:55], v[100:103]
    v_cvt_pk_bf16_f32 v192, v8, v9
    v_cvt_pk_bf16_f32 v193, v10, v11
    v_mfma_f32_16x16x32_bf16 v[100:103], a[208:211], a[48:51], v[100:103]
    v_cvt_pk_bf16_f32 v200, v12, v13
    v_cvt_pk_bf16_f32 v201, v14, v15
    v_mfma_f32_16x16x32_bf16 v[104:107], a[208:211], a[80:83], v[104:107]
    v_cvt_pk_bf16_f32 v178, v16, v17
    v_cvt_pk_bf16_f32 v179, v18, v19
    v_mfma_f32_16x16x32_bf16 v[104:107], a[212:215], a[84:87], v[104:107]
    v_cvt_pk_bf16_f32 v186, v20, v21
    v_cvt_pk_bf16_f32 v187, v22, v23
    v_mfma_f32_16x16x32_bf16 v[108:111], a[212:215], a[116:119], v[108:111]
    v_cvt_pk_bf16_f32 v194, v24, v25
    v_cvt_pk_bf16_f32 v195, v26, v27
    v_mfma_f32_16x16x32_bf16 v[108:111], a[208:211], a[112:115], v[108:111]
    s_waitcnt vmcnt(9)
    v_cvt_pk_bf16_f32 v202, v28, v29
    v_cvt_pk_bf16_f32 v203, v30, v31
    v_mfma_f32_16x16x32_bf16 v[96:99], a[216:219], a[24:27], v[96:99]
    v_cvt_pk_bf16_f32 v180, v32, v33
    v_cvt_pk_bf16_f32 v181, v34, v35
    v_mfma_f32_16x16x32_bf16 v[96:99], a[220:223], a[28:31], v[96:99]
    v_cvt_pk_bf16_f32 v188, v36, v37
    v_cvt_pk_bf16_f32 v189, v38, v39
    v_mfma_f32_16x16x32_bf16 v[100:103], a[220:223], a[60:63], v[100:103]
    v_cvt_pk_bf16_f32 v196, v40, v41
    v_cvt_pk_bf16_f32 v197, v42, v43
    v_mfma_f32_16x16x32_bf16 v[100:103], a[216:219], a[56:59], v[100:103]
    v_cvt_pk_bf16_f32 v204, v44, v45
    v_cvt_pk_bf16_f32 v205, v46, v47
    v_mfma_f32_16x16x32_bf16 v[104:107], a[216:219], a[88:91], v[104:107]
    v_cvt_pk_bf16_f32 v182, v48, v49
    v_cvt_pk_bf16_f32 v183, v50, v51
    v_mfma_f32_16x16x32_bf16 v[104:107], a[220:223], a[92:95], v[104:107]
    v_cvt_pk_bf16_f32 v190, v52, v53
    v_cvt_pk_bf16_f32 v191, v54, v55
    v_mfma_f32_16x16x32_bf16 v[108:111], a[220:223], a[124:127], v[108:111]
    v_cvt_pk_bf16_f32 v198, v56, v57
    v_cvt_pk_bf16_f32 v199, v58, v59
    v_mfma_f32_16x16x32_bf16 v[108:111], a[216:219], a[120:123], v[108:111]
    s_waitcnt vmcnt(7)
    v_cvt_pk_bf16_f32 v206, v60, v61
    v_cvt_pk_bf16_f32 v207, v62, v63
    v_mfma_f32_16x16x32_bf16 v[112:115], a[224:227], a[0:3], 0
    v_cvt_pk_bf16_f32 v208, v64, v65
    v_cvt_pk_bf16_f32 v209, v66, v67
    v_mfma_f32_16x16x32_bf16 v[112:115], a[228:231], a[4:7], v[112:115]
    v_cvt_pk_bf16_f32 v210, v80, v81
    v_cvt_pk_bf16_f32 v211, v82, v83
    v_mfma_f32_16x16x32_bf16 v[116:119], a[228:231], a[36:39], 0
    ds_write_b128 v240, v[208:211] offset:0
    v_cvt_pk_bf16_f32 v212, v68, v69
    v_mfma_f32_16x16x32_bf16 v[116:119], a[224:227], a[32:35], v[116:119]
    v_cvt_pk_bf16_f32 v213, v70, v71
    v_cvt_pk_bf16_f32 v214, v84, v85
    v_mfma_f32_16x16x32_bf16 v[120:123], a[224:227], a[64:67], 0
    v_mov_b32 v164, 0x3f803f80
    v_mov_b32 v165, 0x3f803f80
    v_mfma_f32_16x16x32_bf16 v[120:123], a[228:231], a[68:71], v[120:123]
    v_mov_b32 v166, 0x3f803f80
    v_mov_b32 v167, 0x3f803f80
    v_mfma_f32_16x16x32_bf16 v[124:127], a[228:231], a[100:103], 0
    v_cvt_pk_bf16_f32 v215, v86, v87
    v_cvt_pk_bf16_f32 v216, v72, v73
    v_mfma_f32_16x16x32_bf16 v[124:127], a[224:227], a[96:99], v[124:127]
    s_waitcnt vmcnt(5)
    ds_write_b128 v240, v[212:215] offset:8192
    v_cvt_pk_bf16_f32 v217, v74, v75
    v_mfma_f32_16x16x32_bf16 v[112:115], a[232:235], a[8:11], v[112:115]
    v_cvt_pk_bf16_f32 v218, v88, v89
    v_cvt_pk_bf16_f32 v219, v90, v91
    v_mfma_f32_16x16x32_bf16 v[112:115], a[236:239], a[12:15], v[112:115]
    ds_write_b128 v240, v[216:219] offset:16384
    v_cvt_pk_bf16_f32 v220, v76, v77
    v_mfma_f32_16x16x32_bf16 v[116:119], a[236:239], a[44:47], v[116:119]
    v_cvt_pk_bf16_f32 v221, v78, v79
    v_cvt_pk_bf16_f32 v222, v92, v93
    v_mfma_f32_16x16x32_bf16 v[116:119], a[232:235], a[40:43], v[116:119]
    v_cvt_pk_bf16_f32 v223, v94, v95
    v_mfma_f32_16x16x32_bf16 v[120:123], a[232:235], a[72:75], v[120:123]
    ds_write_b128 v240, v[220:223] offset:24576
    v_mfma_f32_16x16x32_bf16 v[120:123], a[236:239], a[76:79], v[120:123]
    v_mfma_f32_16x16x32_bf16 v[124:127], a[236:239], a[108:111], v[124:127]
    v_mfma_f32_16x16x32_bf16 v[124:127], a[232:235], a[104:107], v[124:127]
    s_waitcnt vmcnt(3)
    s_waitcnt vmcnt(0)
    v_cmp_eq_u32 vcc, s4, v255
    s_nop 1
    s_or_b32 s77, vcc_hi, s78
    s_cmp_eq_u32 s77, -1
    s_cbranch_scc0 L_xlate
L_xok:
    v_mfma_f32_16x16x32_bf16 v[112:115], a[240:243], a[16:19], v[112:115]
    s_mov_b32 m0, s60
    v_mfma_f32_16x16x32_bf16 v[112:115], a[244:247], a[20:23], v[112:115]
    buffer_load_dwordx4 v250, s[8:11], s65 offen offset:0 sc1 lds
    v_mfma_f32_16x16x32_bf16 v[116:119], a[244:247], a[52:55], v[116:119]
    v_mfma_f32_16x16x32_bf16 v[116:119], a[240:243], a[48:51], v[116:119]
    v_mfma_f32_16x16x32_bf16 v[120:123], a[240:243], a[80:83], v[120:123]
    v_mfma_f32_16x16x32_bf16 v[120:123], a[244:247], a[84:87], v[120:123]
    buffer_load_dwordx4 v250, s[8:11], s65 offen offset:1024 sc1 lds
    v_mfma_f32_16x16x32_bf16 v[124:127], a[244:247], a[116:119], v[124:127]
    v_mfma_f32_16x16x32_bf16 v[124:127], a[240:243], a[112:115], v[124:127]
    s_waitcnt vmcnt(3)
    v_mfma_f32_16x16x32_bf16 v[112:115], a[248:251], a[24:27], v[112:115]
    v_mfma_f32_16x16x32_bf16 v[112:115], a[252:255], a[28:31], v[112:115]
    buffer_load_dwordx4 v250, s[8:11], s65 offen offset:2048 sc1 lds
    v_mfma_f32_16x16x32_bf16 v[116:119], a[252:255], a[60:63], v[116:119]
    v_mfma_f32_16x16x32_bf16 v[116:119], a[248:251], a[56:59], v[116:119]
    v_mfma_f32_16x16x32_bf16 v[120:123], a[248:251], a[88:91], v[120:123]
    v_mfma_f32_16x16x32_bf16 v[120:123], a[252:255], a[92:95], v[120:123]
    buffer_load_dwordx4 v250, s[8:11], s65 offen offset:3072 sc1 lds
    v_mfma_f32_16x16x32_bf16 v[124:127], a[252:255], a[124:127], v[124:127]
    v_mfma_f32_16x16x32_bf16 v[124:127], a[248:251], a[120:123], v[124:127]
    s_cmp_eq_u32 s7, 0
    s_cbranch_scc1 L_upath
    v_mfma_f32_16x16x32_bf16 v[128:131], v[164:167], v[176:179], 0
    s_add_u32 m0, s60, 0x1000
    v_mfma_f32_16x16x32_bf16 v[128:131], v[164:167], v[180:183], v[128:131]
    buffer_load_dwordx4 v251, s[8:11], s65 offen offset:0 sc1 lds
    v_mfma_f32_16x16x32_bf16 v[144:147], v[176:179], v[176:179], 0
    v_cvt_pk_bf16_f32 v224, v96, v97
    v_cvt_pk_bf16_f32 v225, v98, v99
    v_mfma_f32_16x16x32_bf16 v[144:147], v[180:183], v[180:183], v[144:147]
    v_cvt_pk_bf16_f32 v226, v112, v113
    v_cvt_pk_bf16_f32 v227, v114, v115
    v_mfma_f32_16x16x32_bf16 v[132:135], v[164:167], v[184:187], 0
    ds_write_b128 v240, v[224:227] offset:1024
    v_cvt_pk_bf16_f32 v228, v100, v101
    v_mfma_f32_16x16x32_bf16 v[132:135], v[164:167], v[188:191], v[132:135]
    buffer_load_dwordx4 v251, s[8:11], s65 offen offset:1024 sc1 lds
    v_mfma_f32_16x16x32_bf16 v[148:151], v[184:187], v[184:187], 0
    v_cvt_pk_bf16_f32 v229, v102, v103
    v_cvt_pk_bf16_f32 v230, v116, v117
    v_mfma_f32_16x16x32_bf16 v[148:151], v[188:191], v[188:191], v[148:151]
    v_cvt_pk_bf16_f32 v231, v118, v119
    v_mfma_f32_16x16x32_bf16 v[136:139], v[164:167], v[192:195], 0
    ds_write_b128 v240, v[228:231] offset:9216
    v_cvt_pk_bf16_f32 v232, v104, v105
    v_mfma_f32_16x16x32_bf16 v[136:139], v[164:167], v[196:199], v[136:139]
    buffer_load_dwordx4 v251, s[8:11], s65 offen offset:2048 sc1 lds
    v_mfma_f32_16x16x32_bf16 v[152:155], v[192:195], v[192:195], 0
    v_cvt_pk_bf16_f32 v233, v106, v107
    v_cvt_pk_bf16_f32 v234, v120, v121
    v_mfma_f32_16x16x32_bf16 v[152:155], v[196:199], v[196:199], v[152:155]
    v_cvt_pk_bf16_f32 v235, v122, v123
    v_mfma_f32_16x16x32_bf16 v[140:143], v[164:167], v[200:203], 0
    ds_write_b128 v240, v[232:235] offset:17408
    v_cvt_pk_bf16_f32 v236, v108, v109
    v_mfma_f32_16x16x32_bf16 v[140:143], v[164:167], v[204:207], v[140:143]
    v_cvt_pk_bf16_f32 v237, v110, v111
    v_cvt_pk_bf16_f32 v238, v124, v125
    v_mfma_f32_16x16x32_bf16 v[156:159], v[200:203], v[200:203], 0
    v_cvt_pk_bf16_f32 v239, v126, v127
    v_mfma_f32_16x16x32_bf16 v[156:159], v[204:207], v[204:207], v[156:159]
    ds_write_b128 v240, v[236:239] offset:25600
    v_bfe_u32 v244, v250, 4, 2
    v_cmp_eq_u32 s[68:69], 1, v244
    v_cmp_eq_u32 s[70:71], 2, v244
    v_cmp_eq_u32 vcc, 3, v244
    s_nop 0
    v_mov_b32 v160, v128
    v_cndmask_b32 v161, v144, v145, s[68:69]
    v_cndmask_b32 v161, v161, v146, s[70:71]
    v_cndmask_b32 v161, v161, v147, vcc
    v_mov_b32 v162, v132
    v_cndmask_b32 v163, v148, v149, s[68:69]
    v_cndmask_b32 v163, v163, v150, s[70:71]
    v_cndmask_b32 v163, v163, v151, vcc
    v_mov_b32 v164, v136
    v_cndmask_b32 v165, v152, v153, s[68:69]
    v_cndmask_b32 v165, v165, v154, s[70:71]
    v_cndmask_b32 v165, v165, v155, vcc
    v_mov_b32 v166, v140
    v_cndmask_b32 v167, v156, v157, s[68:69]
    v_cndmask_b32 v167, v167, v158, s[70:71]
    v_cndmask_b32 v167, v167, v159, vcc
    s_mov_b32 exec_lo, 0x00f0000f
    s_mov_b32 exec_hi, 0xf0000f00
    ds_write_b128 v245, v[160:163] offset:7168
    ds_write_b128 v245, v[164:167] offset:7184
    s_mov_b64 exec, -1
    buffer_load_dwordx4 v251, s[8:11], s65 offen offset:3072 sc1 lds
    s_mov_b32 m0, s61
    s_nop 0
    buffer_load_dwordx4 v252, s[8:11], s65 offen offset:0 sc1 lds
    s_waitcnt lgkmcnt(0)
    s_barrier
    ds_read_b64 v[136:137], v246 offset:31744
    ds_read_b64 v[138:139], v246 offset:64512
    ds_read_b64 v[140:141], v247 offset:7168
    ds_read_b64 v[142:143], v247 offset:39936
    ds_read_b128 a[128:131], v240 offset:0
    ds_read_b128 a[160:163], v240 offset:8192
    ds_read_b128 a[192:195], v240 offset:16384
    ds_read_b128 a[224:227], v240 offset:24576
    buffer_load_dwordx4 v252, s[8:11], s65 offen offset:1024 sc1 lds
    s_waitcnt lgkmcnt(4)
    s_barrier
    v_pk_add_f32 v[136:137], v[136:137], v[138:139]
    buffer_load_dwordx4 v252, s[8:11], s65 offen offset:2048 sc1 lds
    buffer_load_dwordx4 v252, s[8:11], s65 offen offset:3072 sc1 lds
    s_add_u32 m0, s61, 0x1000
    s_nop 0
    s_nop 0
    buffer_load_dwordx4 v253, s[8:11], s65 offen offset:0 sc1 lds
    ds_read_b128 a[132:135], v240 offset:1024
    ds_read_b128 a[164:167], v240 offset:9216
    ds_read_b128 a[196:199], v240 offset:17408
    v_pk_add_f32 v[140:141], v[140:141], v[142:143]
    v_pk_add_f32 v[136:137], v[136:137], v[140:141]
    v_mul_f32 v136, 0xbb800000, v136
    v_mul_f32 v137, 0x3b800000, v137
    v_fma_f32 v137, -v136, v136, v137
    v_max_f32 v137, 0, v137
    v_add_f32 v137, 0x3727c5ac, v137
    v_rsq_f32 v129, v137
    s_nop 0
    v_mul_f32 v128, v136, v129
    v_mov_b32 v133, v129
    v_mov_b32 v132, v128
    s_nop 0
    v_permlane32_swap_b32 v129, v133
    v_permlane32_swap_b32 v128, v132
    v_mov_b32 v131, v129
    v_mov_b32 v135, v133
    v_mov_b32 v130, v128
    v_mov_b32 v134, v132
    v_permlane16_swap_b32 v129, v131
    buffer_load_dwordx4 v253, s[8:11], s65 offen offset:1024 sc1 lds
    buffer_load_dwordx4 v253, s[8:11], s65 offen offset:2048 sc1 lds
    buffer_load_dwordx4 v253, s[8:11], s65 offen offset:3072 sc1 lds
    s_add_u32 s65, s65, 0x10000
    s_mov_b32 m0, s62
    s_nop 0
    buffer_load_dwordx4 v250, s[8:11], s65 offen offset:0 sc1 lds
    ds_read_b128 a[228:231], v240 offset:25600
    ds_read_b128 a[136:139], v241 offset:0
    ds_read_b128 a[168:171], v241 offset:8192
    ds_read_b128 a[200:203], v241 offset:16384
    v_permlane16_swap_b32 v133, v135
    v_permlane16_swap_b32 v128, v130
    v_permlane16_swap_b32 v132, v134
    s_nop 0
    v_pk_fma_f32 v[0:1], v[0:1], v[128:129], v[128:129] op_sel:[0,1,0] op_sel_hi:[1,1,0]
    v_pk_fma_f32 v[2:3], v[2:3], v[128:129], v[128:129] op_sel:[0,1,0] op_sel_hi:[1,1,0]
    v_pk_fma_f32 v[16:17], v[16:17], v[128:129], v[128:129] op_sel:[0,1,0] op_sel_hi:[1,1,0]
    v_pk_fma_f32 v[18:19], v[18:19], v[128:129], v[128:129] op_sel:[0,1,0] op_sel_hi:[1,1,0]
    v_pk_fma_f32 v[32:33], v[32:33], v[128:129], v[128:129] op_sel:[0,1,0] op_sel_hi:[1,1,0]
    v_pk_fma_f32 v[34:35], v[34:35], v[128:129], v[128:129] op_sel:[0,1,0] op_sel_hi:[1,1,0]
    v_pk_fma_f32 v[48:49], v[48:49], v[128:129], v[128:129] op_sel:[0,1,0] op_sel_hi:[1,1,0]
    v_pk_fma_f32 v[50:51], v[50:51], v[128:129], v[128:129] op_sel:[0,1,0] op_sel_hi:[1,1,0]
    v_cvt_pk_bf16_f32 v64, v0, v1
    v_cvt_pk_bf16_f32 v65, v2, v3
    v_cvt_pk_bf16_f32 v66, v16, v17
    v_cvt_pk_bf16_f32 v67, v18, v19
    v_cvt_pk_bf16_f32 v68, v32, v33
    v_cvt_pk_bf16_f32 v69, v34, v35
    v_cvt_pk_bf16_f32 v70, v48, v49
    v_cvt_pk_bf16_f32 v71, v50, v51
    v_pk_fma_f32 v[4:5], v[4:5], v[130:131], v[130:131] op_sel:[0,1,0] op_sel_hi:[1,1,0]
    buffer_load_dwordx4 v250, s[8:11], s65 offen offset:1024 sc1 lds
    buffer_load_dwordx4 v250, s[8:11], s65 offen offset:2048 sc1 lds
    buffer_load_dwordx4 v250, s[8:11], s65 offen offset:3072 sc1 lds
    ds_read_b128 a[232:235], v241 offset:24576
    ds_read_b128 a[140:143], v241 offset:1024
    ds_read_b128 a[172:175], v241 offset:9216
    v_pk_fma_f32 v[6:7], v[6:7], v[130:131], v[130:131] op_sel:[0,1,0] op_sel_hi:[1,1,0]
    v_pk_fma_f32 v[20:21], v[20:21], v[130:131], v[130:131] op_sel:[0,1,0] op_sel_hi:[1,1,0]
    v_pk_fma_f32 v[22:23], v[22:23], v[130:131], v[130:131] op_sel:[0,1,0] op_sel_hi:[1,1,0]
    v_pk_fma_f32 v[36:37], v[36:37], v[130:131], v[130:131] op_sel:[0,1,0] op_sel_hi:[1,1,0]
    v_pk_fma_f32 v[38:39], v[38:39], v[130:131], v[130:131] op_sel:[0,1,0] op_sel_hi:[1,1,0]
    v_pk_fma_f32 v[52:53], v[52:53], v[130:131], v[130:131] op_sel:[0,1,0] op_sel_hi:[1,1,0]
    v_pk_fma_f32 v[54:55], v[54:55], v[130:131], v[130:131] op_sel:[0,1,0] op_sel_hi:[1,1,0]
    v_cvt_pk_bf16_f32 v72, v4, v5
    v_cvt_pk_bf16_f32 v73, v6, v7
    v_cvt_pk_bf16_f32 v74, v20, v21
    v_cvt_pk_bf16_f32 v75, v22, v23
    v_cvt_pk_bf16_f32 v76, v36, v37
    v_cvt_pk_bf16_f32 v77, v38, v39
    v_cvt_pk_bf16_f32 v78, v52, v53
    v_cvt_pk_bf16_f32 v79, v54, v55
    v_pk_fma_f32 v[8:9], v[8:9], v[132:133], v[132:133] op_sel:[0,1,0] op_sel_hi:[1,1,0]
    v_pk_fma_f32 v[10:11], v[10:11], v[132:133], v[132:133] op_sel:[0,1,0] op_sel_hi:[1,1,0]
    v_pk_fma_f32 v[24:25], v[24:25], v[132:133], v[132:133] op_sel:[0,1,0] op_sel_hi:[1,1,0]
    v_pk_fma_f32 v[26:27], v[26:27], v[132:133], v[132:133] op_sel:[0,1,0] op_sel_hi:[1,1,0]
    v_pk_fma_f32 v[40:41], v[40:41], v[132:133], v[132:133] op_sel:[0,1,0] op_sel_hi:[1,1,0]
    s_add_u32 m0, s62, 0x1000
    s_nop 0
    s_nop 0
    buffer_load_dwordx4 v251, s[8:11], s65 offen offset:0 sc1 lds
    buffer_load_dwordx4 v251, s[8:11], s65 offen offset:1024 sc1 lds
    buffer_load_dwordx4 v251, s[8:11], s65 offen offset:2048 sc1 lds
    buffer_load_dwordx4 v251, s[8:11], s65 offen offset:3072 sc1 lds
    ds_read_b128 a[204:207], v241 offset:17408
    ds_read_b128 a[236:239], v241 offset:25600
    ds_read_b128 a[144:147], v242 offset:0
    ds_read_b128 a[176:179], v242 offset:8192
    v_pk_fma_f32 v[42:43], v[42:43], v[132:133], v[132:133] op_sel:[0,1,0] op_sel_hi:[1,1,0]
    v_pk_fma_f32 v[56:57], v[56:57], v[132:133], v[132:133] op_sel:[0,1,0] op_sel_hi:[1,1,0]
    v_pk_fma_f32 v[58:59], v[58:59], v[132:133], v[132:133] op_sel:[0,1,0] op_sel_hi:[1,1,0]
    v_cvt_pk_bf16_f32 v80, v8, v9
    v_cvt_pk_bf16_f32 v81, v10, v11
    v_cvt_pk_bf16_f32 v82, v24, v25
    v_cvt_pk_bf16_f32 v83, v26, v27
    v_cvt_pk_bf16_f32 v84, v40, v41
    v_cvt_pk_bf16_f32 v85, v42, v43
L_pad2:
    s_cbranch_execz L_pad6
    s_nop 0
    v_cvt_pk_bf16_f32 v86, v56, v57
    v_cvt_pk_bf16_f32 v87, v58, v59
    v_pk_fma_f32 v[12:13], v[12:13], v[134:135], v[134:135] op_sel:[0,1,0] op_sel_hi:[1,1,0]
    v_pk_fma_f32 v[14:15], v[14:15], v[134:135], v[134:135] op_sel:[0,1,0] op_sel_hi:[1,1,0]
    v_pk_fma_f32 v[28:29], v[28:29], v[134:135], v[134:135] op_sel:[0,1,0] op_sel_hi:[1,1,0]
    v_pk_fma_f32 v[30:31], v[30:31], v[134:135], v[134:135] op_sel:[0,1,0] op_sel_hi:[1,1,0]
    v_pk_fma_f32 v[44:45], v[44:45], v[134:135], v[134:135] op_sel:[0,1,0] op_sel_hi:[1,1,0]
    v_pk_fma_f32 v[46:47], v[46:47], v[134:135], v[134:135] op_sel:[0,1,0] op_sel_hi:[1,1,0]
    v_pk_fma_f32 v[60:61], v[60:61], v[134:135], v[134:135] op_sel:[0,1,0] op_sel_hi:[1,1,0]
    v_pk_fma_f32 v[62:63], v[62:63], v[134:135], v[134:135] op_sel:[0,1,0] op_sel_hi:[1,1,0]
    v_cvt_pk_bf16_f32 v88, v12, v13
    v_cvt_pk_bf16_f32 v89, v14, v15
    v_cvt_pk_bf16_f32 v90, v28, v29
    v_cvt_pk_bf16_f32 v91, v30, v31
    v_cvt_pk_bf16_f32 v92, v44, v45
    v_cvt_pk_bf16_f32 v93, v46, v47
    v_cvt_pk_bf16_f32 v94, v60, v61
    v_cvt_pk_bf16_f32 v95, v62, v63
    v_mfma_f32_16x16x32_bf16 v[0:3], v[64:67], v[170:173], 0
    ds_read_b128 a[208:211], v242 offset:16384
    v_add_u32 v244, s60, v248
    v_mfma_f32_16x16x32_bf16 v[16:19], v[64:67], v[168:171], 0
    ds_read_b128 a[240:243], v242 offset:24576
    v_and_b32 v245, 0xf0, v250
    v_mfma_f32_16x16x32_bf16 v[32:35], v[68:71], v[170:173], 0
    ds_read_b128 a[148:151], v242 offset:1024
    v_and_b32 v254, 0x300, v250
    v_mfma_f32_16x16x32_bf16 v[48:51], v[68:71], v[168:171], 0
    ds_read_b128 a[180:183], v242 offset:9216
    v_lshl_add_u32 v254, v254, 4, v245
    v_mfma_f32_16x16x32_bf16 v[4:7], v[72:75], v[170:173], 0
    ds_read_b128 a[212:215], v242 offset:17408
    v_add_u32 v245, s61, v248
    v_mfma_f32_16x16x32_bf16 v[20:23], v[72:75], v[168:171], 0
    ds_read_b128 a[244:247], v242 offset:25600
    v_mov_b32 v160, 0
    v_mfma_f32_16x16x32_bf16 v[36:39], v[76:79], v[170:173], 0
    s_waitcnt vmcnt(22)
    ds_read_b128 a[0:3], v244 offset:0
    v_mov_b32 v161, 0
    v_mfma_f32_16x16x32_bf16 v[52:55], v[76:79], v[168:171], 0
    ds_read_b128 a[4:7], v244 offset:1024
    v_mov_b32 v162, 0
    v_mfma_f32_16x16x32_bf16 v[8:11], v[80:83], v[170:173], 0
    ds_read_b128 a[152:155], v243 offset:0
    v_mov_b32 v163, 0
    v_mfma_f32_16x16x32_bf16 v[24:27], v[80:83], v[168:171], 0
    ds_read_b128 a[184:187], v243 offset:8192
    v_mov_b32 v164, 0
    v_mfma_f32_16x16x32_bf16 v[40:43], v[84:87], v[170:173], 0
    ds_read_b128 a[216:219], v243 offset:16384
    v_mov_b32 v165, 0
    v_mfma_f32_16x16x32_bf16 v[56:59], v[84:87], v[168:171], 0
    ds_read_b128 a[248:251], v243 offset:24576
    v_mov_b32 v166, 0
    v_mfma_f32_16x16x32_bf16 v[12:15], v[88:91], v[170:173], 0
    ds_read_b128 a[156:159], v243 offset:1024
    v_mov_b32 v167, 0
    v_mfma_f32_16x16x32_bf16 v[28:31], v[88:91], v[168:171], 0
    s_sub_u32 s34, s33, 4
    ds_read_b128 a[188:191], v243 offset:9216
    v_mfma_f32_16x16x32_bf16 v[44:47], v[92:95], v[170:173], 0
    ds_read_b128 a[220:223], v243 offset:17408
    v_mfma_f32_16x16x32_bf16 v[60:63], v[92:95], v[168:171], 0
    ds_read_b128 a[252:255], v243 offset:25600
L_pjoin:
    v_mov_b64 v[168:169], 0
    v_mov_b64 v[170:171], 0
    v_mov_b64 v[172:173], 0
    v_mov_b64 v[174:175], 0
    s_cmp_eq_u32 s5, 0
    s_cbranch_scc0 L_maxpass
L_maxdone:
    s_waitcnt vmcnt(20) lgkmcnt(0)
    v_mfma_f32_16x16x32_bf16 v[128:131], a[0:3], a[128:131], v[160:163]
    ds_read_b128 a[8:11], v244 offset:2048
    ds_read_b128 a[12:15], v244 offset:3072
    v_mfma_f32_16x16x32_bf16 v[128:131], a[4:7], a[132:135], v[128:131]
    s_mov_b32 m0, s63
    v_add_u32 v246, s60, v249
    v_add_u32 v247, s61, v249
    v_mfma_f32_16x16x32_bf16 v[132:135], a[4:7], a[164:167], v[164:167]
    buffer_load_dwordx4 v252, s[8:11], s65 offen offset:0 sc1 lds
    v_mfma_f32_16x16x32_bf16 v[132:135], a[0:3], a[160:163], v[132:135]
    v_cvt_pk_bf16_f32 v96, v0, v1
    v_cvt_pk_bf16_f32 v97, v2, v3
    v_mfma_f32_16x16x32_bf16 v[136:139], a[0:3], a[192:195], v[168:171]
    v_cvt_pk_bf16_f32 v98, v4, v5
    v_cvt_pk_bf16_f32 v99, v6, v7
    v_mfma_f32_16x16x32_bf16 v[136:139], a[4:7], a[196:199], v[136:139]
    s_waitcnt vmcnt(19)
    ds_read_b128 a[64:67], v244 offset:4096
    ds_read_b128 a[68:71], v244 offset:5120
    v_mfma_f32_16x16x32_bf16 v[140:143], a[4:7], a[228:231], v[172:175]
    buffer_load_dwordx4 v252, s[8:11], s65 offen offset:1024 sc1 lds
    v_mfma_f32_16x16x32_bf16 v[140:143], a[0:3], a[224:227], v[140:143]
    s_waitcnt lgkmcnt(2)
    v_cvt_pk_bf16_f32 v100, v16, v17
    v_cvt_pk_bf16_f32 v101, v18, v19
    v_mfma_f32_16x16x32_bf16 v[128:131], a[8:11], a[136:139], v[128:131]
    v_cvt_pk_bf16_f32 v102, v20, v21
    v_cvt_pk_bf16_f32 v103, v22, v23
    v_mfma_f32_16x16x32_bf16 v[128:131], a[12:15], a[140:143], v[128:131]
    v_cvt_pk_bf16_f32 v104, v32, v33
    v_cvt_pk_bf16_f32 v105, v34, v35
    v_mfma_f32_16x16x32_bf16 v[132:135], a[12:15], a[172:175], v[132:135]
    buffer_load_dwordx4 v252, s[8:11], s65 offen offset:2048 sc1 lds
    v_mfma_f32_16x16x32_bf16 v[132:135], a[8:11], a[168:171], v[132:135]
    buffer_store_dwordx4 v[96:99], v254, s[8:11], s44 offen offset:0 sc1
    v_mfma_f32_16x16x32_bf16 v[136:139], a[8:11], a[200:203], v[136:139]
    v_cvt_pk_bf16_f32 v106, v36, v37
    v_cvt_pk_bf16_f32 v107, v38, v39
    v_mfma_f32_16x16x32_bf16 v[136:139], a[12:15], a[204:207], v[136:139]
    s_waitcnt vmcnt(20)
    ds_read_b128 a[72:75], v244 offset:6144
    ds_read_b128 a[76:79], v244 offset:7168
    v_mfma_f32_16x16x32_bf16 v[140:143], a[12:15], a[236:239], v[140:143]
    buffer_load_dwordx4 v252, s[8:11], s65 offen offset:3072 sc1 lds
    v_mfma_f32_16x16x32_bf16 v[140:143], a[8:11], a[232:235], v[140:143]
    s_waitcnt lgkmcnt(2)
    v_add_u32 v244, s62, v248
    v_cvt_pk_bf16_f32 v108, v48, v49
    v_mfma_f32_16x16x32_bf16 v[128:131], a[64:67], a[144:147], v[128:131]
    v_cvt_pk_bf16_f32 v109, v50, v51
    v_cvt_pk_bf16_f32 v110, v52, v53
    v_mfma_f32_16x16x32_bf16 v[128:131], a[68:71], a[148:151], v[128:131]
    s_add_u32 m0, s63, 0x1000
    v_cvt_pk_bf16_f32 v111, v54, v55
    v_cvt_pk_bf16_f32 v112, v8, v9
    v_mfma_f32_16x16x32_bf16 v[132:135], a[68:71], a[180:183], v[132:135]
    buffer_load_dwordx4 v253, s[8:11], s65 offen offset:0 sc1 lds
    v_mfma_f32_16x16x32_bf16 v[132:135], a[64:67], a[176:179], v[132:135]
    v_cvt_pk_bf16_f32 v113, v10, v11
    v_cvt_pk_bf16_f32 v114, v12, v13
    v_mfma_f32_16x16x32_bf16 v[136:139], a[64:67], a[208:211], v[136:139]
    v_cvt_pk_bf16_f32 v115, v14, v15
    v_cvt_pk_bf16_f32 v116, v24, v25
    v_mfma_f32_16x16x32_bf16 v[136:139], a[68:71], a[212:215], v[136:139]
    s_waitcnt vmcnt(20)
    ds_read_b128 a[0:3], v245 offset:0
    ds_read_b128 a[4:7], v245 offset:1024
    v_mfma_f32_16x16x32_bf16 v[140:143], a[68:71], a[244:247], v[140:143]
    buffer_load_dwordx4 v253, s[8:11], s65 offen offset:1024 sc1 lds
    v_mfma_f32_16x16x32_bf16 v[140:143], a[64:67], a[240:243], v[140:143]
    s_waitcnt lgkmcnt(2)
    v_cvt_pk_bf16_f32 v117, v26, v27
    v_cvt_pk_bf16_f32 v118, v28, v29
    v_mfma_f32_16x16x32_bf16 v[128:131], a[72:75], a[152:155], v[128:131]
    v_cvt_pk_bf16_f32 v119, v30, v31
    v_cvt_pk_bf16_f32 v120, v40, v41
    v_mfma_f32_16x16x32_bf16 v[128:131], a[76:79], a[156:159], v[128:131]
    v_cvt_pk_bf16_f32 v121, v42, v43
    v_cvt_pk_bf16_f32 v122, v44, v45
    v_mfma_f32_16x16x32_bf16 v[132:135], a[76:79], a[188:191], v[132:135]
    buffer_load_dwordx4 v253, s[8:11], s65 offen offset:2048 sc1 lds
    v_mfma_f32_16x16x32_bf16 v[132:135], a[72:75], a[184:187], v[132:135]
    v_cvt_pk_bf16_f32 v123, v46, v47
    v_cvt_pk_bf16_f32 v124, v56, v57
    v_mfma_f32_16x16x32_bf16 v[136:139], a[72:75], a[216:219], v[136:139]
    v_cvt_pk_bf16_f32 v125, v58, v59
    v_cvt_pk_bf16_f32 v126, v60, v61
    v_mfma_f32_16x16x32_bf16 v[136:139], a[76:79], a[220:223], v[136:139]
    s_waitcnt vmcnt(20)
    ds_read_b128 a[8:11], v245 offset:2048
    ds_read_b128 a[12:15], v245 offset:3072
    v_mfma_f32_16x16x32_bf16 v[140:143], a[76:79], a[252:255], v[140:143]
    buffer_load_dwordx4 v253, s[8:11], s65 offen offset:3072 sc1 lds
    v_mfma_f32_16x16x32_bf16 v[140:143], a[72:75], a[248:251], v[140:143]
    s_waitcnt lgkmcnt(2)
    v_cvt_pk_bf16_f32 v127, v62, v63
    v_mfma_f32_16x16x32_bf16 v[144:147], a[0:3], a[128:131], v[160:163]
    s_add_u32 s65, s65, 0x10000
    v_exp_f32 v128, v128
    v_mfma_f32_16x16x32_bf16 v[144:147], a[4:7], a[132:135], v[144:147]
    buffer_store_dwordx4 v[100:103], v254, s[8:11], s44 offen offset:256 sc1
    v_mfma_f32_16x16x32_bf16 v[148:151], a[4:7], a[164:167], v[164:167]
    v_exp_f32 v129, v129
    v_mfma_f32_16x16x32_bf16 v[148:151], a[0:3], a[160:163], v[148:151]
    v_exp_f32 v130, v130
    v_mfma_f32_16x16x32_bf16 v[152:155], a[0:3], a[192:195], v[168:171]
    v_exp_f32 v131, v131
    v_mfma_f32_16x16x32_bf16 v[152:155], a[4:7], a[196:199], v[152:155]
    s_waitcnt vmcnt(20)
    ds_read_b128 a[64:67], v245 offset:4096
    ds_read_b128 a[68:71], v245 offset:5120
    v_mfma_f32_16x16x32_bf16 v[156:159], a[4:7], a[228:231], v[172:175]
    v_exp_f32 v132, v132
    v_mfma_f32_16x16x32_bf16 v[156:159], a[0:3], a[224:227], v[156:159]
    s_waitcnt lgkmcnt(2)
    v_exp_f32 v133, v133
    v_mfma_f32_16x16x32_bf16 v[144:147], a[8:11], a[136:139], v[144:147]
    v_cvt_pk_bf16_f32 v176, v128, v129
    v_cvt_pk_bf16_f32 v177, v130, v131
    v_mfma_f32_16x16x32_bf16 v[144:147], a[12:15], a[140:143], v[144:147]
    v_exp_f32 v134, v134
    v_mfma_f32_16x16x32_bf16 v[148:151], a[12:15], a[172:175], v[148:151]
    v_exp_f32 v135, v135
    v_mfma_f32_16x16x32_bf16 v[148:151], a[8:11], a[168:171], v[148:151]
    v_exp_f32 v136, v136
    v_mfma_f32_16x16x32_bf16 v[152:155], a[8:11], a[200:203], v[152:155]
    v_exp_f32 v137, v137
    v_mfma_f32_16x16x32_bf16 v[152:155], a[12:15], a[204:207], v[152:155]
    s_waitcnt vmcnt(18)
    ds_read_b128 a[72:75], v245 offset:6144
    ds_read_b128 a[76:79], v245 offset:7168
    v_mfma_f32_16x16x32_bf16 v[156:159], a[12:15], a[236:239], v[156:159]
    v_cvt_pk_bf16_f32 v180, v132, v133
    v_cvt_pk_bf16_f32 v181, v134, v135
    v_mfma_f32_16x16x32_bf16 v[156:159], a[8:11], a[232:235], v[156:159]
    s_waitcnt lgkmcnt(2)
    v_add_u32 v245, s63, v248
    v_cvt_pk_bf16_f32 v184, v136, v137
    v_mfma_f32_16x16x32_bf16 v[144:147], a[64:67], a[144:147], v[144:147]
    v_exp_f32 v138, v138
    v_mfma_f32_16x16x32_bf16 v[144:147], a[68:71], a[148:151], v[144:147]
    v_exp_f32 v139, v139
    v_mfma_f32_16x16x32_bf16 v[148:151], a[68:71], a[180:183], v[148:151]
    v_exp_f32 v140, v140
    v_mfma_f32_16x16x32_bf16 v[148:151], a[64:67], a[176:179], v[148:151]
    v_exp_f32 v141, v141
    v_mfma_f32_16x16x32_bf16 v[152:155], a[64:67], a[208:211], v[152:155]
    v_exp_f32 v142, v142
    v_mfma_f32_16x16x32_bf16 v[152:155], a[68:71], a[212:215], v[152:155]
    s_waitcnt vmcnt(16)
    ds_read_b128 a[0:3], v244 offset:0
    ds_read_b128 a[4:7], v244 offset:1024
    v_mfma_f32_16x16x32_bf16 v[156:159], a[68:71], a[244:247], v[156:159]
    buffer_store_dwordx4 v[104:107], v254, s[8:11], s44 offen offset:2048 sc1
    v_mfma_f32_16x16x32_bf16 v[156:159], a[64:67], a[240:243], v[156:159]
    s_waitcnt lgkmcnt(2)
    v_exp_f32 v143, v143
    v_mfma_f32_16x16x32_bf16 v[144:147], a[72:75], a[152:155], v[144:147]
    v_cvt_pk_bf16_f32 v185, v138, v139
    v_cvt_pk_bf16_f32 v188, v140, v141
    v_mfma_f32_16x16x32_bf16 v[144:147], a[76:79], a[156:159], v[144:147]
    v_cvt_pk_bf16_f32 v189, v142, v143
    v_mfma_f32_16x16x32_bf16 v[148:151], a[76:79], a[188:191], v[148:151]
    v_mfma_f32_16x16x32_bf16 v[148:151], a[72:75], a[184:187], v[148:151]
    v_mfma_f32_16x16x32_bf16 v[152:155], a[72:75], a[216:219], v[152:155]
    v_mfma_f32_16x16x32_bf16 v[152:155], a[76:79], a[220:223], v[152:155]
    s_waitcnt vmcnt(15)
    ds_read_b128 a[8:11], v244 offset:2048
    ds_read_b128 a[12:15], v244 offset:3072
    v_mfma_f32_16x16x32_bf16 v[156:159], a[76:79], a[252:255], v[156:159]
    v_mfma_f32_16x16x32_bf16 v[156:159], a[72:75], a[248:251], v[156:159]
    s_waitcnt lgkmcnt(2)
    s_barrier
L_it0:
    v_mfma_f32_16x16x32_bf16 v[128:131], a[0:3], a[128:131], v[160:163]
    v_exp_f32 v144, v144
    v_mfma_f32_16x16x32_bf16 v[128:131], a[4:7], a[132:135], v[128:131]
    s_mov_b32 m0, s64
    v_exp_f32 v145, v145
    v_mfma_f32_16x16x32_bf16 v[132:135], a[4:7], a[164:167], v[164:167]
    buffer_load_dwordx4 v250, s[8:11], s65 offen offset:0 sc1 lds
    v_mfma_f32_16x16x32_bf16 v[132:135], a[0:3], a[160:163], v[132:135]
    v_exp_f32 v146, v146
    v_mfma_f32_16x16x32_bf16 v[136:139], a[0:3], a[192:195], v[168:171]
    v_exp_f32 v147, v147
    v_mfma_f32_16x16x32_bf16 v[136:139], a[4:7], a[196:199], v[136:139]
    s_waitcnt vmcnt(14)
    ds_read_b128 a[64:67], v244 offset:4096
    ds_read_b128 a[68:71], v244 offset:5120
    v_mfma_f32_16x16x32_bf16 v[140:143], a[4:7], a[228:231], v[172:175]
    v_exp_f32 v148, v148
    v_mfma_f32_16x16x32_bf16 v[140:143], a[0:3], a[224:227], v[140:143]
    s_waitcnt lgkmcnt(2)
    v_exp_f32 v149, v149
    v_mfma_f32_16x16x32_bf16 v[128:131], a[8:11], a[136:139], v[128:131]
    v_cvt_pk_bf16_f32 v178, v144, v145
    v_cvt_pk_bf16_f32 v179, v146, v147
    v_mfma_f32_16x16x32_bf16 v[128:131], a[12:15], a[140:143], v[128:131]
    v_exp_f32 v150, v150
    v_mfma_f32_16x16x32_bf16 v[132:135], a[12:15], a[172:175], v[132:135]
    buffer_load_dwordx4 v250, s[8:11], s65 offen offset:1024 sc1 lds
    v_mfma_f32_16x16x32_bf16 v[132:135], a[8:11], a[168:171], v[132:135]
    v_exp_f32 v151, v151
    v_mfma_f32_16x16x32_bf16 v[136:139], a[8:11], a[200:203], v[136:139]
    v_exp_f32 v152, v152
    v_mfma_f32_16x16x32_bf16 v[136:139], a[12:15], a[204:207], v[136:139]
    s_waitcnt vmcnt(13)
    ds_read_b128 a[72:75], v244 offset:6144
    ds_read_b128 a[76:79], v244 offset:7168
    v_mfma_f32_16x16x32_bf16 v[140:143], a[12:15], a[236:239], v[140:143]
    v_exp_f32 v153, v153
    v_mfma_f32_16x16x32_bf16 v[140:143], a[8:11], a[232:235], v[140:143]
    s_waitcnt lgkmcnt(2)
    v_add_u32 v244, s64, v248
    v_cvt_pk_bf16_f32 v182, v148, v149
    v_mfma_f32_16x16x32_bf16 v[128:131], a[64:67], a[144:147], v[128:131]
    v_exp_f32 v154, v154
    v_mfma_f32_16x16x32_bf16 v[128:131], a[68:71], a[148:151], v[128:131]
    v_exp_f32 v155, v155
    v_mfma_f32_16x16x32_bf16 v[132:135], a[68:71], a[180:183], v[132:135]
    buffer_load_dwordx4 v250, s[8:11], s65 offen offset:2048 sc1 lds
    v_mfma_f32_16x16x32_bf16 v[132:135], a[64:67], a[176:179], v[132:135]
    v_cvt_pk_bf16_f32 v183, v150, v151
    v_cvt_pk_bf16_f32 v186, v152, v153
    v_mfma_f32_16x16x32_bf16 v[136:139], a[64:67], a[208:211], v[136:139]
    v_exp_f32 v156, v156
    v_mfma_f32_16x16x32_bf16 v[136:139], a[68:71], a[212:215], v[136:139]
    s_waitcnt vmcnt(12)
    ds_read_b128 a[0:3], v245 offset:0
    ds_read_b128 a[4:7], v245 offset:1024
    v_mfma_f32_16x16x32_bf16 v[140:143], a[68:71], a[244:247], v[140:143]
    v_exp_f32 v157, v157
    v_mfma_f32_16x16x32_bf16 v[140:143], a[64:67], a[240:243], v[140:143]
    s_waitcnt lgkmcnt(2)
    v_exp_f32 v158, v158
    v_mfma_f32_16x16x32_bf16 v[128:131], a[72:75], a[152:155], v[128:131]
    v_exp_f32 v159, v159
    v_mfma_f32_16x16x32_bf16 v[128:131], a[76:79], a[156:159], v[128:131]
    v_cvt_pk_bf16_f32 v187, v154, v155
    v_cvt_pk_bf16_f32 v190, v156, v157
    v_mfma_f32_16x16x32_bf16 v[132:135], a[76:79], a[188:191], v[132:135]
    buffer_load_dwordx4 v250, s[8:11], s65 offen offset:3072 sc1 lds
    v_mfma_f32_16x16x32_bf16 v[132:135], a[72:75], a[184:187], v[132:135]
    v_cvt_pk_bf16_f32 v191, v158, v159
    v_mfma_f32_16x16x32_bf16 v[136:139], a[72:75], a[216:219], v[136:139]
    v_mfma_f32_16x16x32_bf16 v[136:139], a[76:79], a[220:223], v[136:139]
    s_waitcnt vmcnt(10)
    ds_read_b128 a[8:11], v245 offset:2048
    ds_read_b128 a[12:15], v245 offset:3072
    v_mfma_f32_16x16x32_bf16 v[140:143], a[76:79], a[252:255], v[140:143]
    v_mfma_f32_16x16x32_bf16 v[140:143], a[72:75], a[248:251], v[140:143]
    s_waitcnt lgkmcnt(2)
    v_mfma_f32_16x16x32_bf16 v[144:147], a[0:3], a[128:131], v[160:163]
    v_mfma_f32_16x16x32_bf16 v[144:147], a[4:7], a[132:135], v[144:147]
    s_add_u32 m0, s64, 0x1000
    v_mfma_f32_16x16x32_bf16 v[148:151], a[4:7], a[164:167], v[164:167]
    buffer_load_dwordx4 v251, s[8:11], s65 offen offset:0 sc1 lds
    v_mfma_f32_16x16x32_bf16 v[148:151], a[0:3], a[160:163], v[148:151]
    v_mfma_f32_16x16x32_bf16 v[152:155], a[0:3], a[192:195], v[168:171]
    buffer_store_dwordx4 v[108:111], v254, s[8:11], s44 offen offset:2304 sc1
    v_mfma_f32_16x16x32_bf16 v[152:155], a[4:7], a[196:199], v[152:155]
    s_waitcnt vmcnt(10)
    ds_read_b128 a[64:67], v245 offset:4096
    ds_read_b128 a[68:71], v245 offset:5120
    v_mfma_f32_16x16x32_bf16 v[156:159], a[4:7], a[228:231], v[172:175]
    buffer_store_dwordx4 v[112:115], v254, s[8:11], s59 offen offset:0 sc1
    v_mfma_f32_16x16x32_bf16 v[156:159], a[0:3], a[224:227], v[156:159]
    s_waitcnt lgkmcnt(2)
    v_exp_f32 v128, v128
    v_mfma_f32_16x16x32_bf16 v[144:147], a[8:11], a[136:139], v[144:147]
    v_exp_f32 v129, v129
    v_mfma_f32_16x16x32_bf16 v[144:147], a[12:15], a[140:143], v[144:147]
    v_exp_f32 v130, v130
    v_mfma_f32_16x16x32_bf16 v[148:151], a[12:15], a[172:175], v[148:151]
    buffer_load_dwordx4 v251, s[8:11], s65 offen offset:1024 sc1 lds
    v_mfma_f32_16x16x32_bf16 v[148:151], a[8:11], a[168:171], v[148:151]
    v_exp_f32 v131, v131
    v_mfma_f32_16x16x32_bf16 v[152:155], a[8:11], a[200:203], v[152:155]
    v_cvt_pk_bf16_f32 v192, v128, v129
    v_cvt_pk_bf16_f32 v193, v130, v131
    v_mfma_f32_16x16x32_bf16 v[152:155], a[12:15], a[204:207], v[152:155]
    s_waitcnt vmcnt(10)
    ds_read_b128 a[72:75], v245 offset:6144
    ds_read_b128 a[76:79], v245 offset:7168
    v_mfma_f32_16x16x32_bf16 v[156:159], a[12:15], a[236:239], v[156:159]
    v_mfma_f32_16x16x32_bf16 v[156:159], a[8:11], a[232:235], v[156:159]
    s_waitcnt lgkmcnt(2)
    v_add_u32 v245, s60, v248
    v_mfma_f32_16x16x32_bf16 v[144:147], a[64:67], a[144:147], v[144:147]
    ds_read_b64_tr_b16 a[0:1], v246 offset:0
    v_mfma_f32_16x16x32_bf16 v[144:147], a[68:71], a[148:151], v[144:147]
    v_exp_f32 v132, v132
    v_mfma_f32_16x16x32_bf16 v[148:151], a[68:71], a[180:183], v[148:151]
    buffer_load_dwordx4 v251, s[8:11], s65 offen offset:2048 sc1 lds
    v_mfma_f32_16x16x32_bf16 v[148:151], a[64:67], a[176:179], v[148:151]
    ds_read_b64_tr_b16 a[2:3], v247 offset:0
    v_mfma_f32_16x16x32_bf16 v[152:155], a[64:67], a[208:211], v[152:155]
    v_exp_f32 v133, v133
    v_mfma_f32_16x16x32_bf16 v[152:155], a[68:71], a[212:215], v[152:155]
    ds_read_b64_tr_b16 a[4:5], v246 offset:256
    v_cvt_pk_bf16_f32 v196, v132, v133
    v_mfma_f32_16x16x32_bf16 v[156:159], a[68:71], a[244:247], v[156:159]
    ds_read_b64_tr_b16 a[6:7], v247 offset:256
    v_mfma_f32_16x16x32_bf16 v[156:159], a[64:67], a[240:243], v[156:159]
    s_waitcnt lgkmcnt(4)
    v_mfma_f32_16x16x32_bf16 v[144:147], a[72:75], a[152:155], v[144:147]
    ds_read_b64_tr_b16 a[8:9], v246 offset:1024
    v_mfma_f32_16x16x32_bf16 v[144:147], a[76:79], a[156:159], v[144:147]
    buffer_store_dwordx4 v[116:119], v254, s[8:11], s59 offen offset:256 sc1
    v_mfma_f32_16x16x32_bf16 v[148:151], a[76:79], a[188:191], v[148:151]
    buffer_load_dwordx4 v251, s[8:11], s65 offen offset:3072 sc1 lds
    v_mfma_f32_16x16x32_bf16 v[148:151], a[72:75], a[184:187], v[148:151]
    ds_read_b64_tr_b16 a[10:11], v247 offset:1024
    v_mfma_f32_16x16x32_bf16 v[152:155], a[72:75], a[216:219], v[152:155]
    v_exp_f32 v134, v134
    v_mfma_f32_16x16x32_bf16 v[152:155], a[76:79], a[220:223], v[152:155]
    ds_read_b64_tr_b16 a[12:13], v246 offset:1280
    v_mfma_f32_16x16x32_bf16 v[156:159], a[76:79], a[252:255], v[156:159]
    ds_read_b64_tr_b16 a[14:15], v247 offset:1280
    v_mfma_f32_16x16x32_bf16 v[156:159], a[72:75], a[248:251], v[156:159]
    s_waitcnt lgkmcnt(4)
    v_exp_f32 v135, v135
    v_mfma_f32_16x16x32_bf16 v[0:3], a[0:3], v[176:179], 0
    ds_read_b64_tr_b16 a[64:65], v246 offset:2048
    v_cvt_pk_bf16_f32 v197, v134, v135
    v_mfma_f32_16x16x32_bf16 v[64:67], a[0:3], v[180:183], 0
    s_mov_b32 m0, s60
    v_exp_f32 v136, v136
    v_mfma_f32_16x16x32_bf16 v[208:211], a[0:3], v[184:187], 0
    buffer_load_dwordx4 v252, s[8:11], s65 offen offset:0 sc1 lds
    v_mfma_f32_16x16x32_bf16 v[224:227], a[0:3], v[188:191], 0
    ds_read_b64_tr_b16 a[66:67], v247 offset:2048
    v_mfma_f32_16x16x32_bf16 v[228:231], a[4:7], v[188:191], 0
    v_exp_f32 v137, v137
    v_mfma_f32_16x16x32_bf16 v[212:215], a[4:7], v[184:187], 0
    ds_read_b64_tr_b16 a[68:69], v246 offset:2304
    v_cvt_pk_bf16_f32 v200, v136, v137
    v_mfma_f32_16x16x32_bf16 v[68:71], a[4:7], v[180:183], 0
    ds_read_b64_tr_b16 a[70:71], v247 offset:2304
    v_mfma_f32_16x16x32_bf16 v[4:7], a[4:7], v[176:179], 0
    s_waitcnt lgkmcnt(4)
    v_mfma_f32_16x16x32_bf16 v[8:11], a[8:11], v[176:179], 0
    ds_read_b64_tr_b16 a[72:73], v246 offset:3072
    v_mfma_f32_16x16x32_bf16 v[72:75], a[8:11], v[180:183], 0
    v_exp_f32 v138, v138
    v_mfma_f32_16x16x32_bf16 v[216:219], a[8:11], v[184:187], 0
    buffer_load_dwordx4 v252, s[8:11], s65 offen offset:1024 sc1 lds
    v_mfma_f32_16x16x32_bf16 v[232:235], a[8:11], v[188:191], 0
    ds_read_b64_tr_b16 a[74:75], v247 offset:3072
    v_mfma_f32_16x16x32_bf16 v[236:239], a[12:15], v[188:191], 0
    v_exp_f32 v139, v139
    v_mfma_f32_16x16x32_bf16 v[220:223], a[12:15], v[184:187], 0
    ds_read_b64_tr_b16 a[76:77], v246 offset:3328
    v_cvt_pk_bf16_f32 v201, v138, v139
    v_mfma_f32_16x16x32_bf16 v[76:79], a[12:15], v[180:183], 0
    ds_read_b64_tr_b16 a[78:79], v247 offset:3328
    v_mfma_f32_16x16x32_bf16 v[12:15], a[12:15], v[176:179], 0
    s_waitcnt lgkmcnt(4)
    v_mfma_f32_16x16x32_bf16 v[16:19], a[64:67], v[176:179], 0
    ds_read_b64_tr_b16 a[0:1], v246 offset:4096
    v_mfma_f32_16x16x32_bf16 v[80:83], a[64:67], v[180:183], 0
    buffer_store_dwordx4 v[120:123], v254, s[8:11], s59 offen offset:2048 sc1
    v_mfma_f32_16x16x32_bf16 a[16:19], a[64:67], v[184:187], 0
    buffer_load_dwordx4 v252, s[8:11], s65 offen offset:2048 sc1 lds
    v_mfma_f32_16x16x32_bf16 a[80:83], a[64:67], v[188:191], 0
    ds_read_b64_tr_b16 a[2:3], v247 offset:4096
    v_mfma_f32_16x16x32_bf16 a[84:87], a[68:71], v[188:191], 0
    v_exp_f32 v140, v140
    v_mfma_f32_16x16x32_bf16 a[20:23], a[68:71], v[184:187], 0
    ds_read_b64_tr_b16 a[4:5], v246 offset:4352
    v_mfma_f32_16x16x32_bf16 v[84:87], a[68:71], v[180:183], 0
    ds_read_b64_tr_b16 a[6:7], v247 offset:4352
    v_mfma_f32_16x16x32_bf16 v[20:23], a[68:71], v[176:179], 0
    s_waitcnt lgkmcnt(4)
    v_exp_f32 v141, v141
    v_mfma_f32_16x16x32_bf16 v[24:27], a[72:75], v[176:179], 0
    ds_read_b64_tr_b16 a[8:9], v246 offset:5120
    v_cvt_pk_bf16_f32 v204, v140, v141
    v_mfma_f32_16x16x32_bf16 v[88:91], a[72:75], v[180:183], 0
    v_exp_f32 v142, v142
    v_mfma_f32_16x16x32_bf16 a[24:27], a[72:75], v[184:187], 0
    buffer_load_dwordx4 v252, s[8:11], s65 offen offset:3072 sc1 lds
    v_mfma_f32_16x16x32_bf16 a[88:91], a[72:75], v[188:191], 0
    ds_read_b64_tr_b16 a[10:11], v247 offset:5120
    v_mfma_f32_16x16x32_bf16 a[92:95], a[76:79], v[188:191], 0
    v_exp_f32 v143, v143
    v_mfma_f32_16x16x32_bf16 a[28:31], a[76:79], v[184:187], 0
    ds_read_b64_tr_b16 a[12:13], v246 offset:5376
    v_cvt_pk_bf16_f32 v205, v142, v143
    v_mfma_f32_16x16x32_bf16 v[92:95], a[76:79], v[180:183], 0
    ds_read_b64_tr_b16 a[14:15], v247 offset:5376
    v_mfma_f32_16x16x32_bf16 v[28:31], a[76:79], v[176:179], 0
    s_waitcnt lgkmcnt(4)
    v_mfma_f32_16x16x32_bf16 v[32:35], a[0:3], v[176:179], 0
    ds_read_b64_tr_b16 a[64:65], v246 offset:6144
    v_mfma_f32_16x16x32_bf16 v[96:99], a[0:3], v[180:183], 0
    s_add_u32 m0, s60, 0x1000
    v_exp_f32 v144, v144
    v_mfma_f32_16x16x32_bf16 a[32:35], a[0:3], v[184:187], 0
    buffer_load_dwordx4 v253, s[8:11], s65 offen offset:0 sc1 lds
    v_mfma_f32_16x16x32_bf16 a[96:99], a[0:3], v[188:191], 0
    ds_read_b64_tr_b16 a[66:67], v247 offset:6144
    v_mfma_f32_16x16x32_bf16 a[100:103], a[4:7], v[188:191], 0
    buffer_store_dwordx4 v[124:127], v254, s[8:11], s59 offen offset:2304 sc1
    v_mfma_f32_16x16x32_bf16 a[36:39], a[4:7], v[184:187], 0
    ds_read_b64_tr_b16 a[68:69], v246 offset:6400
    v_min_u32 v254, 1, v250
    v_mfma_f32_16x16x32_bf16 v[100:103], a[4:7], v[180:183], 0
    ds_read_b64_tr_b16 a[70:71], v247 offset:6400
    v_lshlrev_b32 v254, 30, v254
    v_mfma_f32_16x16x32_bf16 v[36:39], a[4:7], v[176:179], 0
    s_waitcnt lgkmcnt(4)
    v_exp_f32 v145, v145
    v_mfma_f32_16x16x32_bf16 v[40:43], a[8:11], v[176:179], 0
    ds_read_b64_tr_b16 a[72:73], v246 offset:7168
    v_cvt_pk_bf16_f32 v194, v144, v145
    v_mfma_f32_16x16x32_bf16 v[104:107], a[8:11], v[180:183], 0
    v_exp_f32 v146, v146
    v_mfma_f32_16x16x32_bf16 a[40:43], a[8:11], v[184:187], 0
    buffer_load_dwordx4 v253, s[8:11], s65 offen offset:1024 sc1 lds
    v_mfma_f32_16x16x32_bf16 a[104:107], a[8:11], v[188:191], 0
    ds_read_b64_tr_b16 a[74:75], v247 offset:7168
    v_mov_b32 v255, s4
    v_mfma_f32_16x16x32_bf16 a[108:111], a[12:15], v[188:191], 0
    v_exp_f32 v147, v147
    v_mfma_f32_16x16x32_bf16 a[44:47], a[12:15], v[184:187], 0
    ds_read_b64_tr_b16 a[76:77], v246 offset:7424
    v_cvt_pk_bf16_f32 v195, v146, v147
    v_mfma_f32_16x16x32_bf16 v[108:111], a[12:15], v[180:183], 0
    ds_read_b64_tr_b16 a[78:79], v247 offset:7424
    v_mfma_f32_16x16x32_bf16 v[44:47], a[12:15], v[176:179], 0
    s_waitcnt lgkmcnt(4)
    v_add_u32 v246, s62, v249
    v_add_u32 v247, s63, v249
    v_mfma_f32_16x16x32_bf16 v[48:51], a[64:67], v[176:179], 0
    v_exp_f32 v148, v148
    v_mfma_f32_16x16x32_bf16 v[112:115], a[64:67], v[180:183], 0
    v_exp_f32 v149, v149
    v_mfma_f32_16x16x32_bf16 a[48:51], a[64:67], v[184:187], 0
    buffer_load_dwordx4 v253, s[8:11], s65 offen offset:2048 sc1 lds
    v_mfma_f32_16x16x32_bf16 a[112:115], a[64:67], v[188:191], 0
    v_cvt_pk_bf16_f32 v198, v148, v149
    v_mfma_f32_16x16x32_bf16 a[116:119], a[68:71], v[188:191], 0
    v_mfma_f32_16x16x32_bf16 a[52:55], a[68:71], v[184:187], 0
    s_waitcnt vmcnt(18)
    ds_read_b128 a[0:3], v244 offset:0
    v_mfma_f32_16x16x32_bf16 v[116:119], a[68:71], v[180:183], 0
    ds_read_b128 a[4:7], v244 offset:1024
    v_mfma_f32_16x16x32_bf16 v[52:55], a[68:71], v[176:179], 0
    s_waitcnt lgkmcnt(2)
    v_mfma_f32_16x16x32_bf16 v[56:59], a[72:75], v[176:179], 0
    v_exp_f32 v150, v150
    v_mfma_f32_16x16x32_bf16 v[120:123], a[72:75], v[180:183], 0
    v_exp_f32 v151, v151
    v_mfma_f32_16x16x32_bf16 a[56:59], a[72:75], v[184:187], 0
    buffer_load_dwordx4 v253, s[8:11], s65 offen offset:3072 sc1 lds
    v_mfma_f32_16x16x32_bf16 a[120:123], a[72:75], v[188:191], 0
    s_add_u32 s65, s65, 0x10000
    v_cvt_pk_bf16_f32 v199, v150, v151
    v_mfma_f32_16x16x32_bf16 a[124:127], a[76:79], v[188:191], 0
    v_mfma_f32_16x16x32_bf16 a[60:63], a[76:79], v[184:187], 0
    s_waitcnt vmcnt(17)
    ds_read_b128 a[8:11], v244 offset:2048
    v_mfma_f32_16x16x32_bf16 v[124:127], a[76:79], v[180:183], 0
    ds_read_b128 a[12:15], v244 offset:3072
    v_mfma_f32_16x16x32_bf16 v[60:63], a[76:79], v[176:179], 0
    s_waitcnt lgkmcnt(2)
L_itB:
    v_mfma_f32_16x16x32_bf16 v[128:131], a[0:3], a[128:131], v[160:163]
    v_exp_f32 v152, v152
    v_mfma_f32_16x16x32_bf16 v[128:131], a[4:7], a[132:135], v[128:131]
    s_mov_b32 m0, s61
    v_exp_f32 v153, v153
    v_mfma_f32_16x16x32_bf16 v[132:135], a[4:7], a[164:167], v[164:167]
    buffer_load_dwordx4 v250, s[8:11], s65 offen offset:0 sc1 lds
    v_mfma_f32_16x16x32_bf16 v[132:135], a[0:3], a[160:163], v[132:135]
    v_cvt_pk_bf16_f32 v202, v152, v153
    v_mfma_f32_16x16x32_bf16 v[136:139], a[0:3], a[192:195], v[168:171]
    v_mfma_f32_16x16x32_bf16 v[136:139], a[4:7], a[196:199], v[136:139]
    s_waitcnt vmcnt(11)
    ds_read_b128 a[64:67], v244 offset:4096
    v_mfma_f32_16x16x32_bf16 v[140:143], a[4:7], a[228:231], v[172:175]
    ds_read_b128 a[68:71], v244 offset:5120
    v_mfma_f32_16x16x32_bf16 v[140:143], a[0:3], a[224:227], v[140:143]
    s_waitcnt lgkmcnt(2)
    v_mfma_f32_16x16x32_bf16 v[128:131], a[8:11], a[136:139], v[128:131]
    v_exp_f32 v154, v154
    v_mfma_f32_16x16x32_bf16 v[128:131], a[12:15], a[140:143], v[128:131]
    v_exp_f32 v155, v155
    v_mfma_f32_16x16x32_bf16 v[132:135], a[12:15], a[172:175], v[132:135]
    buffer_load_dwordx4 v250, s[8:11], s65 offen offset:1024 sc1 lds
    v_mfma_f32_16x16x32_bf16 v[132:135], a[8:11], a[168:171], v[132:135]
    v_cvt_pk_bf16_f32 v203, v154, v155
    v_mfma_f32_16x16x32_bf16 v[136:139], a[8:11], a[200:203], v[136:139]
    v_mfma_f32_16x16x32_bf16 v[136:139], a[12:15], a[204:207], v[136:139]
    s_waitcnt vmcnt(10)
    ds_read_b128 a[72:75], v244 offset:6144
    v_mfma_f32_16x16x32_bf16 v[140:143], a[12:15], a[236:239], v[140:143]
    ds_read_b128 a[76:79], v244 offset:7168
    v_mfma_f32_16x16x32_bf16 v[140:143], a[8:11], a[232:235], v[140:143]
    s_waitcnt lgkmcnt(2)
    v_add_u32 v244, s61, v248
    v_mfma_f32_16x16x32_bf16 v[128:131], a[64:67], a[144:147], v[128:131]
    v_exp_f32 v156, v156
    v_mfma_f32_16x16x32_bf16 v[128:131], a[68:71], a[148:151], v[128:131]
    v_exp_f32 v157, v157
    v_mfma_f32_16x16x32_bf16 v[132:135], a[68:71], a[180:183], v[132:135]
    buffer_load_dwordx4 v250, s[8:11], s65 offen offset:2048 sc1 lds
    v_mfma_f32_16x16x32_bf16 v[132:135], a[64:67], a[176:179], v[132:135]
L_pad3:
    s_cbranch_execz L_pad7
    v_cvt_pk_bf16_f32 v206, v156, v157
    v_mfma_f32_16x16x32_bf16 v[136:139], a[64:67], a[208:211], v[136:139]
    v_mfma_f32_16x16x32_bf16 v[136:139], a[68:71], a[212:215], v[136:139]
    s_waitcnt vmcnt(9)
    ds_read_b128 a[0:3], v245 offset:0
    v_mfma_f32_16x16x32_bf16 v[140:143], a[68:71], a[244:247], v[140:143]
    ds_read_b128 a[4:7], v245 offset:1024
    v_mfma_f32_16x16x32_bf16 v[140:143], a[64:67], a[240:243], v[140:143]
    s_waitcnt lgkmcnt(2)
    v_mfma_f32_16x16x32_bf16 v[128:131], a[72:75], a[152:155], v[128:131]
    v_exp_f32 v158, v158
    v_mfma_f32_16x16x32_bf16 v[128:131], a[76:79], a[156:159], v[128:131]
    v_exp_f32 v159, v159
    v_mfma_f32_16x16x32_bf16 v[132:135], a[76:79], a[188:191], v[132:135]
    buffer_load_dwordx4 v250, s[8:11], s65 offen offset:3072 sc1 lds
    v_mfma_f32_16x16x32_bf16 v[132:135], a[72:75], a[184:187], v[132:135]
    v_cvt_pk_bf16_f32 v207, v158, v159
    v_mfma_f32_16x16x32_bf16 v[136:139], a[72:75], a[216:219], v[136:139]
    v_mfma_f32_16x16x32_bf16 v[136:139], a[76:79], a[220:223], v[136:139]
    s_waitcnt vmcnt(8)
    ds_read_b128 a[8:11], v245 offset:2048
    v_mfma_f32_16x16x32_bf16 v[140:143], a[76:79], a[252:255], v[140:143]
    ds_read_b128 a[12:15], v245 offset:3072
    v_mfma_f32_16x16x32_bf16 v[140:143], a[72:75], a[248:251], v[140:143]
    s_waitcnt lgkmcnt(2)
    v_mfma_f32_16x16x32_bf16 v[144:147], a[0:3], a[128:131], v[160:163]
    v_exp_f32 v128, v128
    v_mfma_f32_16x16x32_bf16 v[144:147], a[4:7], a[132:135], v[144:147]
    s_add_u32 m0, s61, 0x1000
    v_exp_f32 v129, v129
    v_mfma_f32_16x16x32_bf16 v[148:151], a[4:7], a[164:167], v[164:167]
    buffer_load_dwordx4 v251, s[8:11], s65 offen offset:0 sc1 lds
    v_mfma_f32_16x16x32_bf16 v[148:151], a[0:3], a[160:163], v[148:151]
    v_cvt_pk_bf16_f32 v176, v128, v129
    v_mfma_f32_16x16x32_bf16 v[152:155], a[0:3], a[192:195], v[168:171]
    v_mfma_f32_16x16x32_bf16 v[152:155], a[4:7], a[196:199], v[152:155]
    s_waitcnt vmcnt(7)
    ds_read_b128 a[64:67], v245 offset:4096
    v_mfma_f32_16x16x32_bf16 v[156:159], a[4:7], a[228:231], v[172:175]
    ds_read_b128 a[68:71], v245 offset:5120
    v_mfma_f32_16x16x32_bf16 v[156:159], a[0:3], a[224:227], v[156:159]
    s_waitcnt lgkmcnt(2)
    v_mfma_f32_16x16x32_bf16 v[144:147], a[8:11], a[136:139], v[144:147]
    v_exp_f32 v130, v130
    v_mfma_f32_16x16x32_bf16 v[144:147], a[12:15], a[140:143], v[144:147]
    v_exp_f32 v131, v131
    v_mfma_f32_16x16x32_bf16 v[148:151], a[12:15], a[172:175], v[148:151]
    buffer_load_dwordx4 v251, s[8:11], s65 offen offset:1024 sc1 lds
    v_mfma_f32_16x16x32_bf16 v[148:151], a[8:11], a[168:171], v[148:151]
    v_cvt_pk_bf16_f32 v177, v130, v131
    v_mfma_f32_16x16x32_bf16 v[152:155], a[8:11], a[200:203], v[152:155]
    v_mfma_f32_16x16x32_bf16 v[152:155], a[12:15], a[204:207], v[152:155]
    s_waitcnt vmcnt(6)
    ds_read_b128 a[72:75], v245 offset:6144
    v_mfma_f32_16x16x32_bf16 v[156:159], a[12:15], a[236:239], v[156:159]
    ds_read_b128 a[76:79], v245 offset:7168
    v_mfma_f32_16x16x32_bf16 v[156:159], a[8:11], a[232:235], v[156:159]
    s_waitcnt lgkmcnt(2)
    v_add_u32 v245, s62, v248
    v_mfma_f32_16x16x32_bf16 v[144:147], a[64:67], a[144:147], v[144:147]
    ds_read_b64_tr_b16 a[0:1], v246 offset:0
    v_mfma_f32_16x16x32_bf16 v[144:147], a[68:71], a[148:151], v[144:147]
    v_exp_f32 v132, v132
    v_mfma_f32_16x16x32_bf16 v[148:151], a[68:71], a[180:183], v[148:151]
    buffer_load_dwordx4 v251, s[8:11], s65 offen offset:2048 sc1 lds
    v_mfma_f32_16x16x32_bf16 v[148:151], a[64:67], a[176:179], v[148:151]
    ds_read_b64_tr_b16 a[2:3], v247 offset:0
    v_mfma_f32_16x16x32_bf16 v[152:155], a[64:67], a[208:211], v[152:155]
    v_exp_f32 v133, v133
    v_mfma_f32_16x16x32_bf16 v[152:155], a[68:71], a[212:215], v[152:155]
    ds_read_b64_tr_b16 a[4:5], v246 offset:256
    v_cvt_pk_bf16_f32 v180, v132, v133
    v_mfma_f32_16x16x32_bf16 v[156:159], a[68:71], a[244:247], v[156:159]
    ds_read_b64_tr_b16 a[6:7], v247 offset:256
    v_mfma_f32_16x16x32_bf16 v[156:159], a[64:67], a[240:243], v[156:159]
    s_waitcnt lgkmcnt(4)
    v_mfma_f32_16x16x32_bf16 v[144:147], a[72:75], a[152:155], v[144:147]
    ds_read_b64_tr_b16 a[8:9], v246 offset:1024
    v_mfma_f32_16x16x32_bf16 v[144:147], a[76:79], a[156:159], v[144:147]
    v_exp_f32 v134, v134
    v_mfma_f32_16x16x32_bf16 v[148:151], a[76:79], a[188:191], v[148:151]
    buffer_load_dwordx4 v251, s[8:11], s65 offen offset:3072 sc1 lds
    v_mfma_f32_16x16x32_bf16 v[148:151], a[72:75], a[184:187], v[148:151]
    ds_read_b64_tr_b16 a[10:11], v247 offset:1024
    v_mfma_f32_16x16x32_bf16 v[152:155], a[72:75], a[216:219], v[152:155]
    v_exp_f32 v135, v135
    v_mfma_f32_16x16x32_bf16 v[152:155], a[76:79], a[220:223], v[152:155]
    ds_read_b64_tr_b16 a[12:13], v246 offset:1280
    v_cvt_pk_bf16_f32 v181, v134, v135
    v_mfma_f32_16x16x32_bf16 v[156:159], a[76:79], a[252:255], v[156:159]
    ds_read_b64_tr_b16 a[14:15], v247 offset:1280
    v_mfma_f32_16x16x32_bf16 v[156:159], a[72:75], a[248:251], v[156:159]
    s_waitcnt lgkmcnt(4)
    v_mfma_f32_16x16x32_bf16 v[0:3], a[0:3], v[192:195], v[0:3]
    ds_read_b64_tr_b16 a[64:65], v246 offset:2048
    v_mfma_f32_16x16x32_bf16 v[64:67], a[0:3], v[196:199], v[64:67]
    s_mov_b32 m0, s62
    v_exp_f32 v136, v136
    v_mfma_f32_16x16x32_bf16 v[208:211], a[0:3], v[200:203], v[208:211]
    buffer_load_dwordx4 v252, s[8:11], s65 offen offset:0 sc1 lds
    v_mfma_f32_16x16x32_bf16 v[224:227], a[0:3], v[204:207], v[224:227]
    ds_read_b64_tr_b16 a[66:67], v247 offset:2048
    v_mfma_f32_16x16x32_bf16 v[228:231], a[4:7], v[204:207], v[228:231]
    v_exp_f32 v137, v137
    v_mfma_f32_16x16x32_bf16 v[212:215], a[4:7], v[200:203], v[212:215]
    ds_read_b64_tr_b16 a[68:69], v246 offset:2304
    v_cvt_pk_bf16_f32 v184, v136, v137
    v_mfma_f32_16x16x32_bf16 v[68:71], a[4:7], v[196:199], v[68:71]
    ds_read_b64_tr_b16 a[70:71], v247 offset:2304
    v_mfma_f32_16x16x32_bf16 v[4:7], a[4:7], v[192:195], v[4:7]
    s_waitcnt lgkmcnt(4)
    v_mfma_f32_16x16x32_bf16 v[8:11], a[8:11], v[192:195], v[8:11]
    ds_read_b64_tr_b16 a[72:73], v246 offset:3072
    v_mfma_f32_16x16x32_bf16 v[72:75], a[8:11], v[196:199], v[72:75]
    v_exp_f32 v138, v138
    v_mfma_f32_16x16x32_bf16 v[216:219], a[8:11], v[200:203], v[216:219]
    buffer_load_dwordx4 v252, s[8:11], s65 offen offset:1024 sc1 lds
    v_mfma_f32_16x16x32_bf16 v[232:235], a[8:11], v[204:207], v[232:235]
    ds_read_b64_tr_b16 a[74:75], v247 offset:3072
    v_mfma_f32_16x16x32_bf16 v[236:239], a[12:15], v[204:207], v[236:239]
    v_exp_f32 v139, v139
    v_mfma_f32_16x16x32_bf16 v[220:223], a[12:15], v[200:203], v[220:223]
    ds_read_b64_tr_b16 a[76:77], v246 offset:3328
    v_cvt_pk_bf16_f32 v185, v138, v139
    v_mfma_f32_16x16x32_bf16 v[76:79], a[12:15], v[196:199], v[76:79]
    ds_read_b64_tr_b16 a[78:79], v247 offset:3328
    v_mfma_f32_16x16x32_bf16 v[12:15], a[12:15], v[192:195], v[12:15]
    s_waitcnt lgkmcnt(4)
    v_mfma_f32_16x16x32_bf16 v[16:19], a[64:67], v[192:195], v[16:19]
    ds_read_b64_tr_b16 a[0:1], v246 offset:4096
    v_mfma_f32_16x16x32_bf16 v[80:83], a[64:67], v[196:199], v[80:83]
    v_exp_f32 v140, v140
    v_mfma_f32_16x16x32_bf16 a[16:19], a[64:67], v[200:203], a[16:19]
    buffer_load_dwordx4 v252, s[8:11], s65 offen offset:2048 sc1 lds
    v_mfma_f32_16x16x32_bf16 a[80:83], a[64:67], v[204:207], a[80:83]
    ds_read_b64_tr_b16 a[2:3], v247 offset:4096
    v_mfma_f32_16x16x32_bf16 a[84:87], a[68:71], v[204:207], a[84:87]
    v_exp_f32 v141, v141
    v_mfma_f32_16x16x32_bf16 a[20:23], a[68:71], v[200:203], a[20:23]
    ds_read_b64_tr_b16 a[4:5], v246 offset:4352
    v_cvt_pk_bf16_f32 v188, v140, v141
    v_mfma_f32_16x16x32_bf16 v[84:87], a[68:71], v[196:199], v[84:87]
    ds_read_b64_tr_b16 a[6:7], v247 offset:4352
    v_mfma_f32_16x16x32_bf16 v[20:23], a[68:71], v[192:195], v[20:23]
    s_waitcnt lgkmcnt(4)
    v_mfma_f32_16x16x32_bf16 v[24:27], a[72:75], v[192:195], v[24:27]
    ds_read_b64_tr_b16 a[8:9], v246 offset:5120
    v_mfma_f32_16x16x32_bf16 v[88:91], a[72:75], v[196:199], v[88:91]
    v_exp_f32 v142, v142
    v_mfma_f32_16x16x32_bf16 a[24:27], a[72:75], v[200:203], a[24:27]
    buffer_load_dwordx4 v252, s[8:11], s65 offen offset:3072 sc1 lds
    v_mfma_f32_16x16x32_bf16 a[88:91], a[72:75], v[204:207], a[88:91]
    ds_read_b64_tr_b16 a[10:11], v247 offset:5120
    v_mfma_f32_16x16x32_bf16 a[92:95], a[76:79], v[204:207], a[92:95]
    v_exp_f32 v143, v143
    v_mfma_f32_16x16x32_bf16 a[28:31], a[76:79], v[200:203], a[28:31]
    ds_read_b64_tr_b16 a[12:13], v246 offset:5376
    v_cvt_pk_bf16_f32 v189, v142, v143
    v_mfma_f32_16x16x32_bf16 v[92:95], a[76:79], v[196:199], v[92:95]
    ds_read_b64_tr_b16 a[14:15], v247 offset:5376
    v_mfma_f32_16x16x32_bf16 v[28:31], a[76:79], v[192:195], v[28:31]
    s_waitcnt lgkmcnt(4)
    v_mfma_f32_16x16x32_bf16 v[32:35], a[0:3], v[192:195], v[32:35]
    ds_read_b64_tr_b16 a[64:65], v246 offset:6144
    v_mfma_f32_16x16x32_bf16 v[96:99], a[0:3], v[196:199], v[96:99]
    s_add_u32 m0, s62, 0x1000
    v_exp_f32 v144, v144
    v_mfma_f32_16x16x32_bf16 a[32:35], a[0:3], v[200:203], a[32:35]
    buffer_load_dwordx4 v253, s[8:11], s65 offen offset:0 sc1 lds
    v_mfma_f32_16x16x32_bf16 a[96:99], a[0:3], v[204:207], a[96:99]
    ds_read_b64_tr_b16 a[66:67], v247 offset:6144
    v_mfma_f32_16x16x32_bf16 a[100:103], a[4:7], v[204:207], a[100:103]
    v_exp_f32 v145, v145
    v_mfma_f32_16x16x32_bf16 a[36:39], a[4:7], v[200:203], a[36:39]
    ds_read_b64_tr_b16 a[68:69], v246 offset:6400
    v_cvt_pk_bf16_f32 v178, v144, v145
    v_mfma_f32_16x16x32_bf16 v[100:103], a[4:7], v[196:199], v[100:103]
    ds_read_b64_tr_b16 a[70:71], v247 offset:6400
    v_mfma_f32_16x16x32_bf16 v[36:39], a[4:7], v[192:195], v[36:39]
    s_waitcnt lgkmcnt(4)
    v_mfma_f32_16x16x32_bf16 v[40:43], a[8:11], v[192:195], v[40:43]
    ds_read_b64_tr_b16 a[72:73], v246 offset:7168
    v_mfma_f32_16x16x32_bf16 v[104:107], a[8:11], v[196:199], v[104:107]
    v_exp_f32 v146, v146
    v_mfma_f32_16x16x32_bf16 a[40:43], a[8:11], v[200:203], a[40:43]
    buffer_load_dwordx4 v253, s[8:11], s65 offen offset:1024 sc1 lds
    v_mfma_f32_16x16x32_bf16 a[104:107], a[8:11], v[204:207], a[104:107]
    ds_read_b64_tr_b16 a[74:75], v247 offset:7168
    v_mfma_f32_16x16x32_bf16 a[108:111], a[12:15], v[204:207], a[108:111]
    v_exp_f32 v147, v147
    v_mfma_f32_16x16x32_bf16 a[44:47], a[12:15], v[200:203], a[44:47]
    ds_read_b64_tr_b16 a[76:77], v246 offset:7424
    v_cvt_pk_bf16_f32 v179, v146, v147
    v_mfma_f32_16x16x32_bf16 v[108:111], a[12:15], v[196:199], v[108:111]
    ds_read_b64_tr_b16 a[78:79], v247 offset:7424
    v_mfma_f32_16x16x32_bf16 v[44:47], a[12:15], v[192:195], v[44:47]
    s_waitcnt lgkmcnt(4)
    v_add_u32 v246, s64, v249
    v_add_u32 v247, s60, v249
    v_mfma_f32_16x16x32_bf16 v[48:51], a[64:67], v[192:195], v[48:51]
    v_exp_f32 v148, v148
    v_mfma_f32_16x16x32_bf16 v[112:115], a[64:67], v[196:199], v[112:115]
    v_exp_f32 v149, v149
    v_mfma_f32_16x16x32_bf16 a[48:51], a[64:67], v[200:203], a[48:51]
    buffer_load_dwordx4 v253, s[8:11], s65 offen offset:2048 sc1 lds
    v_mfma_f32_16x16x32_bf16 a[112:115], a[64:67], v[204:207], a[112:115]
    v_cvt_pk_bf16_f32 v182, v148, v149
    v_mfma_f32_16x16x32_bf16 a[116:119], a[68:71], v[204:207], a[116:119]
    v_mfma_f32_16x16x32_bf16 a[52:55], a[68:71], v[200:203], a[52:55]
    s_waitcnt vmcnt(13)
    ds_read_b128 a[0:3], v244 offset:0
    v_mfma_f32_16x16x32_bf16 v[116:119], a[68:71], v[196:199], v[116:119]
    ds_read_b128 a[4:7], v244 offset:1024
    v_mfma_f32_16x16x32_bf16 v[52:55], a[68:71], v[192:195], v[52:55]
    s_waitcnt lgkmcnt(2)
    v_exp_f32 v150, v150
    v_mfma_f32_16x16x32_bf16 v[56:59], a[72:75], v[192:195], v[56:59]
    v_exp_f32 v151, v151
    v_mfma_f32_16x16x32_bf16 v[120:123], a[72:75], v[196:199], v[120:123]
    v_cvt_pk_bf16_f32 v183, v150, v151
    v_mfma_f32_16x16x32_bf16 a[56:59], a[72:75], v[200:203], a[56:59]
    buffer_load_dwordx4 v253, s[8:11], s65 offen offset:3072 sc1 lds
    v_mfma_f32_16x16x32_bf16 a[120:123], a[72:75], v[204:207], a[120:123]
    s_add_u32 s65, s65, 0x10000
    v_mfma_f32_16x16x32_bf16 a[124:127], a[76:79], v[204:207], a[124:127]
    v_mfma_f32_16x16x32_bf16 a[60:63], a[76:79], v[200:203], a[60:63]
    s_waitcnt vmcnt(12)
    ds_read_b128 a[8:11], v244 offset:2048
    v_mfma_f32_16x16x32_bf16 v[124:127], a[76:79], v[196:199], v[124:127]
    s_sub_u32 s34, s34, 1
    ds_read_b128 a[12:15], v244 offset:3072
    v_mfma_f32_16x16x32_bf16 v[60:63], a[76:79], v[192:195], v[60:63]
    s_waitcnt lgkmcnt(2)
    s_cbranch_scc1 L_itL
L_itA:
    v_mfma_f32_16x16x32_bf16 v[128:131], a[0:3], a[128:131], v[160:163]
    v_exp_f32 v152, v152
    v_mfma_f32_16x16x32_bf16 v[128:131], a[4:7], a[132:135], v[128:131]
    s_mov_b32 m0, s63
    v_exp_f32 v153, v153
    v_mfma_f32_16x16x32_bf16 v[132:135], a[4:7], a[164:167], v[164:167]
    buffer_load_dwordx4 v250, s[8:11], s65 offen offset:0 sc1 lds
    v_mfma_f32_16x16x32_bf16 v[132:135], a[0:3], a[160:163], v[132:135]
    s_waitcnt vmcnt(20)
    v_cvt_pk_bf16_f32 v186, v152, v153
    v_mfma_f32_16x16x32_bf16 v[136:139], a[0:3], a[192:195], v[168:171]
    buffer_store_dword v255, v254, s[8:11], s43 offen sc1
    v_mfma_f32_16x16x32_bf16 v[136:139], a[4:7], a[196:199], v[136:139]
    s_waitcnt vmcnt(12)
    ds_read_b128 a[64:67], v244 offset:4096
    v_mfma_f32_16x16x32_bf16 v[140:143], a[4:7], a[228:231], v[172:175]
    s_mov_b32 s43, 0x7fff0000
    ds_read_b128 a[68:71], v244 offset:5120
    v_mfma_f32_16x16x32_bf16 v[140:143], a[0:3], a[224:227], v[140:143]
    s_waitcnt lgkmcnt(2)
    v_mfma_f32_16x16x32_bf16 v[128:131], a[8:11], a[136:139], v[128:131]
    v_exp_f32 v154, v154
    v_mfma_f32_16x16x32_bf16 v[128:131], a[12:15], a[140:143], v[128:131]
    v_exp_f32 v155, v155
    v_mfma_f32_16x16x32_bf16 v[132:135], a[12:15], a[172:175], v[132:135]
    buffer_load_dwordx4 v250, s[8:11], s65 offen offset:1024 sc1 lds
    v_mfma_f32_16x16x32_bf16 v[132:135], a[8:11], a[168:171], v[132:135]
    v_cvt_pk_bf16_f32 v187, v154, v155
    v_mfma_f32_16x16x32_bf16 v[136:139], a[8:11], a[200:203], v[136:139]
    v_mfma_f32_16x16x32_bf16 v[136:139], a[12:15], a[204:207], v[136:139]
    s_waitcnt vmcnt(11)
    ds_read_b128 a[72:75], v244 offset:6144
    v_mfma_f32_16x16x32_bf16 v[140:143], a[12:15], a[236:239], v[140:143]
    ds_read_b128 a[76:79], v244 offset:7168
    v_mfma_f32_16x16x32_bf16 v[140:143], a[8:11], a[232:235], v[140:143]
    s_waitcnt lgkmcnt(2)
    v_add_u32 v244, s63, v248
    v_mfma_f32_16x16x32_bf16 v[128:131], a[64:67], a[144:147], v[128:131]
    v_exp_f32 v156, v156
    v_mfma_f32_16x16x32_bf16 v[128:131], a[68:71], a[148:151], v[128:131]
    v_exp_f32 v157, v157
    v_mfma_f32_16x16x32_bf16 v[132:135], a[68:71], a[180:183], v[132:135]
    buffer_load_dwordx4 v250, s[8:11], s65 offen offset:2048 sc1 lds
    v_mfma_f32_16x16x32_bf16 v[132:135], a[64:67], a[176:179], v[132:135]
    v_cvt_pk_bf16_f32 v190, v156, v157
    v_mfma_f32_16x16x32_bf16 v[136:139], a[64:67], a[208:211], v[136:139]
    v_mfma_f32_16x16x32_bf16 v[136:139], a[68:71], a[212:215], v[136:139]
    s_waitcnt vmcnt(10)
    ds_read_b128 a[0:3], v245 offset:0
    v_mfma_f32_16x16x32_bf16 v[140:143], a[68:71], a[244:247], v[140:143]
    ds_read_b128 a[4:7], v245 offset:1024
    v_mfma_f32_16x16x32_bf16 v[140:143], a[64:67], a[240:243], v[140:143]
    s_waitcnt lgkmcnt(2)
    v_mfma_f32_16x16x32_bf16 v[128:131], a[72:75], a[152:155], v[128:131]
    v_exp_f32 v158, v158
    v_mfma_f32_16x16x32_bf16 v[128:131], a[76:79], a[156:159], v[128:131]
    v_exp_f32 v159, v159
    v_mfma_f32_16x16x32_bf16 v[132:135], a[76:79], a[188:191], v[132:135]
    buffer_load_dwordx4 v250, s[8:11], s65 offen offset:3072 sc1 lds
    v_mfma_f32_16x16x32_bf16 v[132:135], a[72:75], a[184:187], v[132:135]
    v_cvt_pk_bf16_f32 v191, v158, v159
    v_mfma_f32_16x16x32_bf16 v[136:139], a[72:75], a[216:219], v[136:139]
    v_mfma_f32_16x16x32_bf16 v[136:139], a[76:79], a[220:223], v[136:139]
    s_waitcnt vmcnt(9)
    ds_read_b128 a[8:11], v245 offset:2048
    v_mfma_f32_16x16x32_bf16 v[140:143], a[76:79], a[252:255], v[140:143]
    ds_read_b128 a[12:15], v245 offset:3072
    v_mfma_f32_16x16x32_bf16 v[140:143], a[72:75], a[248:251], v[140:143]
    s_waitcnt lgkmcnt(2)
    v_mfma_f32_16x16x32_bf16 v[144:147], a[0:3], a[128:131], v[160:163]
    v_exp_f32 v128, v128
    v_mfma_f32_16x16x32_bf16 v[144:147], a[4:7], a[132:135], v[144:147]
    s_add_u32 m0, s63, 0x1000
    v_exp_f32 v129, v129
    v_mfma_f32_16x16x32_bf16 v[148:151], a[4:7], a[164:167], v[164:167]
    buffer_load_dwordx4 v251, s[8:11], s65 offen offset:0 sc1 lds
    v_mfma_f32_16x16x32_bf16 v[148:151], a[0:3], a[160:163], v[148:151]
    v_cvt_pk_bf16_f32 v192, v128, v129
    v_mfma_f32_16x16x32_bf16 v[152:155], a[0:3], a[192:195], v[168:171]
    v_mfma_f32_16x16x32_bf16 v[152:155], a[4:7], a[196:199], v[152:155]
    s_waitcnt vmcnt(8)
    ds_read_b128 a[64:67], v245 offset:4096
    v_mfma_f32_16x16x32_bf16 v[156:159], a[4:7], a[228:231], v[172:175]
    ds_read_b128 a[68:71], v245 offset:5120
    v_mfma_f32_16x16x32_bf16 v[156:159], a[0:3], a[224:227], v[156:159]
    s_waitcnt lgkmcnt(2)
    v_mfma_f32_16x16x32_bf16 v[144:147], a[8:11], a[136:139], v[144:147]
    v_exp_f32 v130, v130
    v_mfma_f32_16x16x32_bf16 v[144:147], a[12:15], a[140:143], v[144:147]
    v_exp_f32 v131, v131
    v_mfma_f32_16x16x32_bf16 v[148:151], a[12:15], a[172:175], v[148:151]
    buffer_load_dwordx4 v251, s[8:11], s65 offen offset:1024 sc1 lds
    v_mfma_f32_16x16x32_bf16 v[148:151], a[8:11], a[168:171], v[148:151]
    v_cvt_pk_bf16_f32 v193, v130, v131
    v_mfma_f32_16x16x32_bf16 v[152:155], a[8:11], a[200:203], v[152:155]
    v_mfma_f32_16x16x32_bf16 v[152:155], a[12:15], a[204:207], v[152:155]
    s_waitcnt vmcnt(7)
    ds_read_b128 a[72:75], v245 offset:6144
    v_mfma_f32_16x16x32_bf16 v[156:159], a[12:15], a[236:239], v[156:159]
    ds_read_b128 a[76:79], v245 offset:7168
    v_mfma_f32_16x16x32_bf16 v[156:159], a[8:11], a[232:235], v[156:159]
    s_waitcnt lgkmcnt(2)
    v_add_u32 v245, s64, v248
    v_mfma_f32_16x16x32_bf16 v[144:147], a[64:67], a[144:147], v[144:147]
    ds_read_b64_tr_b16 a[0:1], v246 offset:0
    v_mfma_f32_16x16x32_bf16 v[144:147], a[68:71], a[148:151], v[144:147]
    v_exp_f32 v132, v132
    v_mfma_f32_16x16x32_bf16 v[148:151], a[68:71], a[180:183], v[148:151]
    buffer_load_dwordx4 v251, s[8:11], s65 offen offset:2048 sc1 lds
    v_mfma_f32_16x16x32_bf16 v[148:151], a[64:67], a[176:179], v[148:151]
    ds_read_b64_tr_b16 a[2:3], v247 offset:0
    v_mfma_f32_16x16x32_bf16 v[152:155], a[64:67], a[208:211], v[152:155]
    v_exp_f32 v133, v133
    v_mfma_f32_16x16x32_bf16 v[152:155], a[68:71], a[212:215], v[152:155]
    ds_read_b64_tr_b16 a[4:5], v246 offset:256
    v_cvt_pk_bf16_f32 v196, v132, v133
    v_mfma_f32_16x16x32_bf16 v[156:159], a[68:71], a[244:247], v[156:159]
    ds_read_b64_tr_b16 a[6:7], v247 offset:256
    v_mfma_f32_16x16x32_bf16 v[156:159], a[64:67], a[240:243], v[156:159]
    s_waitcnt lgkmcnt(4)
    v_mfma_f32_16x16x32_bf16 v[144:147], a[72:75], a[152:155], v[144:147]
    ds_read_b64_tr_b16 a[8:9], v246 offset:1024
    v_mfma_f32_16x16x32_bf16 v[144:147], a[76:79], a[156:159], v[144:147]
    v_exp_f32 v134, v134
    v_mfma_f32_16x16x32_bf16 v[148:151], a[76:79], a[188:191], v[148:151]
    buffer_load_dwordx4 v251, s[8:11], s65 offen offset:3072 sc1 lds
    v_mfma_f32_16x16x32_bf16 v[148:151], a[72:75], a[184:187], v[148:151]
    ds_read_b64_tr_b16 a[10:11], v247 offset:1024
    v_mfma_f32_16x16x32_bf16 v[152:155], a[72:75], a[216:219], v[152:155]
    v_exp_f32 v135, v135
    v_mfma_f32_16x16x32_bf16 v[152:155], a[76:79], a[220:223], v[152:155]
    ds_read_b64_tr_b16 a[12:13], v246 offset:1280
    v_cvt_pk_bf16_f32 v197, v134, v135
    v_mfma_f32_16x16x32_bf16 v[156:159], a[76:79], a[252:255], v[156:159]
    ds_read_b64_tr_b16 a[14:15], v247 offset:1280
    v_mfma_f32_16x16x32_bf16 v[156:159], a[72:75], a[248:251], v[156:159]
    s_waitcnt lgkmcnt(4)
    v_mfma_f32_16x16x32_bf16 v[0:3], a[0:3], v[176:179], v[0:3]
    ds_read_b64_tr_b16 a[64:65], v246 offset:2048
    v_mfma_f32_16x16x32_bf16 v[64:67], a[0:3], v[180:183], v[64:67]
    s_mov_b32 m0, s64
    v_exp_f32 v136, v136
    v_mfma_f32_16x16x32_bf16 v[208:211], a[0:3], v[184:187], v[208:211]
    buffer_load_dwordx4 v252, s[8:11], s65 offen offset:0 sc1 lds
    v_mfma_f32_16x16x32_bf16 v[224:227], a[0:3], v[188:191], v[224:227]
    ds_read_b64_tr_b16 a[66:67], v247 offset:2048
    v_mfma_f32_16x16x32_bf16 v[228:231], a[4:7], v[188:191], v[228:231]
    v_exp_f32 v137, v137
    v_mfma_f32_16x16x32_bf16 v[212:215], a[4:7], v[184:187], v[212:215]
    ds_read_b64_tr_b16 a[68:69], v246 offset:2304
    v_cvt_pk_bf16_f32 v200, v136, v137
    v_mfma_f32_16x16x32_bf16 v[68:71], a[4:7], v[180:183], v[68:71]
    ds_read_b64_tr_b16 a[70:71], v247 offset:2304
    v_mfma_f32_16x16x32_bf16 v[4:7], a[4:7], v[176:179], v[4:7]
    s_waitcnt lgkmcnt(4)
    v_mfma_f32_16x16x32_bf16 v[8:11], a[8:11], v[176:179], v[8:11]
    ds_read_b64_tr_b16 a[72:73], v246 offset:3072
    v_mfma_f32_16x16x32_bf16 v[72:75], a[8:11], v[180:183], v[72:75]
    v_exp_f32 v138, v138
    v_mfma_f32_16x16x32_bf16 v[216:219], a[8:11], v[184:187], v[216:219]
    buffer_load_dwordx4 v252, s[8:11], s65 offen offset:1024 sc1 lds
    v_mfma_f32_16x16x32_bf16 v[232:235], a[8:11], v[188:191], v[232:235]
    ds_read_b64_tr_b16 a[74:75], v247 offset:3072
    v_mfma_f32_16x16x32_bf16 v[236:239], a[12:15], v[188:191], v[236:239]
    v_exp_f32 v139, v139
    v_mfma_f32_16x16x32_bf16 v[220:223], a[12:15], v[184:187], v[220:223]
    ds_read_b64_tr_b16 a[76:77], v246 offset:3328
    v_cvt_pk_bf16_f32 v201, v138, v139
    v_mfma_f32_16x16x32_bf16 v[76:79], a[12:15], v[180:183], v[76:79]
    ds_read_b64_tr_b16 a[78:79], v247 offset:3328
    v_mfma_f32_16x16x32_bf16 v[12:15], a[12:15], v[176:179], v[12:15]
    s_waitcnt lgkmcnt(4)
    v_mfma_f32_16x16x32_bf16 v[16:19], a[64:67], v[176:179], v[16:19]
    ds_read_b64_tr_b16 a[0:1], v246 offset:4096
    v_mfma_f32_16x16x32_bf16 v[80:83], a[64:67], v[180:183], v[80:83]
    v_exp_f32 v140, v140
    v_mfma_f32_16x16x32_bf16 a[16:19], a[64:67], v[184:187], a[16:19]
    buffer_load_dwordx4 v252, s[8:11], s65 offen offset:2048 sc1 lds
    v_mfma_f32_16x16x32_bf16 a[80:83], a[64:67], v[188:191], a[80:83]
    ds_read_b64_tr_b16 a[2:3], v247 offset:4096
    v_mfma_f32_16x16x32_bf16 a[84:87], a[68:71], v[188:191], a[84:87]
    v_exp_f32 v141, v141
    v_mfma_f32_16x16x32_bf16 a[20:23], a[68:71], v[184:187], a[20:23]
    ds_read_b64_tr_b16 a[4:5], v246 offset:4352
    v_cvt_pk_bf16_f32 v204, v140, v141
    v_mfma_f32_16x16x32_bf16 v[84:87], a[68:71], v[180:183], v[84:87]
    ds_read_b64_tr_b16 a[6:7], v247 offset:4352
    v_mfma_f32_16x16x32_bf16 v[20:23], a[68:71], v[176:179], v[20:23]
    s_waitcnt lgkmcnt(4)
    v_mfma_f32_16x16x32_bf16 v[24:27], a[72:75], v[176:179], v[24:27]
    ds_read_b64_tr_b16 a[8:9], v246 offset:5120
    v_mfma_f32_16x16x32_bf16 v[88:91], a[72:75], v[180:183], v[88:91]
    v_exp_f32 v142, v142
    v_mfma_f32_16x16x32_bf16 a[24:27], a[72:75], v[184:187], a[24:27]
    buffer_load_dwordx4 v252, s[8:11], s65 offen offset:3072 sc1 lds
    v_mfma_f32_16x16x32_bf16 a[88:91], a[72:75], v[188:191], a[88:91]
    ds_read_b64_tr_b16 a[10:11], v247 offset:5120
    v_mfma_f32_16x16x32_bf16 a[92:95], a[76:79], v[188:191], a[92:95]
    v_exp_f32 v143, v143
    v_mfma_f32_16x16x32_bf16 a[28:31], a[76:79], v[184:187], a[28:31]
    ds_read_b64_tr_b16 a[12:13], v246 offset:5376
    v_cvt_pk_bf16_f32 v205, v142, v143
    v_mfma_f32_16x16x32_bf16 v[92:95], a[76:79], v[180:183], v[92:95]
    ds_read_b64_tr_b16 a[14:15], v247 offset:5376
    v_mfma_f32_16x16x32_bf16 v[28:31], a[76:79], v[176:179], v[28:31]
    s_waitcnt lgkmcnt(4)
    v_mfma_f32_16x16x32_bf16 v[32:35], a[0:3], v[176:179], v[32:35]
    ds_read_b64_tr_b16 a[64:65], v246 offset:6144
    v_mfma_f32_16x16x32_bf16 v[96:99], a[0:3], v[180:183], v[96:99]
    s_add_u32 m0, s64, 0x1000
    v_exp_f32 v144, v144
    v_mfma_f32_16x16x32_bf16 a[32:35], a[0:3], v[184:187], a[32:35]
    buffer_load_dwordx4 v253, s[8:11], s65 offen offset:0 sc1 lds
    v_mfma_f32_16x16x32_bf16 a[96:99], a[0:3], v[188:191], a[96:99]
    ds_read_b64_tr_b16 a[66:67], v247 offset:6144
    v_mfma_f32_16x16x32_bf16 a[100:103], a[4:7], v[188:191], a[100:103]
    v_exp_f32 v145, v145
    v_mfma_f32_16x16x32_bf16 a[36:39], a[4:7], v[184:187], a[36:39]
    ds_read_b64_tr_b16 a[68:69], v246 offset:6400
    v_cvt_pk_bf16_f32 v194, v144, v145
    v_mfma_f32_16x16x32_bf16 v[100:103], a[4:7], v[180:183], v[100:103]
    ds_read_b64_tr_b16 a[70:71], v247 offset:6400
    v_mfma_f32_16x16x32_bf16 v[36:39], a[4:7], v[176:179], v[36:39]
    s_waitcnt lgkmcnt(4)
    v_mfma_f32_16x16x32_bf16 v[40:43], a[8:11], v[176:179], v[40:43]
    ds_read_b64_tr_b16 a[72:73], v246 offset:7168
    v_mfma_f32_16x16x32_bf16 v[104:107], a[8:11], v[180:183], v[104:107]
    v_exp_f32 v146, v146
    v_mfma_f32_16x16x32_bf16 a[40:43], a[8:11], v[184:187], a[40:43]
    buffer_load_dwordx4 v253, s[8:11], s65 offen offset:1024 sc1 lds
    v_mfma_f32_16x16x32_bf16 a[104:107], a[8:11], v[188:191], a[104:107]
    ds_read_b64_tr_b16 a[74:75], v247 offset:7168
    v_mfma_f32_16x16x32_bf16 a[108:111], a[12:15], v[188:191], a[108:111]
    v_exp_f32 v147, v147
    v_mfma_f32_16x16x32_bf16 a[44:47], a[12:15], v[184:187], a[44:47]
    ds_read_b64_tr_b16 a[76:77], v246 offset:7424
    v_cvt_pk_bf16_f32 v195, v146, v147
    v_mfma_f32_16x16x32_bf16 v[108:111], a[12:15], v[180:183], v[108:111]
    ds_read_b64_tr_b16 a[78:79], v247 offset:7424
    v_mfma_f32_16x16x32_bf16 v[44:47], a[12:15], v[176:179], v[44:47]
    s_waitcnt lgkmcnt(4)
    v_add_u32 v246, s61, v249
    v_add_u32 v247, s62, v249
    v_mfma_f32_16x16x32_bf16 v[48:51], a[64:67], v[176:179], v[48:51]
    s_mov_b32 s35, s64
    v_exp_f32 v148, v148
    v_mfma_f32_16x16x32_bf16 v[112:115], a[64:67], v[180:183], v[112:115]
    s_mov_b32 s64, s63
    v_exp_f32 v149, v149
    v_mfma_f32_16x16x32_bf16 a[48:51], a[64:67], v[184:187], a[48:51]
    buffer_load_dwordx4 v253, s[8:11], s65 offen offset:2048 sc1 lds
    v_mfma_f32_16x16x32_bf16 a[112:115], a[64:67], v[188:191], a[112:115]
    s_mov_b32 s63, s62
    v_cvt_pk_bf16_f32 v198, v148, v149
    v_mfma_f32_16x16x32_bf16 a[116:119], a[68:71], v[188:191], a[116:119]
    s_mov_b32 s62, s61
    v_mfma_f32_16x16x32_bf16 a[52:55], a[68:71], v[184:187], a[52:55]
    s_waitcnt vmcnt(13)
    ds_read_b128 a[0:3], v244 offset:0
    v_mfma_f32_16x16x32_bf16 v[116:119], a[68:71], v[180:183], v[116:119]
    s_mov_b32 s61, s60
    ds_read_b128 a[4:7], v244 offset:1024
    v_mfma_f32_16x16x32_bf16 v[52:55], a[68:71], v[176:179], v[52:55]
    s_waitcnt lgkmcnt(2)
    v_exp_f32 v150, v150
    v_mfma_f32_16x16x32_bf16 v[56:59], a[72:75], v[176:179], v[56:59]
    s_mov_b32 s60, s35
    v_exp_f32 v151, v151
    v_mfma_f32_16x16x32_bf16 v[120:123], a[72:75], v[180:183], v[120:123]
    v_cvt_pk_bf16_f32 v199, v150, v151
    v_mfma_f32_16x16x32_bf16 a[56:59], a[72:75], v[184:187], a[56:59]
    buffer_load_dwordx4 v253, s[8:11], s65 offen offset:3072 sc1 lds
    v_mfma_f32_16x16x32_bf16 a[120:123], a[72:75], v[188:191], a[120:123]
    s_add_u32 s65, s65, 0x10000
    v_mfma_f32_16x16x32_bf16 a[124:127], a[76:79], v[188:191], a[124:127]
    v_mfma_f32_16x16x32_bf16 a[60:63], a[76:79], v[184:187], a[60:63]
    s_waitcnt vmcnt(12)
    ds_read_b128 a[8:11], v244 offset:2048
    v_mfma_f32_16x16x32_bf16 v[124:127], a[76:79], v[180:183], v[124:127]
    s_sub_u32 s34, s34, 1
    ds_read_b128 a[12:15], v244 offset:3072
    v_mfma_f32_16x16x32_bf16 v[60:63], a[76:79], v[176:179], v[60:63]
    s_waitcnt lgkmcnt(2)
    s_cbranch_scc0 L_itB
    s_mov_b32 s61, s64
    s_mov_b32 s62, s60
    v_mov_b32 v176, v192
    v_mov_b32 v177, v193
    v_mov_b32 v178, v194
    v_mov_b32 v179, v195
    v_mov_b32 v180, v196
    v_mov_b32 v181, v197
    v_mov_b32 v182, v198
    v_mov_b32 v183, v199
    v_mov_b32 v184, v200
    v_mov_b32 v185, v201
    v_mov_b32 v186, v202
    v_mov_b32 v187, v203
    v_mov_b32 v188, v204
    v_mov_b32 v189, v205
    v_mov_b32 v190, v206
    v_mov_b32 v191, v207
L_itL:
    v_mfma_f32_16x16x32_bf16 v[128:131], a[0:3], a[128:131], v[160:163]
    s_mov_b32 s35, 262144
    v_and_b32 v254, 0xf0, v250
    v_and_b32 v248, 0x380, v250
    v_mfma_f32_16x16x32_bf16 v[128:131], a[4:7], a[132:135], v[128:131]
    buffer_load_dword v255, v254, s[8:11], s56 offen sc1
    v_mfma_f32_16x16x32_bf16 v[132:135], a[4:7], a[164:167], v[164:167]
    buffer_load_dword v254, v254, s[8:11], s35 offen sc1
    v_mfma_f32_16x16x32_bf16 v[132:135], a[0:3], a[160:163], v[132:135]
    s_add_u32 s71, s73, 786432
    s_add_u32 s72, s71, 16384
    s_lshr_b32 s70, s2, 3
    v_mfma_f32_16x16x32_bf16 v[136:139], a[0:3], a[192:195], v[168:171]
    s_lshl_b32 s70, s70, 10
    s_add_u32 s70, s70, s71
    s_sub_u32 s77, s70, 131072
    v_mfma_f32_16x16x32_bf16 v[136:139], a[4:7], a[196:199], v[136:139]
    s_waitcnt vmcnt(12)
    ds_read_b128 a[64:67], v244 offset:4096
    ds_read_b128 a[68:71], v244 offset:5120
    v_mfma_f32_16x16x32_bf16 v[140:143], a[4:7], a[228:231], v[172:175]
    v_exp_f32 v152, v152
    v_mfma_f32_16x16x32_bf16 v[140:143], a[0:3], a[224:227], v[140:143]
    s_waitcnt lgkmcnt(2)
    v_exp_f32 v153, v153
    v_mfma_f32_16x16x32_bf16 v[128:131], a[8:11], a[136:139], v[128:131]
    s_add_u32 m0, s73, 16384
    v_mad_u32_u24 v248, v248, 3, v250
    v_cvt_pk_bf16_f32 v186, v152, v153
    v_mfma_f32_16x16x32_bf16 v[128:131], a[12:15], a[140:143], v[128:131]
    s_add_u32 s65, s45, 0
    v_exp_f32 v154, v154
    v_mfma_f32_16x16x32_bf16 v[132:135], a[12:15], a[172:175], v[132:135]
    buffer_load_dwordx4 v248, s[12:15], s65 offen lds
    v_mfma_f32_16x16x32_bf16 v[132:135], a[8:11], a[168:171], v[132:135]
    v_exp_f32 v155, v155
    v_mfma_f32_16x16x32_bf16 v[136:139], a[8:11], a[200:203], v[136:139]
    v_exp_f32 v156, v156
    v_mfma_f32_16x16x32_bf16 v[136:139], a[12:15], a[204:207], v[136:139]
    s_waitcnt vmcnt(11)
    ds_read_b128 a[72:75], v244 offset:6144
    ds_read_b128 a[76:79], v244 offset:7168
    v_mfma_f32_16x16x32_bf16 v[140:143], a[12:15], a[236:239], v[140:143]
    v_exp_f32 v157, v157
    v_mfma_f32_16x16x32_bf16 v[140:143], a[8:11], a[232:235], v[140:143]
    s_waitcnt lgkmcnt(2)
    v_exp_f32 v158, v158
    v_mfma_f32_16x16x32_bf16 v[128:131], a[64:67], a[144:147], v[128:131]
    s_add_u32 m0, s73, 17408
    v_exp_f32 v159, v159
    v_mfma_f32_16x16x32_bf16 v[128:131], a[68:71], a[148:151], v[128:131]
    s_add_u32 s65, s45, 4096
    v_cvt_pk_bf16_f32 v187, v154, v155
    v_cvt_pk_bf16_f32 v190, v156, v157
    v_mfma_f32_16x16x32_bf16 v[132:135], a[68:71], a[180:183], v[132:135]
    buffer_load_dwordx4 v248, s[12:15], s65 offen lds
    v_mfma_f32_16x16x32_bf16 v[132:135], a[64:67], a[176:179], v[132:135]
L_pad4:
    s_cbranch_execz L_pad8
    v_cvt_pk_bf16_f32 v191, v158, v159
    v_mfma_f32_16x16x32_bf16 v[136:139], a[64:67], a[208:211], v[136:139]
    v_mfma_f32_16x16x32_bf16 v[136:139], a[68:71], a[212:215], v[136:139]
    s_waitcnt vmcnt(10)
    ds_read_b128 a[0:3], v245 offset:0
    ds_read_b128 a[4:7], v245 offset:1024
    v_mfma_f32_16x16x32_bf16 v[140:143], a[68:71], a[244:247], v[140:143]
    v_mfma_f32_16x16x32_bf16 v[140:143], a[64:67], a[240:243], v[140:143]
    s_waitcnt lgkmcnt(2)
    v_mfma_f32_16x16x32_bf16 v[128:131], a[72:75], a[152:155], v[128:131]
    s_add_u32 m0, s73, 18432
    v_mfma_f32_16x16x32_bf16 v[128:131], a[76:79], a[156:159], v[128:131]
    s_add_u32 s65, s45, 8192
    v_mfma_f32_16x16x32_bf16 v[132:135], a[76:79], a[188:191], v[132:135]
    buffer_load_dwordx4 v248, s[12:15], s65 offen lds
    v_mfma_f32_16x16x32_bf16 v[132:135], a[72:75], a[184:187], v[132:135]
    v_mfma_f32_16x16x32_bf16 v[136:139], a[72:75], a[216:219], v[136:139]
    v_mfma_f32_16x16x32_bf16 v[136:139], a[76:79], a[220:223], v[136:139]
    s_waitcnt vmcnt(9)
    ds_read_b128 a[8:11], v245 offset:2048
    ds_read_b128 a[12:15], v245 offset:3072
    v_mfma_f32_16x16x32_bf16 v[140:143], a[76:79], a[252:255], v[140:143]
    v_exp_f32 v128, v128
    v_mfma_f32_16x16x32_bf16 v[140:143], a[72:75], a[248:251], v[140:143]
    s_waitcnt lgkmcnt(2)
    v_exp_f32 v129, v129
    v_mfma_f32_16x16x32_bf16 v[144:147], a[0:3], a[128:131], v[160:163]
    s_add_u32 m0, s73, 19456
    v_exp_f32 v130, v130
    v_mfma_f32_16x16x32_bf16 v[144:147], a[4:7], a[132:135], v[144:147]
    s_add_u32 s65, s45, 12288
    v_exp_f32 v131, v131
    v_mfma_f32_16x16x32_bf16 v[148:151], a[4:7], a[164:167], v[164:167]
    buffer_load_dwordx4 v248, s[12:15], s65 offen lds
    v_mfma_f32_16x16x32_bf16 v[148:151], a[0:3], a[160:163], v[148:151]
    v_exp_f32 v132, v132
    v_mfma_f32_16x16x32_bf16 v[152:155], a[0:3], a[192:195], v[168:171]
    v_exp_f32 v133, v133
    v_mfma_f32_16x16x32_bf16 v[152:155], a[4:7], a[196:199], v[152:155]
    s_waitcnt vmcnt(8)
    ds_read_b128 a[64:67], v245 offset:4096
    ds_read_b128 a[68:71], v245 offset:5120
    v_mfma_f32_16x16x32_bf16 v[156:159], a[4:7], a[228:231], v[172:175]
    v_cvt_pk_bf16_f32 v192, v128, v129
    v_cvt_pk_bf16_f32 v193, v130, v131
    v_mfma_f32_16x16x32_bf16 v[156:159], a[0:3], a[224:227], v[156:159]
    s_waitcnt lgkmcnt(2)
    v_exp_f32 v134, v134
    v_mfma_f32_16x16x32_bf16 v[144:147], a[8:11], a[136:139], v[144:147]
    v_exp_f32 v135, v135
    v_mfma_f32_16x16x32_bf16 v[144:147], a[12:15], a[140:143], v[144:147]
    s_waitcnt vmcnt(4)
    v_cmp_eq_u32 vcc, s4, v254
    v_cmp_eq_u32 s[68:69], s4, v255
    v_mfma_f32_16x16x32_bf16 v[148:151], a[12:15], a[172:175], v[148:151]
    v_exp_f32 v136, v136
    v_mfma_f32_16x16x32_bf16 v[148:151], a[8:11], a[168:171], v[148:151]
    s_and_b64 vcc, vcc, s[68:69]
    s_cmp_eq_u64 vcc, -1
    s_cbranch_scc0 L_hlate
L_hok:
    v_mfma_f32_16x16x32_bf16 v[152:155], a[8:11], a[200:203], v[152:155]
    buffer_load_dword v255, v250, s[8:11], s70 offen sc1
    v_mfma_f32_16x16x32_bf16 v[152:155], a[12:15], a[204:207], v[152:155]
    s_waitcnt vmcnt(7)
    ds_read_b128 a[72:75], v245 offset:6144
    ds_read_b128 a[76:79], v245 offset:7168
    v_mfma_f32_16x16x32_bf16 v[156:159], a[12:15], a[236:239], v[156:159]
    buffer_load_dword v255, v250, s[8:11], s77 offen sc1
    v_mfma_f32_16x16x32_bf16 v[156:159], a[8:11], a[232:235], v[156:159]
    s_waitcnt lgkmcnt(2)
    v_exp_f32 v137, v137
    v_mfma_f32_16x16x32_bf16 v[144:147], a[64:67], a[144:147], v[144:147]
    ds_read_b64_tr_b16 a[0:1], v246 offset:0
    ds_read_b64_tr_b16 a[2:3], v247 offset:0
    v_mfma_f32_16x16x32_bf16 v[144:147], a[68:71], a[148:151], v[144:147]
    v_cvt_pk_bf16_f32 v196, v132, v133
    v_cvt_pk_bf16_f32 v197, v134, v135
    v_mfma_f32_16x16x32_bf16 v[148:151], a[68:71], a[180:183], v[148:151]
    v_exp_f32 v138, v138
    v_mfma_f32_16x16x32_bf16 v[148:151], a[64:67], a[176:179], v[148:151]
    ds_read_b64_tr_b16 a[4:5], v246 offset:256
    ds_read_b64_tr_b16 a[6:7], v247 offset:256
    v_mfma_f32_16x16x32_bf16 v[152:155], a[64:67], a[208:211], v[152:155]
    v_exp_f32 v139, v139
    v_mfma_f32_16x16x32_bf16 v[152:155], a[68:71], a[212:215], v[152:155]
    v_exp_f32 v140, v140
    v_mfma_f32_16x16x32_bf16 v[156:159], a[68:71], a[244:247], v[156:159]
    v_exp_f32 v141, v141
    v_mfma_f32_16x16x32_bf16 v[156:159], a[64:67], a[240:243], v[156:159]
    s_waitcnt lgkmcnt(4)
    v_cvt_pk_bf16_f32 v200, v136, v137
    v_cvt_pk_bf16_f32 v201, v138, v139
    v_mfma_f32_16x16x32_bf16 v[144:147], a[72:75], a[152:155], v[144:147]
    ds_read_b64_tr_b16 a[8:9], v246 offset:1024
    ds_read_b64_tr_b16 a[10:11], v247 offset:1024
    v_mfma_f32_16x16x32_bf16 v[144:147], a[76:79], a[156:159], v[144:147]
    buffer_load_dwordx4 a[128:131], v250, s[8:11], s71 offen offset:0 sc1
    v_mfma_f32_16x16x32_bf16 v[148:151], a[76:79], a[188:191], v[148:151]
    v_exp_f32 v142, v142
    v_mfma_f32_16x16x32_bf16 v[148:151], a[72:75], a[184:187], v[148:151]
    ds_read_b64_tr_b16 a[12:13], v246 offset:1280
    ds_read_b64_tr_b16 a[14:15], v247 offset:1280
    v_mfma_f32_16x16x32_bf16 v[152:155], a[72:75], a[216:219], v[152:155]
    v_exp_f32 v143, v143
    v_mfma_f32_16x16x32_bf16 v[152:155], a[76:79], a[220:223], v[152:155]
    buffer_load_dwordx4 a[160:163], v252, s[8:11], s71 offen offset:0 sc1
    v_mfma_f32_16x16x32_bf16 v[156:159], a[76:79], a[252:255], v[156:159]
    v_exp_f32 v144, v144
    v_mfma_f32_16x16x32_bf16 v[156:159], a[72:75], a[248:251], v[156:159]
    s_waitcnt lgkmcnt(4)
    v_exp_f32 v145, v145
    v_mfma_f32_16x16x32_bf16 v[0:3], a[0:3], v[176:179], v[0:3]
    ds_read_b64_tr_b16 a[64:65], v246 offset:2048
    ds_read_b64_tr_b16 a[66:67], v247 offset:2048
    v_mfma_f32_16x16x32_bf16 v[64:67], a[0:3], v[180:183], v[64:67]
    buffer_load_dwordx4 a[192:195], v250, s[8:11], s72 offen offset:0 sc1
    v_mfma_f32_16x16x32_bf16 v[208:211], a[0:3], v[184:187], v[208:211]
    v_cvt_pk_bf16_f32 v204, v140, v141
    v_cvt_pk_bf16_f32 v205, v142, v143
    v_mfma_f32_16x16x32_bf16 v[224:227], a[0:3], v[188:191], v[224:227]
    ds_read_b64_tr_b16 a[68:69], v246 offset:2304
    ds_read_b64_tr_b16 a[70:71], v247 offset:2304
    v_mfma_f32_16x16x32_bf16 v[228:231], a[4:7], v[188:191], v[228:231]
    v_exp_f32 v146, v146
    v_mfma_f32_16x16x32_bf16 v[212:215], a[4:7], v[184:187], v[212:215]
    buffer_load_dwordx4 a[224:227], v252, s[8:11], s72 offen offset:0 sc1
    v_mfma_f32_16x16x32_bf16 v[68:71], a[4:7], v[180:183], v[68:71]
    v_exp_f32 v147, v147
    v_mfma_f32_16x16x32_bf16 v[4:7], a[4:7], v[176:179], v[4:7]
    s_waitcnt lgkmcnt(4)
    v_exp_f32 v148, v148
    v_mfma_f32_16x16x32_bf16 v[8:11], a[8:11], v[176:179], v[8:11]
    ds_read_b64_tr_b16 a[72:73], v246 offset:3072
    ds_read_b64_tr_b16 a[74:75], v247 offset:3072
    v_mfma_f32_16x16x32_bf16 v[72:75], a[8:11], v[180:183], v[72:75]
    buffer_load_dwordx4 a[132:135], v250, s[8:11], s71 offen offset:1024 sc1
    v_mfma_f32_16x16x32_bf16 v[216:219], a[8:11], v[184:187], v[216:219]
    v_exp_f32 v149, v149
    v_mfma_f32_16x16x32_bf16 v[232:235], a[8:11], v[188:191], v[232:235]
    ds_read_b64_tr_b16 a[76:77], v246 offset:3328
    ds_read_b64_tr_b16 a[78:79], v247 offset:3328
    v_mfma_f32_16x16x32_bf16 v[236:239], a[12:15], v[188:191], v[236:239]
    v_cvt_pk_bf16_f32 v194, v144, v145
    v_cvt_pk_bf16_f32 v195, v146, v147
    v_mfma_f32_16x16x32_bf16 v[220:223], a[12:15], v[184:187], v[220:223]
    buffer_load_dwordx4 a[164:167], v252, s[8:11], s71 offen offset:1024 sc1
    v_mfma_f32_16x16x32_bf16 v[76:79], a[12:15], v[180:183], v[76:79]
    v_exp_f32 v150, v150
    v_mfma_f32_16x16x32_bf16 v[12:15], a[12:15], v[176:179], v[12:15]
    s_waitcnt lgkmcnt(4)
    v_exp_f32 v151, v151
    v_mfma_f32_16x16x32_bf16 v[16:19], a[64:67], v[176:179], v[16:19]
    ds_read_b64_tr_b16 a[0:1], v246 offset:4096
    ds_read_b64_tr_b16 a[2:3], v247 offset:4096
    v_mfma_f32_16x16x32_bf16 v[80:83], a[64:67], v[180:183], v[80:83]
    buffer_load_dwordx4 a[196:199], v250, s[8:11], s72 offen offset:1024 sc1
    v_mfma_f32_16x16x32_bf16 a[16:19], a[64:67], v[184:187], a[16:19]
    v_exp_f32 v152, v152
    v_mfma_f32_16x16x32_bf16 a[80:83], a[64:67], v[188:191], a[80:83]
    ds_read_b64_tr_b16 a[4:5], v246 offset:4352
    ds_read_b64_tr_b16 a[6:7], v247 offset:4352
    v_mfma_f32_16x16x32_bf16 a[84:87], a[68:71], v[188:191], a[84:87]
    v_exp_f32 v153, v153
    v_mfma_f32_16x16x32_bf16 a[20:23], a[68:71], v[184:187], a[20:23]
    buffer_load_dwordx4 a[228:231], v252, s[8:11], s72 offen offset:1024 sc1
    v_mfma_f32_16x16x32_bf16 v[84:87], a[68:71], v[180:183], v[84:87]
    v_cvt_pk_bf16_f32 v198, v148, v149
    v_cvt_pk_bf16_f32 v199, v150, v151
    v_mfma_f32_16x16x32_bf16 v[20:23], a[68:71], v[176:179], v[20:23]
    s_waitcnt lgkmcnt(4)
    v_exp_f32 v154, v154
    v_mfma_f32_16x16x32_bf16 v[24:27], a[72:75], v[176:179], v[24:27]
    ds_read_b64_tr_b16 a[8:9], v246 offset:5120
    ds_read_b64_tr_b16 a[10:11], v247 offset:5120
    v_mfma_f32_16x16x32_bf16 v[88:91], a[72:75], v[180:183], v[88:91]
    buffer_load_dwordx4 a[136:139], v250, s[8:11], s71 offen offset:2048 sc1
    v_mfma_f32_16x16x32_bf16 a[24:27], a[72:75], v[184:187], a[24:27]
    v_exp_f32 v155, v155
    v_mfma_f32_16x16x32_bf16 a[88:91], a[72:75], v[188:191], a[88:91]
    ds_read_b64_tr_b16 a[12:13], v246 offset:5376
    ds_read_b64_tr_b16 a[14:15], v247 offset:5376
    v_mfma_f32_16x16x32_bf16 a[92:95], a[76:79], v[188:191], a[92:95]
    v_exp_f32 v156, v156
    v_mfma_f32_16x16x32_bf16 a[28:31], a[76:79], v[184:187], a[28:31]
    buffer_load_dwordx4 a[168:171], v252, s[8:11], s71 offen offset:2048 sc1
    v_mfma_f32_16x16x32_bf16 v[92:95], a[76:79], v[180:183], v[92:95]
    v_exp_f32 v157, v157
    v_mfma_f32_16x16x32_bf16 v[28:31], a[76:79], v[176:179], v[28:31]
    s_waitcnt lgkmcnt(4)
    v_cvt_pk_bf16_f32 v202, v152, v153
    v_cvt_pk_bf16_f32 v203, v154, v155
    v_mfma_f32_16x16x32_bf16 v[32:35], a[0:3], v[176:179], v[32:35]
    ds_read_b64_tr_b16 a[64:65], v246 offset:6144
    ds_read_b64_tr_b16 a[66:67], v247 offset:6144
    v_mfma_f32_16x16x32_bf16 v[96:99], a[0:3], v[180:183], v[96:99]
    buffer_load_dwordx4 a[200:203], v250, s[8:11], s72 offen offset:2048 sc1
    v_mfma_f32_16x16x32_bf16 a[32:35], a[0:3], v[184:187], a[32:35]
    v_exp_f32 v158, v158
    v_mfma_f32_16x16x32_bf16 a[96:99], a[0:3], v[188:191], a[96:99]
    ds_read_b64_tr_b16 a[68:69], v246 offset:6400
    ds_read_b64_tr_b16 a[70:71], v247 offset:6400
    v_mfma_f32_16x16x32_bf16 a[100:103], a[4:7], v[188:191], a[100:103]
    v_exp_f32 v159, v159
    v_mfma_f32_16x16x32_bf16 a[36:39], a[4:7], v[184:187], a[36:39]
    buffer_load_dwordx4 a[232:235], v252, s[8:11], s72 offen offset:2048 sc1
    v_mfma_f32_16x16x32_bf16 v[100:103], a[4:7], v[180:183], v[100:103]
    v_cvt_pk_bf16_f32 v206, v156, v157
    v_cvt_pk_bf16_f32 v207, v158, v159
    v_mfma_f32_16x16x32_bf16 v[36:39], a[4:7], v[176:179], v[36:39]
    s_waitcnt lgkmcnt(4)
    v_bfe_u32 v240, v250, 4, 4
    v_bfe_u32 v241, v250, 8, 2
    v_mfma_f32_16x16x32_bf16 v[40:43], a[8:11], v[176:179], v[40:43]
    ds_read_b64_tr_b16 a[72:73], v246 offset:7168
    ds_read_b64_tr_b16 a[74:75], v247 offset:7168
    v_mfma_f32_16x16x32_bf16 v[104:107], a[8:11], v[180:183], v[104:107]
    buffer_load_dwordx4 a[140:143], v250, s[8:11], s71 offen offset:3072 sc1
    v_mfma_f32_16x16x32_bf16 a[40:43], a[8:11], v[184:187], a[40:43]
    v_lshlrev_b32 v241, 2, v241
    v_sub_u32 v240, v240, v241
    v_mfma_f32_16x16x32_bf16 a[104:107], a[8:11], v[188:191], a[104:107]
    ds_read_b64_tr_b16 a[76:77], v246 offset:7424
    ds_read_b64_tr_b16 a[78:79], v247 offset:7424
    v_mfma_f32_16x16x32_bf16 a[108:111], a[12:15], v[188:191], a[108:111]
    v_and_b32 v241, 16, v250
    v_mov_b32 v244, 0x3f80
    v_mfma_f32_16x16x32_bf16 a[44:47], a[12:15], v[184:187], a[44:47]
    buffer_load_dwordx4 a[172:175], v252, s[8:11], s71 offen offset:3072 sc1
    v_mfma_f32_16x16x32_bf16 v[108:111], a[12:15], v[180:183], v[108:111]
    v_lshlrev_b32 v241, v241, v244
    v_lshrrev_b32 v240, 1, v240
    v_mfma_f32_16x16x32_bf16 v[44:47], a[12:15], v[176:179], v[44:47]
    s_waitcnt lgkmcnt(4)
    v_add_u32 v246, s61, v249
    v_add_u32 v247, s62, v249
    v_mfma_f32_16x16x32_bf16 v[48:51], a[64:67], v[176:179], v[48:51]
    ds_read_b64_tr_b16 a[0:1], v246 offset:2048
    ds_read_b64_tr_b16 a[2:3], v247 offset:2048
    v_mfma_f32_16x16x32_bf16 v[112:115], a[64:67], v[180:183], v[112:115]
    buffer_load_dwordx4 a[204:207], v250, s[8:11], s72 offen offset:3072 sc1
    v_mfma_f32_16x16x32_bf16 a[48:51], a[64:67], v[184:187], a[48:51]
    v_cmp_eq_u32 vcc, 0, v240
    v_cmp_eq_u32 s[68:69], 1, v240
    v_mfma_f32_16x16x32_bf16 a[112:115], a[64:67], v[188:191], a[112:115]
    ds_read_b64_tr_b16 a[4:5], v246 offset:2304
    ds_read_b64_tr_b16 a[6:7], v247 offset:2304
    v_mfma_f32_16x16x32_bf16 a[116:119], a[68:71], v[188:191], a[116:119]
    v_mov_b32 v244, 0
    v_mov_b32 v245, 0
    v_mfma_f32_16x16x32_bf16 a[52:55], a[68:71], v[184:187], a[52:55]
    buffer_load_dwordx4 a[236:239], v252, s[8:11], s72 offen offset:3072 sc1
    v_mfma_f32_16x16x32_bf16 v[116:119], a[68:71], v[180:183], v[116:119]
    v_cndmask_b32 v242, 0, v241, vcc
    v_cndmask_b32 v243, 0, v241, s[68:69]
    v_mfma_f32_16x16x32_bf16 v[52:55], a[68:71], v[176:179], v[52:55]
    s_waitcnt lgkmcnt(4)
    v_mov_b32 v240, 0
    v_mov_b32 v241, 0
    v_mfma_f32_16x16x32_bf16 v[56:59], a[72:75], v[176:179], v[56:59]
    ds_read_b64_tr_b16 a[8:9], v246 offset:3072
    ds_read_b64_tr_b16 a[10:11], v247 offset:3072
    v_mfma_f32_16x16x32_bf16 v[120:123], a[72:75], v[180:183], v[120:123]
    buffer_load_dwordx4 a[144:147], v251, s[8:11], s71 offen offset:0 sc1
    v_mfma_f32_16x16x32_bf16 a[56:59], a[72:75], v[184:187], a[56:59]
    v_mfma_f32_16x16x32_bf16 a[120:123], a[72:75], v[188:191], a[120:123]
    ds_read_b64_tr_b16 a[12:13], v246 offset:3328
    ds_read_b64_tr_b16 a[14:15], v247 offset:3328
    v_mfma_f32_16x16x32_bf16 a[124:127], a[76:79], v[188:191], a[124:127]
    v_mfma_f32_16x16x32_bf16 a[60:63], a[76:79], v[184:187], a[60:63]
    buffer_load_dwordx4 a[176:179], v253, s[8:11], s71 offen offset:0 sc1
    v_mfma_f32_16x16x32_bf16 v[124:127], a[76:79], v[180:183], v[124:127]
    v_mfma_f32_16x16x32_bf16 v[60:63], a[76:79], v[176:179], v[60:63]
    s_waitcnt lgkmcnt(4)
    v_mfma_f32_16x16x32_bf16 v[16:19], a[0:3], v[192:195], v[16:19]
    buffer_load_dwordx4 a[208:211], v251, s[8:11], s72 offen offset:0 sc1
    v_mfma_f32_16x16x32_bf16 v[80:83], a[0:3], v[196:199], v[80:83]
    s_add_u32 s35, s55, 10485760
    ds_read_b64_tr_b16 a[64:65], v246 offset:4096
    ds_read_b64_tr_b16 a[66:67], v247 offset:4096
    v_mfma_f32_16x16x32_bf16 a[16:19], a[0:3], v[200:203], a[16:19]
    s_add_u32 s68, s55, 10502144
    ds_read_b64_tr_b16 a[68:69], v246 offset:4352
    ds_read_b64_tr_b16 a[70:71], v247 offset:4352
    v_mfma_f32_16x16x32_bf16 a[80:83], a[0:3], v[204:207], a[80:83]
    s_add_u32 s69, s55, 6291456
    v_add_u32 v254, s73, v250
    v_mov_b32 v186, v160
    v_mfma_f32_16x16x32_bf16 v[20:23], a[4:7], v[192:195], v[20:23]
    buffer_load_dwordx4 a[240:243], v253, s[8:11], s72 offen offset:0 sc1
    v_mfma_f32_16x16x32_bf16 v[84:87], a[4:7], v[196:199], v[84:87]
    s_lshl_b32 s70, s3, 12
    v_mov_b32 v187, v164
    v_mov_b32 v188, v168
    v_mfma_f32_16x16x32_bf16 a[20:23], a[4:7], v[200:203], a[20:23]
    s_add_u32 s70, s70, 917504
    v_mov_b32 v189, v172
    v_mfma_f32_16x16x32_bf16 a[84:87], a[4:7], v[204:207], a[84:87]
    s_waitcnt lgkmcnt(4)
    v_mfma_f32_16x16x32_bf16 v[24:27], a[8:11], v[192:195], v[24:27]
    buffer_load_dwordx4 v[168:171], v250, s[8:11], s70 offen offset:0 sc1
    v_mfma_f32_16x16x32_bf16 v[88:91], a[8:11], v[196:199], v[88:91]
    ds_read_b64_tr_b16 a[72:73], v246 offset:5120
    ds_read_b64_tr_b16 a[74:75], v247 offset:5120
    v_mfma_f32_16x16x32_bf16 a[24:27], a[8:11], v[200:203], a[24:27]
    ds_read_b64_tr_b16 a[76:77], v246 offset:5376
    ds_read_b64_tr_b16 a[78:79], v247 offset:5376
    v_mfma_f32_16x16x32_bf16 a[88:91], a[8:11], v[204:207], a[88:91]
    v_cvt_pk_bf16_f32 v16, v16, v17
    v_cvt_pk_bf16_f32 v17, v18, v19
    v_mfma_f32_16x16x32_bf16 v[28:31], a[12:15], v[192:195], v[28:31]
    buffer_load_dwordx4 v[172:175], v250, s[8:11], s70 offen offset:1024 sc1
    v_mfma_f32_16x16x32_bf16 v[92:95], a[12:15], v[196:199], v[92:95]
    v_cvt_pk_bf16_f32 v18, v20, v21
    v_cvt_pk_bf16_f32 v19, v22, v23
    v_mfma_f32_16x16x32_bf16 a[28:31], a[12:15], v[200:203], a[28:31]
    ds_write_b128 v254, v[16:19] offset:20480
    v_cvt_pk_bf16_f32 v80, v80, v81
    v_mfma_f32_16x16x32_bf16 a[92:95], a[12:15], v[204:207], a[92:95]
    s_waitcnt lgkmcnt(5)
    v_cvt_pk_bf16_f32 v81, v82, v83
    v_cvt_pk_bf16_f32 v82, v84, v85
    v_mfma_f32_16x16x32_bf16 v[32:35], a[64:67], v[192:195], v[32:35]
    buffer_load_dwordx4 v[176:179], v250, s[8:11], s70 offen offset:2048 sc1
    v_mfma_f32_16x16x32_bf16 v[96:99], a[64:67], v[196:199], v[96:99]
    ds_read_b64_tr_b16 a[0:1], v246 offset:6144
    ds_read_b64_tr_b16 a[2:3], v247 offset:6144
    v_mfma_f32_16x16x32_bf16 a[32:35], a[64:67], v[200:203], a[32:35]
    ds_read_b64_tr_b16 a[4:5], v246 offset:6400
    ds_read_b64_tr_b16 a[6:7], v247 offset:6400
    v_mfma_f32_16x16x32_bf16 a[96:99], a[64:67], v[204:207], a[96:99]
    v_cvt_pk_bf16_f32 v83, v86, v87
    v_cvt_pk_bf16_f32 v24, v24, v25
    v_mfma_f32_16x16x32_bf16 v[36:39], a[68:71], v[192:195], v[36:39]
    buffer_load_dwordx4 v[180:183], v250, s[8:11], s70 offen offset:3072 sc1
    v_mfma_f32_16x16x32_bf16 v[100:103], a[68:71], v[196:199], v[100:103]
    ds_write_b128 v254, v[80:83] offset:22528
    v_cvt_pk_bf16_f32 v25, v26, v27
    v_mfma_f32_16x16x32_bf16 a[36:39], a[68:71], v[200:203], a[36:39]
    v_cvt_pk_bf16_f32 v26, v28, v29
    v_cvt_pk_bf16_f32 v27, v30, v31
    v_mfma_f32_16x16x32_bf16 a[100:103], a[68:71], v[204:207], a[100:103]
    s_waitcnt lgkmcnt(6)
    ds_write_b128 v254, v[24:27] offset:21504
    v_cvt_pk_bf16_f32 v88, v88, v89
    v_mfma_f32_16x16x32_bf16 v[40:43], a[72:75], v[192:195], v[40:43]
    buffer_load_dwordx4 v[128:131], v250, s[8:11], s58 offen sc1
    v_mfma_f32_16x16x32_bf16 v[104:107], a[72:75], v[196:199], v[104:107]
    ds_read_b64_tr_b16 a[8:9], v246 offset:7168
    ds_read_b64_tr_b16 a[10:11], v247 offset:7168
    v_mfma_f32_16x16x32_bf16 a[40:43], a[72:75], v[200:203], a[40:43]
    ds_read_b64_tr_b16 a[12:13], v246 offset:7424
    ds_read_b64_tr_b16 a[14:15], v247 offset:7424
    v_mfma_f32_16x16x32_bf16 a[104:107], a[72:75], v[204:207], a[104:107]
    v_cvt_pk_bf16_f32 v89, v90, v91
    v_cvt_pk_bf16_f32 v90, v92, v93
    v_mfma_f32_16x16x32_bf16 v[44:47], a[76:79], v[192:195], v[44:47]
    buffer_load_dwordx4 v[132:135], v250, s[8:11], s35 offen sc1
    v_mfma_f32_16x16x32_bf16 v[108:111], a[76:79], v[196:199], v[108:111]
    v_cvt_pk_bf16_f32 v91, v94, v95
    v_cvt_pk_bf16_f32 v32, v32, v33
    v_mfma_f32_16x16x32_bf16 a[44:47], a[76:79], v[200:203], a[44:47]
    ds_write_b128 v254, v[88:91] offset:23552
    v_cvt_pk_bf16_f32 v33, v34, v35
    v_mfma_f32_16x16x32_bf16 a[108:111], a[76:79], v[204:207], a[108:111]
    s_waitcnt lgkmcnt(7)
    v_cvt_pk_bf16_f32 v34, v36, v37
    v_cvt_pk_bf16_f32 v35, v38, v39
    v_mfma_f32_16x16x32_bf16 v[48:51], a[0:3], v[192:195], v[48:51]
    buffer_load_dwordx4 v[136:139], v251, s[8:11], s35 offen sc1
    v_mfma_f32_16x16x32_bf16 v[112:115], a[0:3], v[196:199], v[112:115]
    ds_read_b64_tr_b16 a[64:65], v246 offset:0
    ds_read_b64_tr_b16 a[66:67], v247 offset:0
    v_mfma_f32_16x16x32_bf16 a[48:51], a[0:3], v[200:203], a[48:51]
    ds_read_b64_tr_b16 a[68:69], v246 offset:256
    ds_read_b64_tr_b16 a[70:71], v247 offset:256
    v_mfma_f32_16x16x32_bf16 a[112:115], a[0:3], v[204:207], a[112:115]
    ds_write_b128 v254, v[32:35] offset:24576
    v_cvt_pk_bf16_f32 v96, v96, v97
    v_mfma_f32_16x16x32_bf16 v[52:55], a[4:7], v[192:195], v[52:55]
    buffer_load_dwordx4 v[140:143], v252, s[8:11], s35 offen sc1
    v_mfma_f32_16x16x32_bf16 v[116:119], a[4:7], v[196:199], v[116:119]
    v_cvt_pk_bf16_f32 v97, v98, v99
    v_cvt_pk_bf16_f32 v98, v100, v101
    v_mfma_f32_16x16x32_bf16 a[52:55], a[4:7], v[200:203], a[52:55]
    v_cvt_pk_bf16_f32 v99, v102, v103
    v_cvt_pk_bf16_f32 v40, v40, v41
    v_mfma_f32_16x16x32_bf16 a[116:119], a[4:7], v[204:207], a[116:119]
    s_waitcnt lgkmcnt(6)
    ds_write_b128 v254, v[96:99] offset:26624
    v_cvt_pk_bf16_f32 v41, v42, v43
    v_mfma_f32_16x16x32_bf16 v[56:59], a[8:11], v[192:195], v[56:59]
    buffer_load_dwordx4 v[144:147], v253, s[8:11], s35 offen sc1
    v_mfma_f32_16x16x32_bf16 v[120:123], a[8:11], v[196:199], v[120:123]
    ds_read_b64_tr_b16 a[72:73], v246 offset:1024
    ds_read_b64_tr_b16 a[74:75], v247 offset:1024
    v_mfma_f32_16x16x32_bf16 a[56:59], a[8:11], v[200:203], a[56:59]
    ds_read_b64_tr_b16 a[76:77], v246 offset:1280
    ds_read_b64_tr_b16 a[78:79], v247 offset:1280
    v_mfma_f32_16x16x32_bf16 a[120:123], a[8:11], v[204:207], a[120:123]
    v_cvt_pk_bf16_f32 v42, v44, v45
    v_cvt_pk_bf16_f32 v43, v46, v47
    v_mfma_f32_16x16x32_bf16 v[60:63], a[12:15], v[192:195], v[60:63]
    buffer_load_dwordx4 v[148:151], v250, s[8:11], s68 offen sc1
    v_mfma_f32_16x16x32_bf16 v[124:127], a[12:15], v[196:199], v[124:127]
    ds_write_b128 v254, v[40:43] offset:25600
    v_cvt_pk_bf16_f32 v104, v104, v105
    v_mfma_f32_16x16x32_bf16 a[60:63], a[12:15], v[200:203], a[60:63]
    v_cvt_pk_bf16_f32 v105, v106, v107
    v_cvt_pk_bf16_f32 v106, v108, v109
    v_mfma_f32_16x16x32_bf16 a[124:127], a[12:15], v[204:207], a[124:127]
    s_waitcnt lgkmcnt(7)
    v_cvt_pk_bf16_f32 v107, v110, v111
    v_cvt_pk_bf16_f32 v48, v48, v49
    v_mfma_f32_16x16x32_bf16 v[0:3], a[64:67], v[192:195], v[0:3]
    buffer_load_dwordx4 v[152:155], v250, s[8:11], s69 offen sc1
    v_mfma_f32_16x16x32_bf16 v[64:67], a[64:67], v[196:199], v[64:67]
    ds_write_b128 v254, v[104:107] offset:27648
    v_cvt_pk_bf16_f32 v49, v50, v51
    v_mfma_f32_16x16x32_bf16 v[208:211], a[64:67], v[200:203], v[208:211]
    v_cvt_pk_bf16_f32 v50, v52, v53
    v_cvt_pk_bf16_f32 v51, v54, v55
    v_mfma_f32_16x16x32_bf16 v[224:227], a[64:67], v[204:207], v[224:227]
    ds_write_b128 v254, v[48:51] offset:28672
    v_cvt_pk_bf16_f32 v112, v112, v113
    v_mfma_f32_16x16x32_bf16 v[4:7], a[68:71], v[192:195], v[4:7]
    buffer_load_dwordx4 v[156:159], v251, s[8:11], s69 offen sc1
    v_mfma_f32_16x16x32_bf16 v[68:71], a[68:71], v[196:199], v[68:71]
    v_cvt_pk_bf16_f32 v113, v114, v115
    v_cvt_pk_bf16_f32 v114, v116, v117
    v_mfma_f32_16x16x32_bf16 v[212:215], a[68:71], v[200:203], v[212:215]
    v_cvt_pk_bf16_f32 v115, v118, v119
    v_cvt_pk_bf16_f32 v56, v56, v57
    v_mfma_f32_16x16x32_bf16 v[228:231], a[68:71], v[204:207], v[228:231]
    s_waitcnt lgkmcnt(3)
    ds_write_b128 v254, v[112:115] offset:30720
    v_cvt_pk_bf16_f32 v57, v58, v59
    v_mfma_f32_16x16x32_bf16 v[8:11], a[72:75], v[192:195], v[8:11]
    buffer_load_dwordx4 v[160:163], v252, s[8:11], s69 offen sc1
    v_mfma_f32_16x16x32_bf16 v[72:75], a[72:75], v[196:199], v[72:75]
    v_cvt_pk_bf16_f32 v58, v60, v61
    v_cvt_pk_bf16_f32 v59, v62, v63
    v_mfma_f32_16x16x32_bf16 v[216:219], a[72:75], v[200:203], v[216:219]
    ds_write_b128 v254, v[56:59] offset:29696
    v_cvt_pk_bf16_f32 v120, v120, v121
    v_mfma_f32_16x16x32_bf16 v[232:235], a[72:75], v[204:207], v[232:235]
    v_cvt_pk_bf16_f32 v121, v122, v123
    v_cvt_pk_bf16_f32 v122, v124, v125
    v_mfma_f32_16x16x32_bf16 v[12:15], a[76:79], v[192:195], v[12:15]
    buffer_load_dwordx4 v[164:167], v253, s[8:11], s69 offen sc1
    v_mfma_f32_16x16x32_bf16 v[76:79], a[76:79], v[196:199], v[76:79]
    v_cvt_pk_bf16_f32 v123, v126, v127
    v_mfma_f32_16x16x32_bf16 v[220:223], a[76:79], v[200:203], v[220:223]
    ds_write_b128 v254, v[120:123] offset:31744
    v_mfma_f32_16x16x32_bf16 v[236:239], a[76:79], v[204:207], v[236:239]
    buffer_load_dwordx4 a[148:151], v251, s[8:11], s71 offen offset:1024 sc1
    v_add_u32 v192, s36, v250
    v_add_u32 v193, s37, v250
    v_add_u32 v194, s54, v250
    s_cmp_eq_u32 s3, 1
    s_cbranch_scc1 L_l1
    s_cmp_eq_u32 s3, 2
    s_cbranch_scc1 L_l2
    s_cmp_eq_u32 s3, 3
    s_cbranch_scc1 L_l3
L_l0:
    v_mov_b32 v246, v63
    v_mov_b32 v247, v127
    v_accvgpr_read_b32 v248, a63
    v_accvgpr_read_b32 v249, a127
L_ldone:
    ds_write_b128 v254, v[246:249] offset:13312
    v_or_b32 v199, 0x300, v250
    v_add_u32 v195, 0x10000, v199
    s_waitcnt lgkmcnt(0)
    s_barrier
    s_nop 0
    ds_read_b128 v[80:83], v192 offset:20480
    ds_read_b128 v[84:87], v192 offset:21504
    ds_read_b128 v[16:19], v199 offset:13312
    ds_read_b128 v[20:23], v199 offset:46080
    ds_read_b128 v[24:27], v195 offset:13312
    ds_read_b128 v[28:31], v195 offset:46080
    ds_read_b128 v[88:91], v193 offset:24576
    ds_read_b128 v[92:95], v193 offset:25600
    buffer_load_dwordx4 a[180:183], v253, s[8:11], s71 offen offset:1024 sc1
    v_and_b32 v254, 0x300, v250
    v_bfe_u32 v255, v250, 4, 4
    v_lshlrev_b32 v255, 3, v255
    v_lshl_add_u32 v254, v254, 4, v255
    s_mul_i32 s65, s57, 4096
    s_add_u32 s65, s65, 14680064
    s_waitcnt lgkmcnt(6)
    v_mfma_f32_16x16x32_bf16 v[0:3], v[242:245], v[80:83], v[0:3]
    ds_read_b128 v[96:99], v194 offset:28672
    v_mfma_f32_16x16x32_bf16 v[4:7], v[240:243], v[80:83], v[4:7]
    ds_read_b128 v[100:103], v194 offset:29696
    v_mfma_f32_16x16x32_bf16 v[8:11], v[242:245], v[84:87], v[8:11]
    ds_read_b128 v[104:107], v192 offset:22528
    v_mfma_f32_16x16x32_bf16 v[12:15], v[240:243], v[84:87], v[12:15]
    s_waitcnt lgkmcnt(3)
    ds_read_b128 v[108:111], v192 offset:23552
    v_mfma_f32_16x16x32_bf16 v[0:3], v[242:245], v[88:91], v[0:3]
    ds_read_b128 v[112:115], v193 offset:26624
    v_add_f32 v246, v16, v20
    v_mfma_f32_16x16x32_bf16 v[4:7], v[240:243], v[88:91], v[4:7]
    v_add_f32 v24, v24, v28
    v_add_f32 v247, v17, v21
    v_mfma_f32_16x16x32_bf16 v[8:11], v[242:245], v[92:95], v[8:11]
    ds_read_b128 v[116:119], v193 offset:27648
    v_add_f32 v25, v25, v29
    v_mfma_f32_16x16x32_bf16 v[12:15], v[240:243], v[92:95], v[12:15]
    s_waitcnt lgkmcnt(4)
    v_add_f32 v248, v18, v22
    v_add_f32 v26, v26, v30
    v_mfma_f32_16x16x32_bf16 v[0:3], v[242:245], v[96:99], v[0:3]
    ds_read_b128 v[120:123], v194 offset:30720
    v_add_f32 v249, v19, v23
    v_mfma_f32_16x16x32_bf16 v[4:7], v[240:243], v[96:99], v[4:7]
    v_add_f32 v27, v27, v31
    v_add_f32 v246, v246, v24
    v_mfma_f32_16x16x32_bf16 v[8:11], v[242:245], v[100:103], v[8:11]
    ds_read_b128 v[124:127], v194 offset:31744
    v_add_f32 v247, v247, v25
    v_mfma_f32_16x16x32_bf16 v[12:15], v[240:243], v[100:103], v[12:15]
    s_waitcnt lgkmcnt(4)
    v_add_f32 v248, v248, v26
    v_add_f32 v249, v249, v27
    v_mfma_f32_16x16x32_bf16 v[64:67], v[242:245], v[104:107], v[64:67]
    v_min3_f32 v17, v246, v247, v248
    v_add_f32 v18, v246, v247
    v_mfma_f32_16x16x32_bf16 v[68:71], v[240:243], v[104:107], v[68:71]
    v_add_f32 v19, v248, v249
    v_min_f32 v17, v17, v249
    v_mfma_f32_16x16x32_bf16 v[72:75], v[242:245], v[108:111], v[72:75]
    v_cvt_pk_bf16_f32 v0, v0, v1
    v_cvt_pk_bf16_f32 v1, v2, v3
    v_mfma_f32_16x16x32_bf16 v[76:79], v[240:243], v[108:111], v[76:79]
    s_waitcnt lgkmcnt(2)
    v_cvt_pk_bf16_f32 v2, v4, v5
    v_cvt_pk_bf16_f32 v3, v6, v7
    v_mfma_f32_16x16x32_bf16 v[64:67], v[242:245], v[112:115], v[64:67]
    buffer_store_dwordx4 v[0:3], v250, s[8:11], s65 offen offset:0 sc1
    v_mfma_f32_16x16x32_bf16 v[68:71], v[240:243], v[112:115], v[68:71]
    v_add_f32 v18, v18, v19
    s_mov_b32 s35, 0x21800000
    v_mfma_f32_16x16x32_bf16 v[72:75], v[242:245], v[116:119], v[72:75]
    v_cvt_pk_bf16_f32 v8, v8, v9
    v_cvt_pk_bf16_f32 v9, v10, v11
    v_mfma_f32_16x16x32_bf16 v[76:79], v[240:243], v[116:119], v[76:79]
    s_waitcnt lgkmcnt(0)
    v_cvt_pk_bf16_f32 v10, v12, v13
    v_cvt_pk_bf16_f32 v11, v14, v15
    v_mfma_f32_16x16x32_bf16 v[64:67], v[242:245], v[120:123], v[64:67]
    buffer_store_dwordx4 v[8:11], v250, s[8:11], s65 offen offset:1024 sc1
    v_mfma_f32_16x16x32_bf16 v[68:71], v[240:243], v[120:123], v[68:71]
    v_cmp_gt_f32 vcc, 0x67800000, v18
    v_cmp_lt_f32 s[68:69], s35, v17
    v_mfma_f32_16x16x32_bf16 v[72:75], v[242:245], v[124:127], v[72:75]
    v_mov_b32 v184, v246
    v_mov_b32 v185, v247
    v_mfma_f32_16x16x32_bf16 v[76:79], v[240:243], v[124:127], v[76:79]
    v_mov_b32 v246, v188
    v_mov_b32 v247, v189
    s_and_b64 vcc, vcc, s[68:69]
    s_cmp_eq_u64 vcc, -1
    s_cselect_b32 s35, 1, s5
    s_cmp_eq_u32 s35, 0
    s_cbranch_scc1 L_fallback
    s_waitcnt vmcnt(4)
    s_add_u32 s69, s73, 655360
    s_add_u32 s70, s69, 16384
    v_bfe_u32 v190, v250, 8, 2
    v_cmp_eq_u32 vcc, 1, v190
    v_cmp_eq_u32 s[60:61], 2, v190
    v_cmp_eq_u32 s[62:63], 3, v190
    v_cvt_pk_bf16_f32 v64, v64, v65
    v_cvt_pk_bf16_f32 v65, v66, v67
    v_cvt_pk_bf16_f32 v66, v68, v69
L_pad5:
    s_cbranch_execz L_padret
    s_nop 0
    v_cvt_pk_bf16_f32 v67, v70, v71
    v_cvt_pk_bf16_f32 v72, v72, v73
    v_cvt_pk_bf16_f32 v73, v74, v75
    v_cvt_pk_bf16_f32 v74, v76, v77
    v_cvt_pk_bf16_f32 v75, v78, v79
    buffer_store_dwordx4 v[64:67], v250, s[8:11], s65 offen offset:2048 sc1
    buffer_store_dwordx4 v[72:75], v250, s[8:11], s65 offen offset:3072 sc1
    v_dot2_f32_bf16 v96, v128, v168, 0
    v_dot2_f32_bf16 v97, v129, v176, 0
    v_dot2_f32_bf16 v98, v129, v168, 0
    v_dot2_f32_bf16 v99, v130, v176, 0
    v_dot2c_f32_bf16 v96, v129, v169
    v_dot2c_f32_bf16 v97, v130, v177
    v_dot2c_f32_bf16 v98, v130, v169
    v_dot2c_f32_bf16 v99, v131, v177
    v_dot2c_f32_bf16 v96, v130, v170
    v_dot2c_f32_bf16 v97, v131, v178
    v_dot2c_f32_bf16 v98, v131, v170
    v_dot2c_f32_bf16 v99, v132, v178
    v_dot2c_f32_bf16 v96, v131, v171
    v_dot2c_f32_bf16 v97, v132, v179
    v_dot2c_f32_bf16 v98, v132, v171
    v_dot2c_f32_bf16 v99, v133, v179
    v_dot2c_f32_bf16 v96, v132, v172
    v_dot2c_f32_bf16 v97, v133, v180
    v_dot2c_f32_bf16 v98, v133, v172
    v_dot2c_f32_bf16 v99, v134, v180
    v_dot2c_f32_bf16 v96, v133, v173
    v_dot2c_f32_bf16 v97, v134, v181
    v_dot2c_f32_bf16 v98, v134, v173
    v_dot2c_f32_bf16 v99, v135, v181
    v_dot2c_f32_bf16 v96, v134, v174
    v_dot2c_f32_bf16 v97, v135, v182
    v_dot2c_f32_bf16 v98, v135, v174
    v_dot2c_f32_bf16 v99, v136, v182
    v_dot2c_f32_bf16 v96, v135, v175
    v_dot2c_f32_bf16 v97, v136, v183
    v_cndmask_b32 v191, v184, v185, vcc
    v_cndmask_b32 v191, v191, v186, s[60:61]
    v_cndmask_b32 v191, v191, v187, s[62:63]
    v_add_u32 v190, s4, v191
    v_add3_u32 v190, v190, v0, v1
    v_add3_u32 v190, v190, v2, v3
    v_add3_u32 v190, v190, v8, v9
    v_add3_u32 v190, v190, v10, v11
    v_add3_u32 v190, v190, v64, v65
    v_add3_u32 v190, v190, v66, v67
    v_add3_u32 v190, v190, v72, v73
    v_add3_u32 v190, v190, v74, v75
    v_lshrrev_b32 v255, 1, v250
    s_lshl_b32 s35, s57, 9
    s_add_u32 s35, s35, 1048576
    buffer_store_dwordx2 v[190:191], v255, s[8:11], s35 offen sc1
    buffer_load_dwordx4 a[212:215], v251, s[8:11], s72 offen offset:1024 sc1
    v_dot2c_f32_bf16 v98, v136, v175
    v_dot2c_f32_bf16 v99, v137, v183
    v_dot2_f32_bf16 v100, v130, v168, 0
    v_dot2_f32_bf16 v101, v131, v176, 0
    v_dot2_f32_bf16 v102, v131, v168, 0
    v_dot2_f32_bf16 v103, v132, v176, 0
    v_dot2c_f32_bf16 v100, v131, v169
    v_dot2c_f32_bf16 v101, v132, v177
    v_dot2c_f32_bf16 v102, v132, v169
    v_dot2c_f32_bf16 v103, v133, v177
    v_dot2c_f32_bf16 v100, v132, v170
    v_dot2c_f32_bf16 v101, v133, v178
    v_dot2c_f32_bf16 v102, v133, v170
    v_dot2c_f32_bf16 v103, v134, v178
    v_dot2c_f32_bf16 v100, v133, v171
    v_dot2c_f32_bf16 v101, v134, v179
    v_dot2c_f32_bf16 v102, v134, v171
    v_dot2c_f32_bf16 v103, v135, v179
    v_dot2c_f32_bf16 v100, v134, v172
    v_dot2c_f32_bf16 v101, v135, v180
    v_dot2c_f32_bf16 v102, v135, v172
    v_dot2c_f32_bf16 v103, v136, v180
    v_dot2c_f32_bf16 v100, v135, v173
    v_dot2c_f32_bf16 v101, v136, v181
    v_dot2c_f32_bf16 v102, v136, v173
    v_dot2c_f32_bf16 v103, v137, v181
    v_dot2c_f32_bf16 v100, v136, v174
    v_dot2c_f32_bf16 v101, v137, v182
    v_dot2c_f32_bf16 v102, v137, v174
    v_dot2c_f32_bf16 v103, v138, v182
    v_dot2c_f32_bf16 v100, v137, v175
    v_dot2c_f32_bf16 v101, v138, v183
    v_dot2c_f32_bf16 v102, v138, v175
    v_dot2c_f32_bf16 v103, v139, v183
    v_dot2_f32_bf16 v104, v132, v168, 0
    v_dot2_f32_bf16 v105, v133, v176, 0
    v_dot2_f32_bf16 v106, v133, v168, 0
    v_dot2_f32_bf16 v107, v134, v176, 0
    v_dot2c_f32_bf16 v104, v133, v169
    v_dot2c_f32_bf16 v105, v134, v177
    v_dot2c_f32_bf16 v106, v134, v169
    v_dot2c_f32_bf16 v107, v135, v177
    v_dot2c_f32_bf16 v104, v134, v170
    v_dot2c_f32_bf16 v105, v135, v178
    v_dot2c_f32_bf16 v106, v135, v170
    v_dot2c_f32_bf16 v107, v136, v178
    v_dot2c_f32_bf16 v104, v135, v171
    v_dot2c_f32_bf16 v105, v136, v179
    v_dot2c_f32_bf16 v106, v136, v171
    v_dot2c_f32_bf16 v107, v137, v179
    v_dot2c_f32_bf16 v104, v136, v172
    v_dot2c_f32_bf16 v105, v137, v180
    v_dot2c_f32_bf16 v106, v137, v172
    v_dot2c_f32_bf16 v107, v138, v180
    v_dot2c_f32_bf16 v104, v137, v173
    v_dot2c_f32_bf16 v105, v138, v181
    v_dot2c_f32_bf16 v106, v138, v173
    v_dot2c_f32_bf16 v107, v139, v181
    v_dot2c_f32_bf16 v104, v138, v174
    v_dot2c_f32_bf16 v105, v139, v182
    v_dot2c_f32_bf16 v106, v139, v174
    v_dot2c_f32_bf16 v107, v140, v182
    v_dot2c_f32_bf16 v104, v139, v175
    v_dot2c_f32_bf16 v105, v140, v183
    v_dot2c_f32_bf16 v106, v140, v175
    v_dot2c_f32_bf16 v107, v141, v183
    v_dot2_f32_bf16 v108, v134, v168, 0
    v_dot2_f32_bf16 v109, v135, v176, 0
    v_dot2_f32_bf16 v110, v135, v168, 0
    v_dot2_f32_bf16 v111, v136, v176, 0
    v_dot2c_f32_bf16 v108, v135, v169
    v_dot2c_f32_bf16 v109, v136, v177
    v_dot2c_f32_bf16 v110, v136, v169
    v_dot2c_f32_bf16 v111, v137, v177
    v_dot2c_f32_bf16 v108, v136, v170
    v_dot2c_f32_bf16 v109, v137, v178
    v_dot2c_f32_bf16 v110, v137, v170
    v_dot2c_f32_bf16 v111, v138, v178
    v_dot2c_f32_bf16 v108, v137, v171
    v_dot2c_f32_bf16 v109, v138, v179
    v_dot2c_f32_bf16 v110, v138, v171
    v_dot2c_f32_bf16 v111, v139, v179
    v_dot2c_f32_bf16 v108, v138, v172
    v_dot2c_f32_bf16 v109, v139, v180
    v_dot2c_f32_bf16 v110, v139, v172
    v_dot2c_f32_bf16 v111, v140, v180
    v_dot2c_f32_bf16 v108, v139, v173
    v_dot2c_f32_bf16 v109, v140, v181
    v_dot2c_f32_bf16 v110, v140, v173
    v_dot2c_f32_bf16 v111, v141, v181
    v_dot2c_f32_bf16 v108, v140, v174
    v_dot2c_f32_bf16 v109, v141, v182
    v_dot2c_f32_bf16 v110, v141, v174
    v_dot2c_f32_bf16 v111, v142, v182
    v_dot2c_f32_bf16 v108, v141, v175
    v_dot2c_f32_bf16 v109, v142, v183
    v_dot2c_f32_bf16 v110, v142, v175
    v_dot2c_f32_bf16 v111, v143, v183
    v_dot2_f32_bf16 v112, v136, v168, 0
    v_dot2_f32_bf16 v113, v137, v176, 0
    v_dot2_f32_bf16 v114, v137, v168, 0
    v_dot2_f32_bf16 v115, v138, v176, 0
    buffer_load_dwordx4 a[244:247], v253, s[8:11], s72 offen offset:1024 sc1
    buffer_load_dwordx4 a[152:155], v251, s[8:11], s71 offen offset:2048 sc1
    v_dot2c_f32_bf16 v112, v137, v169
    v_dot2c_f32_bf16 v113, v138, v177
    v_dot2c_f32_bf16 v114, v138, v169
    v_dot2c_f32_bf16 v115, v139, v177
    v_dot2c_f32_bf16 v112, v138, v170
    v_dot2c_f32_bf16 v113, v139, v178
    v_dot2c_f32_bf16 v114, v139, v170
    v_dot2c_f32_bf16 v115, v140, v178
    v_dot2c_f32_bf16 v112, v139, v171
    v_dot2c_f32_bf16 v113, v140, v179
    v_dot2c_f32_bf16 v114, v140, v171
    v_dot2c_f32_bf16 v115, v141, v179
    v_dot2c_f32_bf16 v112, v140, v172
    v_dot2c_f32_bf16 v113, v141, v180
    v_dot2c_f32_bf16 v114, v141, v172
    v_dot2c_f32_bf16 v115, v142, v180
    v_dot2c_f32_bf16 v112, v141, v173
    v_dot2c_f32_bf16 v113, v142, v181
    v_dot2c_f32_bf16 v114, v142, v173
    v_dot2c_f32_bf16 v115, v143, v181
    v_dot2c_f32_bf16 v112, v142, v174
    v_dot2c_f32_bf16 v113, v143, v182
    v_dot2c_f32_bf16 v114, v143, v174
    v_dot2c_f32_bf16 v115, v144, v182
    v_dot2c_f32_bf16 v112, v143, v175
    v_dot2c_f32_bf16 v113, v144, v183
    v_dot2c_f32_bf16 v114, v144, v175
    v_dot2c_f32_bf16 v115, v145, v183
    v_dot2_f32_bf16 v116, v138, v168, 0
    v_dot2_f32_bf16 v117, v139, v176, 0
    v_dot2_f32_bf16 v118, v139, v168, 0
    v_dot2_f32_bf16 v119, v140, v176, 0
    v_dot2c_f32_bf16 v116, v139, v169
    v_dot2c_f32_bf16 v117, v140, v177
    v_dot2c_f32_bf16 v118, v140, v169
    v_dot2c_f32_bf16 v119, v141, v177
    v_dot2c_f32_bf16 v116, v140, v170
    v_dot2c_f32_bf16 v117, v141, v178
    v_dot2c_f32_bf16 v118, v141, v170
    v_dot2c_f32_bf16 v119, v142, v178
    v_dot2c_f32_bf16 v116, v141, v171
    v_dot2c_f32_bf16 v117, v142, v179
    buffer_load_dwordx4 a[184:187], v253, s[8:11], s71 offen offset:2048 sc1
    buffer_load_dwordx4 a[216:219], v251, s[8:11], s72 offen offset:2048 sc1
    v_dot2c_f32_bf16 v118, v142, v171
    v_dot2c_f32_bf16 v119, v143, v179
    v_dot2c_f32_bf16 v116, v142, v172
    v_dot2c_f32_bf16 v117, v143, v180
    v_dot2c_f32_bf16 v118, v143, v172
    v_dot2c_f32_bf16 v119, v144, v180
    v_dot2c_f32_bf16 v116, v143, v173
    v_dot2c_f32_bf16 v117, v144, v181
    v_dot2c_f32_bf16 v118, v144, v173
    v_dot2c_f32_bf16 v119, v145, v181
    v_dot2c_f32_bf16 v116, v144, v174
    v_dot2c_f32_bf16 v117, v145, v182
    v_dot2c_f32_bf16 v118, v145, v174
    v_dot2c_f32_bf16 v119, v146, v182
    v_dot2c_f32_bf16 v116, v145, v175
    v_dot2c_f32_bf16 v117, v146, v183
    v_dot2c_f32_bf16 v118, v146, v175
    v_dot2c_f32_bf16 v119, v147, v183
    v_dot2_f32_bf16 v120, v140, v168, 0
    v_dot2_f32_bf16 v121, v141, v176, 0
    v_dot2_f32_bf16 v122, v141, v168, 0
    v_dot2_f32_bf16 v123, v142, v176, 0
    v_dot2c_f32_bf16 v120, v141, v169
    v_dot2c_f32_bf16 v121, v142, v177
    v_dot2c_f32_bf16 v122, v142, v169
    v_dot2c_f32_bf16 v123, v143, v177
    v_dot2c_f32_bf16 v120, v142, v170
    v_dot2c_f32_bf16 v121, v143, v178
    v_dot2c_f32_bf16 v122, v143, v170
    v_dot2c_f32_bf16 v123, v144, v178
    v_dot2c_f32_bf16 v120, v143, v171
    v_dot2c_f32_bf16 v121, v144, v179
    v_dot2c_f32_bf16 v122, v144, v171
    v_dot2c_f32_bf16 v123, v145, v179
    v_dot2c_f32_bf16 v120, v144, v172
    v_dot2c_f32_bf16 v121, v145, v180
    v_dot2c_f32_bf16 v122, v145, v172
    v_dot2c_f32_bf16 v123, v146, v180
    v_dot2c_f32_bf16 v120, v145, v173
    v_dot2c_f32_bf16 v121, v146, v181
    v_dot2c_f32_bf16 v122, v146, v173
    v_dot2c_f32_bf16 v123, v147, v181
    buffer_load_dwordx4 a[248:251], v253, s[8:11], s72 offen offset:2048 sc1
    buffer_load_dwordx4 a[156:159], v251, s[8:11], s71 offen offset:3072 sc1
    v_dot2c_f32_bf16 v120, v146, v174
    v_dot2c_f32_bf16 v121, v147, v182
    v_dot2c_f32_bf16 v122, v147, v174
    v_dot2c_f32_bf16 v123, v148, v182
    v_dot2c_f32_bf16 v120, v147, v175
    v_dot2c_f32_bf16 v121, v148, v183
    v_dot2c_f32_bf16 v122, v148, v175
    v_dot2c_f32_bf16 v123, v149, v183
    v_dot2_f32_bf16 v124, v142, v168, 0
    v_dot2_f32_bf16 v125, v143, v176, 0
    v_dot2_f32_bf16 v126, v143, v168, 0
    v_dot2_f32_bf16 v127, v144, v176, 0
    v_dot2c_f32_bf16 v124, v143, v169
    v_dot2c_f32_bf16 v125, v144, v177
    v_dot2c_f32_bf16 v126, v144, v169
    v_dot2c_f32_bf16 v127, v145, v177
    v_dot2c_f32_bf16 v124, v144, v170
    v_dot2c_f32_bf16 v125, v145, v178
    v_dot2c_f32_bf16 v126, v145, v170
    v_dot2c_f32_bf16 v127, v146, v178
    v_dot2c_f32_bf16 v124, v145, v171
    v_dot2c_f32_bf16 v125, v146, v179
    v_dot2c_f32_bf16 v126, v146, v171
    v_dot2c_f32_bf16 v127, v147, v179
    v_dot2c_f32_bf16 v124, v146, v172
    v_dot2c_f32_bf16 v125, v147, v180
    v_dot2c_f32_bf16 v126, v147, v172
    v_dot2c_f32_bf16 v127, v148, v180
    v_dot2c_f32_bf16 v124, v147, v173
    v_dot2c_f32_bf16 v125, v148, v181
    v_dot2c_f32_bf16 v126, v148, v173
    v_dot2c_f32_bf16 v127, v149, v181
    v_dot2c_f32_bf16 v124, v148, v174
    v_dot2c_f32_bf16 v125, v149, v182
    v_dot2c_f32_bf16 v126, v149, v174
    v_dot2c_f32_bf16 v127, v150, v182
    v_dot2c_f32_bf16 v124, v149, v175
    v_dot2c_f32_bf16 v125, v150, v183
    v_dot2c_f32_bf16 v126, v150, v175
    v_dot2c_f32_bf16 v127, v151, v183
    v_bfe_u32 v144, v250, 5, 2
    v_bfe_u32 v145, v250, 7, 1
    buffer_load_dwordx4 a[188:191], v253, s[8:11], s71 offen offset:3072 sc1
    buffer_load_dwordx4 a[220:223], v251, s[8:11], s72 offen offset:3072 sc1
    v_lshlrev_b32 v145, 1, v145
    v_xor_b32 v144, v144, v145
    v_lshlrev_b32 v144, 4, v144
    s_lshl_b32 s35, s3, 12
    s_add_u32 s35, s35, 131072
    v_lshl_add_u32 v144, v250, 2, v144
    v_add_u32 v144, s35, v144
    v_xor_b32 v145, 16, v144
    v_xor_b32 v146, 32, v144
    v_xor_b32 v147, 48, v144
    v_lshlrev_b32 v148, 16, v152
    v_and_b32 v149, s101, v152
    v_pk_mul_f32 v[96:97], v[96:97], v[148:149]
    v_cvt_pk_bf16_f32 v128, v96, v97
    v_lshlrev_b32 v150, 16, v153
    v_and_b32 v151, s101, v153
    v_pk_mul_f32 v[98:99], v[98:99], v[150:151]
    v_cvt_pk_bf16_f32 v129, v98, v99
    v_lshlrev_b32 v148, 16, v156
    v_and_b32 v149, s101, v156
    v_pk_mul_f32 v[104:105], v[104:105], v[148:149]
    v_cvt_pk_bf16_f32 v130, v104, v105
    v_lshlrev_b32 v150, 16, v157
    v_and_b32 v151, s101, v157
    v_pk_mul_f32 v[106:107], v[106:107], v[150:151]
    v_cvt_pk_bf16_f32 v131, v106, v107
    ds_write_b128 v144, v[128:131]
    buffer_load_dwordx4 a[252:255], v253, s[8:11], s72 offen offset:3072 sc1
    v_lshlrev_b32 v148, 16, v160
    v_and_b32 v149, s101, v160
    v_pk_mul_f32 v[112:113], v[112:113], v[148:149]
    v_cvt_pk_bf16_f32 v132, v112, v113
    v_lshlrev_b32 v150, 16, v161
    v_and_b32 v151, s101, v161
    v_pk_mul_f32 v[114:115], v[114:115], v[150:151]
    v_cvt_pk_bf16_f32 v133, v114, v115
    v_lshlrev_b32 v148, 16, v164
    v_and_b32 v149, s101, v164
    v_pk_mul_f32 v[120:121], v[120:121], v[148:149]
    v_cvt_pk_bf16_f32 v134, v120, v121
    v_lshlrev_b32 v150, 16, v165
    v_and_b32 v151, s101, v165
    v_pk_mul_f32 v[122:123], v[122:123], v[150:151]
    v_cvt_pk_bf16_f32 v135, v122, v123
    ds_write_b128 v145, v[132:135]
    buffer_load_dwordx4 v[0:3], v250, s[8:11], s69 offen offset:0 sc1
    v_lshlrev_b32 v148, 16, v154
    v_and_b32 v149, s101, v154
    v_pk_mul_f32 v[100:101], v[100:101], v[148:149]
    v_cvt_pk_bf16_f32 v136, v100, v101
    v_lshlrev_b32 v150, 16, v155
    v_and_b32 v151, s101, v155
    v_pk_mul_f32 v[102:103], v[102:103], v[150:151]
    v_cvt_pk_bf16_f32 v137, v102, v103
    v_lshlrev_b32 v148, 16, v158
    v_and_b32 v149, s101, v158
    v_pk_mul_f32 v[108:109], v[108:109], v[148:149]
    v_cvt_pk_bf16_f32 v138, v108, v109
    v_lshlrev_b32 v150, 16, v159
    v_and_b32 v151, s101, v159
    v_pk_mul_f32 v[110:111], v[110:111], v[150:151]
    v_cvt_pk_bf16_f32 v139, v110, v111
    ds_write_b128 v146, v[136:139]
    buffer_load_dwordx4 v[32:35], v252, s[8:11], s69 offen offset:0 sc1
    v_lshlrev_b32 v148, 16, v162
    v_and_b32 v149, s101, v162
    v_pk_mul_f32 v[116:117], v[116:117], v[148:149]
    v_cvt_pk_bf16_f32 v140, v116, v117
    v_lshlrev_b32 v150, 16, v163
    v_and_b32 v151, s101, v163
    v_pk_mul_f32 v[118:119], v[118:119], v[150:151]
    v_cvt_pk_bf16_f32 v141, v118, v119
    v_lshlrev_b32 v148, 16, v166
    v_and_b32 v149, s101, v166
    v_pk_mul_f32 v[124:125], v[124:125], v[148:149]
    v_cvt_pk_bf16_f32 v142, v124, v125
    v_lshlrev_b32 v150, 16, v167
    v_and_b32 v151, s101, v167
    v_pk_mul_f32 v[126:127], v[126:127], v[150:151]
    v_cvt_pk_bf16_f32 v143, v126, v127
    ds_write_b128 v147, v[140:143]
    buffer_load_dwordx4 v[64:67], v250, s[8:11], s70 offen offset:0 sc1
    v_add_u32 v255, s73, v250
    v_lshrrev_b32 v182, 1, v250
    s_xor_b32 s66, s57, 4
    s_lshl_b32 s67, s66, 9
    s_add_u32 s67, s67, 1048576
    s_mul_i32 s66, s66, 4096
    s_add_u32 s66, s66, 14680064
    v_accvgpr_read_b32 v152, a16
    v_accvgpr_read_b32 v153, a17
    v_cvt_pk_bf16_f32 v144, v152, v153
    v_accvgpr_read_b32 v154, a18
    v_accvgpr_read_b32 v155, a19
    v_cvt_pk_bf16_f32 v145, v154, v155
    v_accvgpr_read_b32 v152, a20
    v_accvgpr_read_b32 v153, a21
    v_cvt_pk_bf16_f32 v146, v152, v153
    v_accvgpr_read_b32 v154, a22
    v_accvgpr_read_b32 v155, a23
    v_cvt_pk_bf16_f32 v147, v154, v155
    ds_write_b128 v255, v[144:147] offset:0
    buffer_load_dwordx4 a[0:3], v252, s[8:11], s70 offen offset:0 sc1
    v_accvgpr_read_b32 v152, a24
    v_accvgpr_read_b32 v153, a25
    v_cvt_pk_bf16_f32 v148, v152, v153
    v_accvgpr_read_b32 v154, a26
    v_accvgpr_read_b32 v155, a27
    v_cvt_pk_bf16_f32 v149, v154, v155
    v_accvgpr_read_b32 v152, a28
    v_accvgpr_read_b32 v153, a29
    v_cvt_pk_bf16_f32 v150, v152, v153
    v_accvgpr_read_b32 v154, a30
    v_accvgpr_read_b32 v155, a31
    v_cvt_pk_bf16_f32 v151, v154, v155
    ds_write_b128 v255, v[148:151] offset:1024
    buffer_load_dwordx4 v[4:7], v250, s[8:11], s69 offen offset:1024 sc1
    v_accvgpr_read_b32 v152, a80
    v_accvgpr_read_b32 v153, a81
    v_cvt_pk_bf16_f32 v144, v152, v153
    v_accvgpr_read_b32 v154, a82
    v_accvgpr_read_b32 v155, a83
    v_cvt_pk_bf16_f32 v145, v154, v155
    v_accvgpr_read_b32 v152, a84
    v_accvgpr_read_b32 v153, a85
    v_cvt_pk_bf16_f32 v146, v152, v153
    v_accvgpr_read_b32 v154, a86
    v_accvgpr_read_b32 v155, a87
    v_cvt_pk_bf16_f32 v147, v154, v155
    ds_write_b128 v255, v[144:147] offset:2048
    buffer_load_dwordx4 v[36:39], v252, s[8:11], s69 offen offset:1024 sc1
    v_accvgpr_read_b32 v152, a88
    v_accvgpr_read_b32 v153, a89
    v_cvt_pk_bf16_f32 v148, v152, v153
    v_accvgpr_read_b32 v154, a90
    v_accvgpr_read_b32 v155, a91
    v_cvt_pk_bf16_f32 v149, v154, v155
    v_accvgpr_read_b32 v152, a92
    v_accvgpr_read_b32 v153, a93
    v_cvt_pk_bf16_f32 v150, v152, v153
    v_accvgpr_read_b32 v154, a94
    v_accvgpr_read_b32 v155, a95
    v_cvt_pk_bf16_f32 v151, v154, v155
    ds_write_b128 v255, v[148:151] offset:3072
    buffer_load_dwordx4 v[68:71], v250, s[8:11], s70 offen offset:1024 sc1
    v_accvgpr_read_b32 v152, a32
    v_accvgpr_read_b32 v153, a33
    v_cvt_pk_bf16_f32 v144, v152, v153
    v_accvgpr_read_b32 v154, a34
    v_accvgpr_read_b32 v155, a35
    v_cvt_pk_bf16_f32 v145, v154, v155
    v_accvgpr_read_b32 v152, a36
    v_accvgpr_read_b32 v153, a37
    v_cvt_pk_bf16_f32 v146, v152, v153
    v_accvgpr_read_b32 v154, a38
    v_accvgpr_read_b32 v155, a39
    v_cvt_pk_bf16_f32 v147, v154, v155
    ds_write_b128 v255, v[144:147] offset:4096
    buffer_load_dwordx4 a[4:7], v252, s[8:11], s70 offen offset:1024 sc1
    v_accvgpr_read_b32 v152, a40
    v_accvgpr_read_b32 v153, a41
    v_cvt_pk_bf16_f32 v148, v152, v153
    v_accvgpr_read_b32 v154, a42
    v_accvgpr_read_b32 v155, a43
    v_cvt_pk_bf16_f32 v149, v154, v155
    v_accvgpr_read_b32 v152, a44
    v_accvgpr_read_b32 v153, a45
    v_cvt_pk_bf16_f32 v150, v152, v153
    v_accvgpr_read_b32 v154, a46
    v_accvgpr_read_b32 v155, a47
    v_cvt_pk_bf16_f32 v151, v154, v155
    ds_write_b128 v255, v[148:151] offset:5120
    buffer_load_dwordx4 v[8:11], v250, s[8:11], s69 offen offset:2048 sc1
    v_accvgpr_read_b32 v152, a96
    v_accvgpr_read_b32 v153, a97
    v_cvt_pk_bf16_f32 v144, v152, v153
    v_accvgpr_read_b32 v154, a98
    v_accvgpr_read_b32 v155, a99
    v_cvt_pk_bf16_f32 v145, v154, v155
    v_accvgpr_read_b32 v152, a100
    v_accvgpr_read_b32 v153, a101
    v_cvt_pk_bf16_f32 v146, v152, v153
    v_accvgpr_read_b32 v154, a102
    v_accvgpr_read_b32 v155, a103
    v_cvt_pk_bf16_f32 v147, v154, v155
    ds_write_b128 v255, v[144:147] offset:6144
    buffer_load_dwordx2 v[180:181], v182, s[8:11], s67 offen sc1
    v_accvgpr_read_b32 v152, a104
    v_accvgpr_read_b32 v153, a105
    v_cvt_pk_bf16_f32 v148, v152, v153
    v_accvgpr_read_b32 v154, a106
    v_accvgpr_read_b32 v155, a107
    v_cvt_pk_bf16_f32 v149, v154, v155
    v_accvgpr_read_b32 v152, a108
    v_accvgpr_read_b32 v153, a109
    v_cvt_pk_bf16_f32 v150, v152, v153
    v_accvgpr_read_b32 v154, a110
    v_accvgpr_read_b32 v155, a111
    v_cvt_pk_bf16_f32 v151, v154, v155
    ds_write_b128 v255, v[148:151] offset:7168
    buffer_load_dwordx4 v[160:163], v250, s[8:11], s66 offen offset:0 sc1
    v_accvgpr_read_b32 v152, a48
    v_accvgpr_read_b32 v153, a49
    v_cvt_pk_bf16_f32 v144, v152, v153
    v_accvgpr_read_b32 v154, a50
    v_accvgpr_read_b32 v155, a51
    v_cvt_pk_bf16_f32 v145, v154, v155
    v_accvgpr_read_b32 v152, a52
    v_accvgpr_read_b32 v153, a53
    v_cvt_pk_bf16_f32 v146, v152, v153
    v_accvgpr_read_b32 v154, a54
    v_accvgpr_read_b32 v155, a55
    v_cvt_pk_bf16_f32 v147, v154, v155
    ds_write_b128 v255, v[144:147] offset:8192
    buffer_load_dwordx4 v[164:167], v250, s[8:11], s66 offen offset:1024 sc1
    v_accvgpr_read_b32 v152, a56
    v_accvgpr_read_b32 v153, a57
    v_cvt_pk_bf16_f32 v148, v152, v153
    v_accvgpr_read_b32 v154, a58
    v_accvgpr_read_b32 v155, a59
    v_cvt_pk_bf16_f32 v149, v154, v155
    v_accvgpr_read_b32 v152, a60
    v_accvgpr_read_b32 v153, a61
    v_cvt_pk_bf16_f32 v150, v152, v153
    v_accvgpr_read_b32 v154, a62
    v_accvgpr_read_b32 v155, a63
    v_cvt_pk_bf16_f32 v151, v154, v155
    ds_write_b128 v255, v[148:151] offset:9216
    buffer_load_dwordx4 v[168:171], v250, s[8:11], s66 offen offset:2048 sc1
    v_accvgpr_read_b32 v152, a112
    v_accvgpr_read_b32 v153, a113
    v_cvt_pk_bf16_f32 v144, v152, v153
    v_accvgpr_read_b32 v154, a114
    v_accvgpr_read_b32 v155, a115
    v_cvt_pk_bf16_f32 v145, v154, v155
    v_accvgpr_read_b32 v152, a116
    v_accvgpr_read_b32 v153, a117
    v_cvt_pk_bf16_f32 v146, v152, v153
    v_accvgpr_read_b32 v154, a118
    v_accvgpr_read_b32 v155, a119
    v_cvt_pk_bf16_f32 v147, v154, v155
    ds_write_b128 v255, v[144:147] offset:10240
    buffer_load_dwordx4 v[172:175], v250, s[8:11], s66 offen offset:3072 sc1
    v_accvgpr_read_b32 v152, a120
    v_accvgpr_read_b32 v153, a121
    v_cvt_pk_bf16_f32 v148, v152, v153
    v_accvgpr_read_b32 v154, a122
    v_accvgpr_read_b32 v155, a123
    v_cvt_pk_bf16_f32 v149, v154, v155
    v_accvgpr_read_b32 v152, a124
    v_accvgpr_read_b32 v153, a125
    v_cvt_pk_bf16_f32 v150, v152, v153
    v_accvgpr_read_b32 v154, a126
    v_accvgpr_read_b32 v155, a127
    v_cvt_pk_bf16_f32 v151, v154, v155
    ds_write_b128 v255, v[148:151] offset:11264
    buffer_load_dwordx4 v[40:43], v252, s[8:11], s69 offen offset:2048 sc1
    v_add_u32 v186, s36, v250
    v_add_u32 v187, s37, v250
    v_add_u32 v188, s54, v250
    s_waitcnt lgkmcnt(0)
    s_barrier
    s_nop 0
    ds_read_b128 a[16:19], v186 offset:0
    ds_read_b128 a[20:23], v186 offset:1024
    ds_read_b128 a[24:27], v186 offset:2048
    ds_read_b128 a[28:31], v186 offset:3072
    ds_read_b128 a[32:35], v187 offset:4096
    ds_read_b128 a[36:39], v187 offset:5120
    s_waitcnt lgkmcnt(4)
    v_mfma_f32_16x16x32_bf16 v[208:211], v[242:245], a[16:19], v[208:211]
    ds_read_b128 a[40:43], v187 offset:6144
    ds_read_b128 a[44:47], v187 offset:7168
    v_mfma_f32_16x16x32_bf16 v[212:215], v[240:243], a[16:19], v[212:215]
    buffer_load_dwordx4 v[72:75], v250, s[8:11], s70 offen offset:2048 sc1
    v_mfma_f32_16x16x32_bf16 v[216:219], v[242:245], a[20:23], v[216:219]
    ds_read_b128 a[48:51], v188 offset:8192
    ds_read_b128 a[52:55], v188 offset:9216
    v_mfma_f32_16x16x32_bf16 v[220:223], v[240:243], a[20:23], v[220:223]
    s_waitcnt lgkmcnt(6)
    v_bfe_u32 v156, v250, 6, 2
    v_bfe_u32 v157, v250, 8, 2
    v_mfma_f32_16x16x32_bf16 v[224:227], v[242:245], a[24:27], v[224:227]
    ds_read_b128 a[56:59], v188 offset:10240
    ds_read_b128 a[60:63], v188 offset:11264
    v_mfma_f32_16x16x32_bf16 v[228:231], v[240:243], a[24:27], v[228:231]
    buffer_load_dwordx4 a[8:11], v252, s[8:11], s70 offen offset:2048 sc1
    v_mfma_f32_16x16x32_bf16 v[232:235], v[242:245], a[28:31], v[232:235]
    v_lshl_add_u32 v184, v157, 3, v156
    v_lshlrev_b32 v184, 6, v184
    v_mfma_f32_16x16x32_bf16 v[236:239], v[240:243], a[28:31], v[236:239]
    s_waitcnt lgkmcnt(6)
    v_lshrrev_b32 v156, 1, v156
    v_bfe_u32 v158, v250, 5, 1
    v_mfma_f32_16x16x32_bf16 v[208:211], v[242:245], a[32:35], v[208:211]
    v_xor_b32 v156, v156, v158
    v_and_b32 v157, 1, v157
    v_mfma_f32_16x16x32_bf16 v[212:215], v[240:243], a[32:35], v[212:215]
    buffer_load_dwordx4 v[12:15], v250, s[8:11], s69 offen offset:3072 sc1
    v_mfma_f32_16x16x32_bf16 v[216:219], v[242:245], a[36:39], v[216:219]
    v_lshl_add_u32 v156, v157, 1, v156
    v_lshl_add_u32 v184, v156, 4, v184
    v_mfma_f32_16x16x32_bf16 v[220:223], v[240:243], a[36:39], v[220:223]
    s_waitcnt lgkmcnt(4)
    v_bfe_u32 v158, v250, 4, 1
    v_lshl_add_u32 v184, v158, 3, v184
    v_mfma_f32_16x16x32_bf16 v[224:227], v[242:245], a[40:43], v[224:227]
    v_add_u32 v184, 131072, v184
    v_xor_b32 v185, 32, v184
    v_mfma_f32_16x16x32_bf16 v[228:231], v[240:243], a[40:43], v[228:231]
    buffer_load_dwordx4 v[44:47], v252, s[8:11], s69 offen offset:3072 sc1
    v_mfma_f32_16x16x32_bf16 v[232:235], v[242:245], a[44:47], v[232:235]
    ds_read_b64_tr_b16 v[128:129], v184 offset:0
    ds_read_b64_tr_b16 v[130:131], v185 offset:256
    v_mfma_f32_16x16x32_bf16 v[236:239], v[240:243], a[44:47], v[236:239]
    s_waitcnt lgkmcnt(4)
    v_and_b32 v190, 0x300, v250
    v_bfe_u32 v191, v250, 4, 4
    v_mfma_f32_16x16x32_bf16 v[208:211], v[242:245], a[48:51], v[208:211]
    ds_read_b64_tr_b16 v[132:133], v185 offset:0
    ds_read_b64_tr_b16 v[134:135], v184 offset:256
    v_mfma_f32_16x16x32_bf16 v[212:215], v[240:243], a[48:51], v[212:215]
    buffer_load_dwordx4 v[76:79], v250, s[8:11], s70 offen offset:3072 sc1
    v_mfma_f32_16x16x32_bf16 v[216:219], v[242:245], a[52:55], v[216:219]
    ds_read_b64_tr_b16 v[136:137], v184 offset:2048
    ds_read_b64_tr_b16 v[138:139], v185 offset:2304
    v_mfma_f32_16x16x32_bf16 v[220:223], v[240:243], a[52:55], v[220:223]
    s_waitcnt lgkmcnt(6)
    v_lshlrev_b32 v191, 3, v191
    v_lshl_add_u32 v190, v190, 2, v191
    v_mfma_f32_16x16x32_bf16 v[224:227], v[242:245], a[56:59], v[224:227]
    ds_read_b64_tr_b16 v[140:141], v185 offset:2048
    ds_read_b64_tr_b16 v[142:143], v184 offset:2304
    v_mfma_f32_16x16x32_bf16 v[228:231], v[240:243], a[56:59], v[228:231]
    buffer_load_dwordx4 a[12:15], v252, s[8:11], s70 offen offset:3072 sc1
    v_mfma_f32_16x16x32_bf16 v[232:235], v[242:245], a[60:63], v[232:235]
    v_add_u32 v190, s73, v190
    v_mfma_f32_16x16x32_bf16 v[236:239], v[240:243], a[60:63], v[236:239]
    s_waitcnt vmcnt(63) lgkmcnt(4)
    ds_read_b64 v[192:193], v190 offset:16384
    ds_read_b64 v[194:195], v190 offset:16512
    v_mfma_f32_16x16x32_bf16 v[96:99], v[128:131], a[128:131], 0
    ds_read_b64_tr_b16 v[144:145], v184 offset:4096
    ds_read_b64_tr_b16 v[146:147], v185 offset:4352
    v_mfma_f32_16x16x32_bf16 v[100:103], v[132:135], a[128:131], 0
    buffer_load_dwordx4 v[16:19], v251, s[8:11], s69 offen offset:0 sc1
    v_mfma_f32_16x16x32_bf16 v[104:107], v[128:131], a[160:163], 0
    ds_read_b64_tr_b16 v[148:149], v185 offset:4096
    ds_read_b64_tr_b16 v[150:151], v184 offset:4352
    v_mfma_f32_16x16x32_bf16 v[108:111], v[132:135], a[160:163], 0
    ds_read_b64 v[196:197], v190 offset:16640
    ds_read_b64 v[198:199], v190 offset:16768
    v_mfma_f32_16x16x32_bf16 v[112:115], v[128:131], a[192:195], 0
    ds_read_b64 v[200:201], v190 offset:16896
    ds_read_b64 v[202:203], v190 offset:17024
    v_mfma_f32_16x16x32_bf16 v[116:119], v[132:135], a[192:195], 0
    buffer_load_dwordx4 v[48:51], v253, s[8:11], s69 offen offset:0 sc1
    v_mfma_f32_16x16x32_bf16 v[120:123], v[128:131], a[224:227], 0
    ds_read_b64 v[204:205], v190 offset:17152
    ds_read_b64 v[206:207], v190 offset:17280
    v_mfma_f32_16x16x32_bf16 v[124:127], v[132:135], a[224:227], 0
    s_waitcnt vmcnt(63) lgkmcnt(12)
    v_mfma_f32_16x16x32_bf16 v[96:99], v[136:139], a[132:135], v[96:99]
L_pad6:
    s_cbranch_execz L_padret
    ds_read_b64_tr_b16 v[152:153], v184 offset:6144
    ds_read_b64_tr_b16 v[154:155], v185 offset:6400
    v_mfma_f32_16x16x32_bf16 v[100:103], v[140:143], a[132:135], v[100:103]
    buffer_load_dwordx4 v[80:83], v251, s[8:11], s70 offen offset:0 sc1
    v_mfma_f32_16x16x32_bf16 v[104:107], v[136:139], a[164:167], v[104:107]
    ds_read_b64_tr_b16 v[156:157], v185 offset:6144
    ds_read_b64_tr_b16 v[158:159], v184 offset:6400
    v_mfma_f32_16x16x32_bf16 v[108:111], v[140:143], a[164:167], v[108:111]
    v_mfma_f32_16x16x32_bf16 v[112:115], v[136:139], a[196:199], v[112:115]
    s_waitcnt vmcnt(10)
    v_mov_b32 v176, v181
    v_mov_b32 v178, v181
    v_mfma_f32_16x16x32_bf16 v[116:119], v[140:143], a[196:199], v[116:119]
    buffer_load_dwordx4 a[64:67], v253, s[8:11], s70 offen offset:0 sc1
    v_mfma_f32_16x16x32_bf16 v[120:123], v[136:139], a[228:231], v[120:123]
    v_add_u32 v189, s4, v181
    v_add3_u32 v189, v189, v160, v161
    v_mfma_f32_16x16x32_bf16 v[124:127], v[140:143], a[228:231], v[124:127]
    s_waitcnt vmcnt(63) lgkmcnt(10)
    v_permlane32_swap_b32 v176, v178
    v_mov_b32 v177, v176
    v_mfma_f32_16x16x32_bf16 v[96:99], v[144:147], a[136:139], v[96:99]
    v_mov_b32 v179, v178
    v_add3_u32 v189, v189, v162, v163
    v_mfma_f32_16x16x32_bf16 v[100:103], v[148:151], a[136:139], v[100:103]
    buffer_load_dwordx4 v[20:23], v251, s[8:11], s69 offen offset:1024 sc1
    v_mfma_f32_16x16x32_bf16 v[104:107], v[144:147], a[168:171], v[104:107]
    v_add3_u32 v189, v189, v164, v165
    v_permlane16_swap_b32 v176, v177
    v_mfma_f32_16x16x32_bf16 v[108:111], v[148:151], a[168:171], v[108:111]
    v_permlane16_swap_b32 v178, v179
    v_add3_u32 v189, v189, v166, v167
    v_mfma_f32_16x16x32_bf16 v[112:115], v[144:147], a[200:203], v[112:115]
    v_add3_u32 v189, v189, v168, v169
    v_add3_u32 v189, v189, v170, v171
    v_mfma_f32_16x16x32_bf16 v[116:119], v[148:151], a[200:203], v[116:119]
    buffer_load_dwordx4 v[52:55], v253, s[8:11], s69 offen offset:1024 sc1
    v_mfma_f32_16x16x32_bf16 v[120:123], v[144:147], a[232:235], v[120:123]
    v_add3_u32 v189, v189, v172, v173
    v_add3_u32 v189, v189, v174, v175
    v_mfma_f32_16x16x32_bf16 v[124:127], v[148:151], a[232:235], v[124:127]
    s_waitcnt vmcnt(62) lgkmcnt(0)
    v_cmp_eq_u32 vcc, v189, v180
    v_cmp_eq_u32 s[60:61], v246, v178
    v_mfma_f32_16x16x32_bf16 v[96:99], v[152:155], a[140:143], v[96:99]
    ds_read_b64_tr_b16 v[128:129], v184 offset:8192
    ds_read_b64_tr_b16 v[130:131], v185 offset:8448
    v_mfma_f32_16x16x32_bf16 v[100:103], v[156:159], a[140:143], v[100:103]
    buffer_load_dwordx4 v[84:87], v251, s[8:11], s70 offen offset:1024 sc1
    v_mfma_f32_16x16x32_bf16 v[104:107], v[152:155], a[172:175], v[104:107]
    ds_read_b64_tr_b16 v[132:133], v185 offset:8192
    ds_read_b64_tr_b16 v[134:135], v184 offset:8448
    v_mfma_f32_16x16x32_bf16 v[108:111], v[156:159], a[172:175], v[108:111]
    v_cmp_eq_u32 s[62:63], v247, v179
    s_nop 0
    v_mfma_f32_16x16x32_bf16 v[112:115], v[152:155], a[204:207], v[112:115]
    s_and_b64 vcc, vcc, s[60:61]
    s_and_b64 vcc, vcc, s[62:63]
    v_mfma_f32_16x16x32_bf16 v[116:119], v[156:159], a[204:207], v[116:119]
    buffer_load_dwordx4 a[68:71], v253, s[8:11], s70 offen offset:1024 sc1
    v_mfma_f32_16x16x32_bf16 v[120:123], v[152:155], a[236:239], v[120:123]
    v_mfma_f32_16x16x32_bf16 v[124:127], v[156:159], a[236:239], v[124:127]
    s_cmp_eq_u64 vcc, -1
    s_cbranch_scc0 L_plate
L_pok:
    v_mfma_f32_16x16x32_bf16 v[208:211], v[242:245], v[160:163], v[208:211]
    ds_read_b64_tr_b16 v[136:137], v184 offset:10240
    ds_read_b64_tr_b16 v[138:139], v185 offset:10496
    v_mfma_f32_16x16x32_bf16 v[212:215], v[240:243], v[160:163], v[212:215]
    buffer_load_dwordx4 v[24:27], v251, s[8:11], s69 offen offset:2048 sc1
    v_mfma_f32_16x16x32_bf16 v[216:219], v[242:245], v[164:167], v[216:219]
    ds_read_b64_tr_b16 v[140:141], v185 offset:10240
    ds_read_b64_tr_b16 v[142:143], v184 offset:10496
    v_mfma_f32_16x16x32_bf16 v[220:223], v[240:243], v[164:167], v[220:223]
    v_add_f32 v248, v248, v176
    v_add_f32 v249, v249, v177
    v_mfma_f32_16x16x32_bf16 v[224:227], v[242:245], v[168:171], v[224:227]
    s_lshl_b32 s35, s3, 11
    s_add_u32 s35, s35, 147456
    v_add_u32 v255, s35, v250
    v_mfma_f32_16x16x32_bf16 v[228:231], v[240:243], v[168:171], v[228:231]
    buffer_load_dwordx4 v[56:59], v253, s[8:11], s69 offen offset:2048 sc1
    v_mfma_f32_16x16x32_bf16 v[232:235], v[242:245], v[172:175], v[232:235]
    v_cvt_pk_bf16_f32 v208, v208, v209
    v_cvt_pk_bf16_f32 v209, v210, v211
    v_mfma_f32_16x16x32_bf16 v[236:239], v[240:243], v[172:175], v[236:239]
    s_waitcnt vmcnt(62) lgkmcnt(4)
    v_cvt_pk_bf16_f32 v210, v212, v213
    v_cvt_pk_bf16_f32 v211, v214, v215
    v_mfma_f32_16x16x32_bf16 v[96:99], v[128:131], a[144:147], v[96:99]
    ds_read_b64_tr_b16 v[144:145], v184 offset:12288
    ds_read_b64_tr_b16 v[146:147], v185 offset:12544
    v_mfma_f32_16x16x32_bf16 v[100:103], v[132:135], a[144:147], v[100:103]
    buffer_load_dwordx4 v[88:91], v251, s[8:11], s70 offen offset:2048 sc1
    v_mfma_f32_16x16x32_bf16 v[104:107], v[128:131], a[176:179], v[104:107]
    ds_read_b64_tr_b16 v[148:149], v185 offset:12288
    ds_read_b64_tr_b16 v[150:151], v184 offset:12544
    v_mfma_f32_16x16x32_bf16 v[108:111], v[132:135], a[176:179], v[108:111]
    ds_write_b128 v255, v[208:211] offset:0
    v_cvt_pk_bf16_f32 v216, v216, v217
    v_mfma_f32_16x16x32_bf16 v[112:115], v[128:131], a[208:211], v[112:115]
    v_cvt_pk_bf16_f32 v217, v218, v219
    v_cvt_pk_bf16_f32 v218, v220, v221
    v_mfma_f32_16x16x32_bf16 v[116:119], v[132:135], a[208:211], v[116:119]
    buffer_load_dwordx4 a[72:75], v253, s[8:11], s70 offen offset:2048 sc1
    v_mfma_f32_16x16x32_bf16 v[120:123], v[128:131], a[240:243], v[120:123]
    v_cvt_pk_bf16_f32 v219, v222, v223
    v_cvt_pk_bf16_f32 v224, v224, v225
    v_mfma_f32_16x16x32_bf16 v[124:127], v[132:135], a[240:243], v[124:127]
    s_waitcnt vmcnt(41) lgkmcnt(5)
    ds_write_b128 v255, v[216:219] offset:1024
    v_cvt_pk_bf16_f32 v225, v226, v227
    v_mfma_f32_16x16x32_bf16 v[96:99], v[136:139], a[148:151], v[96:99]
    ds_read_b64_tr_b16 v[152:153], v184 offset:14336
    ds_read_b64_tr_b16 v[154:155], v185 offset:14592
    v_mfma_f32_16x16x32_bf16 v[100:103], v[140:143], a[148:151], v[100:103]
    buffer_load_dwordx4 v[28:31], v251, s[8:11], s69 offen offset:3072 sc1
    v_mfma_f32_16x16x32_bf16 v[104:107], v[136:139], a[180:183], v[104:107]
    ds_read_b64_tr_b16 v[156:157], v185 offset:14336
    ds_read_b64_tr_b16 v[158:159], v184 offset:14592
    v_mfma_f32_16x16x32_bf16 v[108:111], v[140:143], a[180:183], v[108:111]
    v_cvt_pk_bf16_f32 v226, v228, v229
    v_cvt_pk_bf16_f32 v227, v230, v231
    v_mfma_f32_16x16x32_bf16 v[112:115], v[136:139], a[212:215], v[112:115]
    ds_write_b128 v255, v[224:227] offset:8192
    v_cvt_pk_bf16_f32 v232, v232, v233
    v_mfma_f32_16x16x32_bf16 v[116:119], v[140:143], a[212:215], v[116:119]
    buffer_load_dwordx4 v[60:63], v253, s[8:11], s69 offen offset:3072 sc1
    v_mfma_f32_16x16x32_bf16 v[120:123], v[136:139], a[244:247], v[120:123]
    v_cvt_pk_bf16_f32 v233, v234, v235
    v_cvt_pk_bf16_f32 v234, v236, v237
    v_mfma_f32_16x16x32_bf16 v[124:127], v[140:143], a[244:247], v[124:127]
    s_waitcnt vmcnt(39) lgkmcnt(7)
    v_cvt_pk_bf16_f32 v235, v238, v239
    v_mfma_f32_16x16x32_bf16 v[96:99], v[144:147], a[152:155], v[96:99]
    ds_write_b128 v255, v[232:235] offset:9216
    v_mfma_f32_16x16x32_bf16 v[100:103], v[148:151], a[152:155], v[100:103]
    buffer_load_dwordx4 v[92:95], v251, s[8:11], s70 offen offset:3072 sc1
    v_mfma_f32_16x16x32_bf16 v[104:107], v[144:147], a[184:187], v[104:107]
    v_mfma_f32_16x16x32_bf16 v[108:111], v[148:151], a[184:187], v[108:111]
    v_mfma_f32_16x16x32_bf16 v[112:115], v[144:147], a[216:219], v[112:115]
    v_add_u32 v255, 147456, v250
    v_mfma_f32_16x16x32_bf16 v[116:119], v[148:151], a[216:219], v[116:119]
    buffer_load_dwordx4 a[76:79], v253, s[8:11], s70 offen offset:3072 sc1
    v_mfma_f32_16x16x32_bf16 v[120:123], v[144:147], a[248:251], v[120:123]
    v_mfma_f32_16x16x32_bf16 v[124:127], v[148:151], a[248:251], v[124:127]
    s_waitcnt vmcnt(37) lgkmcnt(0)
    v_mfma_f32_16x16x32_bf16 v[96:99], v[152:155], a[156:159], v[96:99]
    s_barrier
    ds_read_b128 v[128:131], v255 offset:0
    ds_read_b128 v[132:135], v255 offset:8192
    v_mfma_f32_16x16x32_bf16 v[100:103], v[156:159], a[156:159], v[100:103]
    ds_read_b128 v[136:139], v255 offset:1024
    ds_read_b128 v[140:143], v255 offset:9216
    v_mfma_f32_16x16x32_bf16 v[104:107], v[152:155], a[188:191], v[104:107]
    v_mfma_f32_16x16x32_bf16 v[108:111], v[156:159], a[188:191], v[108:111]
    v_mfma_f32_16x16x32_bf16 v[112:115], v[152:155], a[220:223], v[112:115]
    v_mfma_f32_16x16x32_bf16 v[116:119], v[156:159], a[220:223], v[116:119]
    v_mfma_f32_16x16x32_bf16 v[120:123], v[152:155], a[252:255], v[120:123]
    v_mfma_f32_16x16x32_bf16 v[124:127], v[156:159], a[252:255], v[124:127]
    s_waitcnt vmcnt(33) lgkmcnt(2)
    v_mfma_f32_16x16x32_bf16 v[160:163], v[128:131], v[0:3], 0
    ds_read_b128 v[144:147], v255 offset:2048
    v_mfma_f32_16x16x32_bf16 v[168:171], v[128:131], v[32:35], 0
    v_rcp_f32 v248, v248
    v_mfma_f32_16x16x32_bf16 v[176:179], v[128:131], v[64:67], 0
    v_rcp_f32 v249, v249
    v_mfma_f32_16x16x32_bf16 v[184:187], v[128:131], a[0:3], 0
    v_bfe_u32 v246, v250, 4, 4
    v_lshl_add_u32 v246, v246, 2, s73
    v_mfma_f32_16x16x32_bf16 v[164:167], v[132:135], v[0:3], 0
    ds_read_b128 v[148:151], v255 offset:3072
    v_bfe_u32 v247, v250, 8, 2
    v_mfma_f32_16x16x32_bf16 v[172:175], v[132:135], v[32:35], 0
    v_lshl_add_u32 v247, v247, 4, s73
    v_mfma_f32_16x16x32_bf16 v[180:183], v[132:135], v[64:67], 0
    ds_write_b32 v246, v248 offset:12288
    ds_write_b32 v246, v249 offset:12352
    v_mfma_f32_16x16x32_bf16 v[188:191], v[132:135], a[0:3], 0
    s_waitcnt vmcnt(29) lgkmcnt(4)
    ds_read_b128 v[208:211], v247 offset:12288
    ds_read_b128 v[212:215], v247 offset:12352
    v_mfma_f32_16x16x32_bf16 v[160:163], v[136:139], v[4:7], v[160:163]
    s_waitcnt lgkmcnt(15)
    ds_read_b128 v[152:155], v255 offset:4096
    v_lshlrev_b32 v216, 16, v192
    v_mfma_f32_16x16x32_bf16 v[168:171], v[136:139], v[36:39], v[168:171]
    v_and_b32 v217, s101, v192
    v_add_f32 v96, v96, v216
    v_mfma_f32_16x16x32_bf16 v[176:179], v[136:139], v[68:71], v[176:179]
    v_add_f32 v104, v104, v217
    v_lshlrev_b32 v216, 16, v193
    v_mfma_f32_16x16x32_bf16 v[184:187], v[136:139], a[4:7], v[184:187]
    v_and_b32 v217, s101, v193
    v_add_f32 v112, v112, v216
    v_mfma_f32_16x16x32_bf16 v[164:167], v[140:143], v[4:7], v[164:167]
    ds_read_b128 v[156:159], v255 offset:5120
    v_add_f32 v120, v120, v217
    v_mfma_f32_16x16x32_bf16 v[172:175], v[140:143], v[36:39], v[172:175]
    v_lshlrev_b32 v216, 16, v194
    v_and_b32 v217, s101, v194
    v_mfma_f32_16x16x32_bf16 v[180:183], v[140:143], v[68:71], v[180:183]
    v_add_f32 v97, v97, v216
    v_add_f32 v105, v105, v217
    v_mfma_f32_16x16x32_bf16 v[188:191], v[140:143], a[4:7], v[188:191]
    s_waitcnt vmcnt(16) lgkmcnt(6)
    v_lshlrev_b32 v216, 16, v195
    v_and_b32 v217, s101, v195
    v_mfma_f32_16x16x32_bf16 v[160:163], v[144:147], v[8:11], v[160:163]
    ds_read_b128 v[128:131], v255 offset:6144
    v_add_f32 v113, v113, v216
    v_mfma_f32_16x16x32_bf16 v[168:171], v[144:147], v[40:43], v[168:171]
    v_add_f32 v121, v121, v217
    v_lshlrev_b32 v216, 16, v196
    v_mfma_f32_16x16x32_bf16 v[176:179], v[144:147], v[72:75], v[176:179]
    v_and_b32 v217, s101, v196
    v_add_f32 v98, v98, v216
    v_mfma_f32_16x16x32_bf16 v[184:187], v[144:147], a[8:11], v[184:187]
    v_add_f32 v106, v106, v217
    v_lshlrev_b32 v216, 16, v197
    v_mfma_f32_16x16x32_bf16 v[160:163], v[148:151], v[12:15], v[160:163]
    ds_read_b128 v[132:135], v255 offset:7168
    v_and_b32 v217, s101, v197
    v_mfma_f32_16x16x32_bf16 v[168:171], v[148:151], v[44:47], v[168:171]
    v_add_f32 v114, v114, v216
    v_add_f32 v122, v122, v217
    v_mfma_f32_16x16x32_bf16 v[176:179], v[148:151], v[76:79], v[176:179]
    v_lshlrev_b32 v216, 16, v198
    v_and_b32 v217, s101, v198
    v_mfma_f32_16x16x32_bf16 v[184:187], v[148:151], a[12:15], v[184:187]
    s_waitcnt vmcnt(8) lgkmcnt(2)
    v_add_f32 v99, v99, v216
    v_add_f32 v107, v107, v217
    v_mfma_f32_16x16x32_bf16 v[160:163], v[152:155], v[16:19], v[160:163]
    ds_read_b128 v[136:139], v255 offset:10240
    v_lshlrev_b32 v216, 16, v199
    v_mfma_f32_16x16x32_bf16 v[168:171], v[152:155], v[48:51], v[168:171]
    v_and_b32 v217, s101, v199
    v_add_f32 v115, v115, v216
    v_mfma_f32_16x16x32_bf16 v[176:179], v[152:155], v[80:83], v[176:179]
    v_add_f32 v123, v123, v217
    v_mfma_f32_16x16x32_bf16 v[184:187], v[152:155], a[64:67], v[184:187]
    v_lshlrev_b32 v216, 16, v200
    v_and_b32 v217, s101, v200
    v_mfma_f32_16x16x32_bf16 v[160:163], v[156:159], v[20:23], v[160:163]
    ds_read_b128 v[140:143], v255 offset:11264
    v_add_f32 v100, v100, v216
    v_mfma_f32_16x16x32_bf16 v[168:171], v[156:159], v[52:55], v[168:171]
    v_add_f32 v108, v108, v217
    v_lshlrev_b32 v216, 16, v201
    v_mfma_f32_16x16x32_bf16 v[176:179], v[156:159], v[84:87], v[176:179]
    v_and_b32 v217, s101, v201
    v_add_f32 v116, v116, v216
    v_mfma_f32_16x16x32_bf16 v[184:187], v[156:159], a[68:71], v[184:187]
    s_waitcnt vmcnt(0) lgkmcnt(2)
    v_add_f32 v124, v124, v217
    v_lshlrev_b32 v216, 16, v202
    v_mfma_f32_16x16x32_bf16 v[160:163], v[128:131], v[24:27], v[160:163]
    ds_read_b128 v[144:147], v255 offset:12288
    v_and_b32 v217, s101, v202
    v_mfma_f32_16x16x32_bf16 v[168:171], v[128:131], v[56:59], v[168:171]
    v_add_f32 v101, v101, v216
    v_add_f32 v109, v109, v217
    v_mfma_f32_16x16x32_bf16 v[176:179], v[128:131], v[88:91], v[176:179]
    v_lshlrev_b32 v216, 16, v203
    v_and_b32 v217, s101, v203
    v_mfma_f32_16x16x32_bf16 v[184:187], v[128:131], a[72:75], v[184:187]
    v_add_f32 v117, v117, v216
    v_add_f32 v125, v125, v217
    v_mfma_f32_16x16x32_bf16 v[160:163], v[132:135], v[28:31], v[160:163]
    ds_read_b128 v[148:151], v255 offset:13312
    v_lshlrev_b32 v216, 16, v204
    v_mfma_f32_16x16x32_bf16 v[168:171], v[132:135], v[60:63], v[168:171]
    v_and_b32 v217, s101, v204
    v_add_f32 v102, v102, v216
    v_mfma_f32_16x16x32_bf16 v[176:179], v[132:135], v[92:95], v[176:179]
    v_add_f32 v110, v110, v217
    v_lshlrev_b32 v216, 16, v205
    v_mfma_f32_16x16x32_bf16 v[184:187], v[132:135], a[76:79], v[184:187]
    s_waitcnt vmcnt(16) lgkmcnt(2)
    v_and_b32 v217, s101, v205
    v_add_f32 v118, v118, v216
    v_mfma_f32_16x16x32_bf16 v[164:167], v[136:139], v[8:11], v[164:167]
    ds_read_b128 v[152:155], v255 offset:14336
    v_add_f32 v126, v126, v217
    v_mfma_f32_16x16x32_bf16 v[172:175], v[136:139], v[40:43], v[172:175]
    v_lshlrev_b32 v216, 16, v206
    v_and_b32 v217, s101, v206
    v_mfma_f32_16x16x32_bf16 v[180:183], v[136:139], v[72:75], v[180:183]
    v_add_f32 v103, v103, v216
    v_add_f32 v111, v111, v217
    v_mfma_f32_16x16x32_bf16 v[188:191], v[136:139], a[8:11], v[188:191]
    v_lshlrev_b32 v216, 16, v207
    v_and_b32 v217, s101, v207
    v_mfma_f32_16x16x32_bf16 v[164:167], v[140:143], v[12:15], v[164:167]
    s_waitcnt lgkmcnt(9)
    ds_read_b128 v[156:159], v255 offset:15360
    v_fmac_f32 v96, v160, v208
    v_mfma_f32_16x16x32_bf16 v[172:175], v[140:143], v[44:47], v[172:175]
    v_fmac_f32 v104, v168, v208
    v_fmac_f32 v112, v176, v208
    v_mfma_f32_16x16x32_bf16 v[180:183], v[140:143], v[76:79], v[180:183]
    v_fmac_f32 v120, v184, v208
    v_cvt_pk_bf16_f32 v224, v96, v104
    v_mfma_f32_16x16x32_bf16 v[188:191], v[140:143], a[12:15], v[188:191]
    s_waitcnt vmcnt(8) lgkmcnt(2)
    v_cvt_pk_bf16_f32 v225, v112, v120
    v_mfma_f32_16x16x32_bf16 v[164:167], v[144:147], v[16:19], v[164:167]
    buffer_store_dwordx2 v[224:225], v254, s[16:19], s45 offen offset:0 sc1
    v_mfma_f32_16x16x32_bf16 v[172:175], v[144:147], v[48:51], v[172:175]
    v_fmac_f32 v97, v161, v209
    v_fmac_f32 v105, v169, v209
    v_mfma_f32_16x16x32_bf16 v[180:183], v[144:147], v[80:83], v[180:183]
    v_fmac_f32 v113, v177, v209
    v_fmac_f32 v121, v185, v209
    v_mfma_f32_16x16x32_bf16 v[188:191], v[144:147], a[64:67], v[188:191]
    v_cvt_pk_bf16_f32 v226, v97, v105
    v_cvt_pk_bf16_f32 v227, v113, v121
    v_mfma_f32_16x16x32_bf16 v[164:167], v[148:151], v[20:23], v[164:167]
    buffer_store_dwordx2 v[226:227], v254, s[16:19], s45 offen offset:512 sc1
    v_mfma_f32_16x16x32_bf16 v[172:175], v[148:151], v[52:55], v[172:175]
    v_fmac_f32 v98, v162, v210
    v_fmac_f32 v106, v170, v210
    v_mfma_f32_16x16x32_bf16 v[180:183], v[148:151], v[84:87], v[180:183]
    v_fmac_f32 v114, v178, v210
    v_fmac_f32 v122, v186, v210
    v_mfma_f32_16x16x32_bf16 v[188:191], v[148:151], a[68:71], v[188:191]
    s_waitcnt vmcnt(2) lgkmcnt(0)
    v_cvt_pk_bf16_f32 v228, v98, v106
    v_cvt_pk_bf16_f32 v229, v114, v122
    v_mfma_f32_16x16x32_bf16 v[164:167], v[152:155], v[24:27], v[164:167]
    buffer_store_dwordx2 v[228:229], v254, s[16:19], s45 offen offset:1024 sc1
    v_mfma_f32_16x16x32_bf16 v[172:175], v[152:155], v[56:59], v[172:175]
    v_fmac_f32 v99, v163, v211
    v_fmac_f32 v107, v171, v211
    v_mfma_f32_16x16x32_bf16 v[180:183], v[152:155], v[88:91], v[180:183]
    v_fmac_f32 v115, v179, v211
    v_fmac_f32 v123, v187, v211
    v_mfma_f32_16x16x32_bf16 v[188:191], v[152:155], a[72:75], v[188:191]
    v_cvt_pk_bf16_f32 v230, v99, v107
    v_cvt_pk_bf16_f32 v231, v115, v123
    v_mfma_f32_16x16x32_bf16 v[164:167], v[156:159], v[28:31], v[164:167]
    buffer_store_dwordx2 v[230:231], v254, s[16:19], s45 offen offset:1536 sc1
    v_mfma_f32_16x16x32_bf16 v[172:175], v[156:159], v[60:63], v[172:175]
    v_add_f32 v119, v119, v216
    v_add_f32 v127, v127, v217
    v_mfma_f32_16x16x32_bf16 v[180:183], v[156:159], v[92:95], v[180:183]
    v_mfma_f32_16x16x32_bf16 v[188:191], v[156:159], a[76:79], v[188:191]
    s_nop 4
    s_nop 0
    v_pk_fma_f32 v[100:101], v[164:165], v[212:213], v[100:101]
    v_pk_fma_f32 v[102:103], v[166:167], v[214:215], v[102:103]
    v_pk_fma_f32 v[108:109], v[172:173], v[212:213], v[108:109]
    v_pk_fma_f32 v[110:111], v[174:175], v[214:215], v[110:111]
    v_pk_fma_f32 v[116:117], v[180:181], v[212:213], v[116:117]
    v_pk_fma_f32 v[118:119], v[182:183], v[214:215], v[118:119]
    v_pk_fma_f32 v[124:125], v[188:189], v[212:213], v[124:125]
    v_pk_fma_f32 v[126:127], v[190:191], v[214:215], v[126:127]
    v_cvt_pk_bf16_f32 v232, v100, v108
    v_cvt_pk_bf16_f32 v233, v116, v124
    v_cvt_pk_bf16_f32 v234, v101, v109
    v_cvt_pk_bf16_f32 v235, v117, v125
    v_cvt_pk_bf16_f32 v236, v102, v110
    v_cvt_pk_bf16_f32 v237, v118, v126
    v_cvt_pk_bf16_f32 v238, v103, v111
    v_cvt_pk_bf16_f32 v239, v119, v127
    buffer_store_dwordx2 v[232:233], v254, s[16:19], s45 offen offset:2048 sc1
    buffer_store_dwordx2 v[234:235], v254, s[16:19], s45 offen offset:2560 sc1
    buffer_store_dwordx2 v[236:237], v254, s[16:19], s45 offen offset:3072 sc1
    buffer_store_dwordx2 v[238:239], v254, s[16:19], s45 offen offset:3584 sc1
    s_endpgm
L_pad7:
    s_branch L_padret
L_upath:
    v_mfma_f32_16x16x32_bf16 v[0:3], v[176:179], v[170:173], 0
    s_add_u32 m0, s60, 0x1000
    v_mfma_f32_16x16x32_bf16 v[16:19], v[176:179], v[168:171], 0
    buffer_load_dwordx4 v251, s[8:11], s65 offen offset:0 sc1 lds
    v_mfma_f32_16x16x32_bf16 v[32:35], v[180:183], v[170:173], 0
    v_cvt_pk_bf16_f32 v224, v96, v97
    v_cvt_pk_bf16_f32 v225, v98, v99
    v_mfma_f32_16x16x32_bf16 v[48:51], v[180:183], v[168:171], 0
    v_cvt_pk_bf16_f32 v226, v112, v113
    v_cvt_pk_bf16_f32 v227, v114, v115
    v_mfma_f32_16x16x32_bf16 v[4:7], v[184:187], v[170:173], 0
    ds_write_b128 v240, v[224:227] offset:1024
    v_cvt_pk_bf16_f32 v228, v100, v101
    v_mfma_f32_16x16x32_bf16 v[20:23], v[184:187], v[168:171], 0
    buffer_load_dwordx4 v251, s[8:11], s65 offen offset:1024 sc1 lds
    v_mfma_f32_16x16x32_bf16 v[36:39], v[188:191], v[170:173], 0
    v_cvt_pk_bf16_f32 v229, v102, v103
    v_cvt_pk_bf16_f32 v230, v116, v117
    v_mfma_f32_16x16x32_bf16 v[52:55], v[188:191], v[168:171], 0
    v_cvt_pk_bf16_f32 v231, v118, v119
    v_mfma_f32_16x16x32_bf16 v[8:11], v[192:195], v[170:173], 0
    ds_write_b128 v240, v[228:231] offset:9216
    v_cvt_pk_bf16_f32 v232, v104, v105
    v_mfma_f32_16x16x32_bf16 v[24:27], v[192:195], v[168:171], 0
    buffer_load_dwordx4 v251, s[8:11], s65 offen offset:2048 sc1 lds
    v_mfma_f32_16x16x32_bf16 v[40:43], v[196:199], v[170:173], 0
    v_cvt_pk_bf16_f32 v233, v106, v107
    v_cvt_pk_bf16_f32 v234, v120, v121
    v_mfma_f32_16x16x32_bf16 v[56:59], v[196:199], v[168:171], 0
    v_cvt_pk_bf16_f32 v235, v122, v123
    v_mfma_f32_16x16x32_bf16 v[12:15], v[200:203], v[170:173], 0
    ds_write_b128 v240, v[232:235] offset:17408
    v_cvt_pk_bf16_f32 v236, v108, v109
    v_mfma_f32_16x16x32_bf16 v[28:31], v[200:203], v[168:171], 0
    v_cvt_pk_bf16_f32 v237, v110, v111
    v_cvt_pk_bf16_f32 v238, v124, v125
    v_mfma_f32_16x16x32_bf16 v[44:47], v[204:207], v[170:173], 0
    v_cvt_pk_bf16_f32 v239, v126, v127
    v_mfma_f32_16x16x32_bf16 v[60:63], v[204:207], v[168:171], 0
    ds_write_b128 v240, v[236:239] offset:25600
    buffer_load_dwordx4 v251, s[8:11], s65 offen offset:3072 sc1 lds
    s_mov_b32 m0, s61
    s_nop 0
    buffer_load_dwordx4 v252, s[8:11], s65 offen offset:0 sc1 lds
    s_waitcnt lgkmcnt(0)
    s_barrier
    ds_read_b128 a[128:131], v240 offset:0
    ds_read_b128 a[160:163], v240 offset:8192
    ds_read_b128 a[192:195], v240 offset:16384
    ds_read_b128 a[224:227], v240 offset:24576
    v_add_u32 v244, s60, v248
    v_and_b32 v245, 0xf0, v250
    v_and_b32 v254, 0x300, v250
    v_lshl_add_u32 v254, v254, 4, v245
    v_add_u32 v245, s61, v248
    v_mov_b32 v160, 0
    v_mov_b32 v161, 0
    v_mov_b32 v162, 0
    v_mov_b32 v163, 0
    v_mov_b32 v164, 0
    v_mov_b32 v165, 0
    v_mov_b32 v166, 0
    v_mov_b32 v167, 0
    s_sub_u32 s34, s33, 4
    s_nop 0
    buffer_load_dwordx4 v252, s[8:11], s65 offen offset:1024 sc1 lds
    ds_read_b128 a[132:135], v240 offset:1024
    buffer_load_dwordx4 v252, s[8:11], s65 offen offset:2048 sc1 lds
    ds_read_b128 a[164:167], v240 offset:9216
    ds_read_b128 a[196:199], v240 offset:17408
    buffer_load_dwordx4 v252, s[8:11], s65 offen offset:3072 sc1 lds
    ds_read_b128 a[228:231], v240 offset:25600
    ds_read_b128 a[136:139], v241 offset:0
    s_add_u32 m0, s61, 0x1000
    s_nop 0
    s_nop 0
    buffer_load_dwordx4 v253, s[8:11], s65 offen offset:0 sc1 lds
    ds_read_b128 a[168:171], v241 offset:8192
    ds_read_b128 a[200:203], v241 offset:16384
    buffer_load_dwordx4 v253, s[8:11], s65 offen offset:1024 sc1 lds
    ds_read_b128 a[232:235], v241 offset:24576
    ds_read_b128 a[140:143], v241 offset:1024
    buffer_load_dwordx4 v253, s[8:11], s65 offen offset:2048 sc1 lds
    ds_read_b128 a[172:175], v241 offset:9216
    ds_read_b128 a[204:207], v241 offset:17408
    buffer_load_dwordx4 v253, s[8:11], s65 offen offset:3072 sc1 lds
    ds_read_b128 a[236:239], v241 offset:25600
    ds_read_b128 a[144:147], v242 offset:0
    s_add_u32 s65, s65, 0x10000
    s_mov_b32 m0, s62
    s_nop 0
    buffer_load_dwordx4 v250, s[8:11], s65 offen offset:0 sc1 lds
    ds_read_b128 a[176:179], v242 offset:8192
    buffer_load_dwordx4 v250, s[8:11], s65 offen offset:1024 sc1 lds
    ds_read_b128 a[208:211], v242 offset:16384
    ds_read_b128 a[240:243], v242 offset:24576
    buffer_load_dwordx4 v250, s[8:11], s65 offen offset:2048 sc1 lds
    ds_read_b128 a[148:151], v242 offset:1024
    ds_read_b128 a[180:183], v242 offset:9216
    buffer_load_dwordx4 v250, s[8:11], s65 offen offset:3072 sc1 lds
    ds_read_b128 a[212:215], v242 offset:17408
    ds_read_b128 a[244:247], v242 offset:25600
    s_add_u32 m0, s62, 0x1000
    s_nop 0
    s_nop 0
    buffer_load_dwordx4 v251, s[8:11], s65 offen offset:0 sc1 lds
    ds_read_b128 a[152:155], v243 offset:0
    ds_read_b128 a[184:187], v243 offset:8192
    buffer_load_dwordx4 v251, s[8:11], s65 offen offset:1024 sc1 lds
    ds_read_b128 a[216:219], v243 offset:16384
    ds_read_b128 a[248:251], v243 offset:24576
    buffer_load_dwordx4 v251, s[8:11], s65 offen offset:2048 sc1 lds
    ds_read_b128 a[156:159], v243 offset:1024
    ds_read_b128 a[188:191], v243 offset:9216
    buffer_load_dwordx4 v251, s[8:11], s65 offen offset:3072 sc1 lds
    ds_read_b128 a[220:223], v243 offset:17408
    ds_read_b128 a[252:255], v243 offset:25600
    s_waitcnt vmcnt(22)
    ds_read_b128 a[0:3], v244 offset:0
    ds_read_b128 a[4:7], v244 offset:1024
    s_branch L_pjoin
L_pad8:
    s_branch L_padret
L_l1:
    v_mov_b32 v246, v47
    v_mov_b32 v247, v111
    v_accvgpr_read_b32 v248, a47
    v_accvgpr_read_b32 v249, a111
    s_branch L_ldone
L_l2:
    v_mov_b32 v246, v31
    v_mov_b32 v247, v95
    v_accvgpr_read_b32 v248, a31
    v_accvgpr_read_b32 v249, a95
    s_branch L_ldone
L_l3:
    s_nop 0
    v_mov_b32 v246, v15
    v_mov_b32 v247, v79
    v_mov_b32 v248, v223
    v_mov_b32 v249, v239
    s_branch L_ldone
L_mlate:
    s_nop 0
    v_pk_mul_f32 v[112:113], v[8:9], v[8:9]
    v_pk_mul_f32 v[114:115], v[10:11], v[10:11]
    v_pk_mul_f32 v[116:117], v[12:13], v[12:13]
    v_pk_mul_f32 v[118:119], v[14:15], v[14:15]
    v_pk_mul_f32 v[104:105], v[16:17], v[16:17]
    v_pk_mul_f32 v[106:107], v[18:19], v[18:19]
    v_pk_mul_f32 v[108:109], v[20:21], v[20:21]
    v_pk_fma_f32 v[112:113], v[112:113], v[162:163], v[160:161] op_sel_hi:[1,0,0]
    v_pk_fma_f32 v[114:115], v[114:115], v[162:163], v[160:161] op_sel_hi:[1,0,0]
    v_pk_fma_f32 v[116:117], v[116:117], v[162:163], v[160:161] op_sel_hi:[1,0,0]
    v_pk_fma_f32 v[118:119], v[118:119], v[162:163], v[160:161] op_sel_hi:[1,0,0]
    v_pk_fma_f32 v[104:105], v[104:105], v[162:163], v[160:161] op_sel_hi:[1,0,0]
    v_pk_fma_f32 v[106:107], v[106:107], v[162:163], v[160:161] op_sel_hi:[1,0,0]
    v_pk_fma_f32 v[108:109], v[108:109], v[162:163], v[160:161] op_sel_hi:[1,0,0]
    v_pk_mul_f32 v[112:113], v[112:113], v[8:9]
    v_pk_mul_f32 v[114:115], v[114:115], v[10:11]
    v_pk_mul_f32 v[116:117], v[116:117], v[12:13]
    v_pk_mul_f32 v[118:119], v[118:119], v[14:15]
    v_pk_mul_f32 v[104:105], v[104:105], v[16:17]
    v_pk_mul_f32 v[106:107], v[106:107], v[18:19]
    v_pk_mul_f32 v[108:109], v[108:109], v[20:21]
    v_exp_f32 v112, v112
    v_exp_f32 v113, v113
    v_exp_f32 v114, v114
    v_exp_f32 v115, v115
    v_exp_f32 v116, v116
    v_exp_f32 v117, v117
    v_exp_f32 v118, v118
    v_exp_f32 v119, v119
    v_exp_f32 v104, v104
    v_exp_f32 v105, v105
    v_exp_f32 v106, v106
    s_waitcnt vmcnt(0)
    buffer_store_dword v73, v68, s[8:11], s42 offen sc1
    v_exp_f32 v107, v107
    v_exp_f32 v108, v108
    v_exp_f32_e64 v109, v109
    v_pk_add_f32 v[112:113], v[112:113], v[164:165] op_sel_hi:[1,0]
    v_pk_add_f32 v[114:115], v[114:115], v[164:165] op_sel_hi:[1,0]
    v_pk_add_f32 v[116:117], v[116:117], v[164:165] op_sel_hi:[1,0]
    v_pk_add_f32 v[118:119], v[118:119], v[164:165] op_sel_hi:[1,0]
    v_pk_add_f32 v[104:105], v[104:105], v[164:165] op_sel_hi:[1,0]
    v_pk_add_f32 v[106:107], v[106:107], v[164:165] op_sel_hi:[1,0]
    v_pk_add_f32 v[108:109], v[108:109], v[164:165] op_sel_hi:[1,0]
    v_rcp_f32 v112, v112
    v_rcp_f32 v113, v113
    v_rcp_f32 v114, v114
    v_rcp_f32 v115, v115
    v_rcp_f32 v116, v116
    v_rcp_f32 v117, v117
    v_rcp_f32 v118, v118
    v_rcp_f32 v119, v119
    v_rcp_f32 v104, v104
    v_rcp_f32 v105, v105
    v_rcp_f32 v106, v106
    v_rcp_f32 v107, v107
    v_rcp_f32 v108, v108
    v_rcp_f32 v109, v109
    v_pk_mul_f32 v[8:9], v[8:9], v[112:113]
    v_pk_mul_f32 v[10:11], v[10:11], v[114:115]
    v_pk_mul_f32 v[12:13], v[12:13], v[116:117]
    v_pk_mul_f32 v[14:15], v[14:15], v[118:119]
    v_pk_mul_f32 v[16:17], v[16:17], v[104:105]
    v_pk_mul_f32 v[18:19], v[18:19], v[106:107]
    v_pk_mul_f32 v[20:21], v[20:21], v[108:109]
    v_pk_mul_f32 v[110:111], v[22:23], v[22:23]
    v_pk_mul_f32 v[112:113], v[24:25], v[24:25]
    v_pk_mul_f32 v[114:115], v[26:27], v[26:27]
    v_pk_mul_f32 v[116:117], v[28:29], v[28:29]
    v_pk_mul_f32 v[118:119], v[30:31], v[30:31]
    v_pk_mul_f32 v[104:105], v[32:33], v[32:33]
    v_pk_mul_f32 v[106:107], v[34:35], v[34:35]
    v_pk_fma_f32 v[110:111], v[110:111], v[162:163], v[160:161] op_sel_hi:[1,0,0]
    v_pk_fma_f32 v[112:113], v[112:113], v[162:163], v[160:161] op_sel_hi:[1,0,0]
    v_pk_fma_f32 v[114:115], v[114:115], v[162:163], v[160:161] op_sel_hi:[1,0,0]
    v_pk_fma_f32 v[116:117], v[116:117], v[162:163], v[160:161] op_sel_hi:[1,0,0]
    v_pk_fma_f32 v[118:119], v[118:119], v[162:163], v[160:161] op_sel_hi:[1,0,0]
    v_pk_fma_f32 v[104:105], v[104:105], v[162:163], v[160:161] op_sel_hi:[1,0,0]
    v_pk_fma_f32 v[106:107], v[106:107], v[162:163], v[160:161] op_sel_hi:[1,0,0]
    v_pk_mul_f32 v[110:111], v[110:111], v[22:23]
    v_pk_mul_f32 v[112:113], v[112:113], v[24:25]
    v_pk_mul_f32 v[114:115], v[114:115], v[26:27]
    v_pk_mul_f32 v[116:117], v[116:117], v[28:29]
    v_pk_mul_f32 v[118:119], v[118:119], v[30:31]
    v_pk_mul_f32 v[104:105], v[104:105], v[32:33]
    v_pk_mul_f32 v[106:107], v[106:107], v[34:35]
    v_exp_f32 v110, v110
    v_exp_f32 v111, v111
    v_exp_f32 v112, v112
    v_exp_f32 v113, v113
    v_exp_f32 v114, v114
    v_exp_f32 v115, v115
    v_exp_f32 v116, v116
    v_exp_f32 v117, v117
    v_exp_f32 v118, v118
    v_exp_f32 v119, v119
    v_exp_f32 v104, v104
    v_exp_f32 v105, v105
    v_exp_f32 v106, v106
    v_exp_f32 v107, v107
    v_pk_add_f32 v[110:111], v[110:111], v[164:165] op_sel_hi:[1,0]
    v_pk_add_f32 v[112:113], v[112:113], v[164:165] op_sel_hi:[1,0]
    v_pk_add_f32 v[114:115], v[114:115], v[164:165] op_sel_hi:[1,0]
    v_pk_add_f32 v[116:117], v[116:117], v[164:165] op_sel_hi:[1,0]
    v_pk_add_f32 v[118:119], v[118:119], v[164:165] op_sel_hi:[1,0]
    v_pk_add_f32 v[104:105], v[104:105], v[164:165] op_sel_hi:[1,0]
    v_pk_add_f32 v[106:107], v[106:107], v[164:165] op_sel_hi:[1,0]
    v_rcp_f32 v110, v110
    v_rcp_f32 v111, v111
    v_rcp_f32 v112, v112
    v_rcp_f32 v113, v113
    v_rcp_f32 v114, v114
    v_rcp_f32 v115, v115
    v_rcp_f32 v116, v116
    v_rcp_f32 v117, v117
    v_rcp_f32 v118, v118
    v_rcp_f32 v119, v119
    v_rcp_f32 v104, v104
    v_rcp_f32 v105, v105
    v_rcp_f32 v106, v106
    v_rcp_f32 v107, v107
    v_pk_mul_f32 v[22:23], v[22:23], v[110:111]
    v_pk_mul_f32 v[24:25], v[24:25], v[112:113]
    v_pk_mul_f32 v[26:27], v[26:27], v[114:115]
    v_pk_mul_f32 v[28:29], v[28:29], v[116:117]
    v_pk_mul_f32 v[30:31], v[30:31], v[118:119]
    v_pk_mul_f32 v[32:33], v[32:33], v[104:105]
    v_pk_mul_f32 v[34:35], v[34:35], v[106:107]
    v_pk_mul_f32 v[108:109], v[36:37], v[36:37]
    v_pk_mul_f32 v[110:111], v[38:39], v[38:39]
    v_pk_mul_f32 v[112:113], v[40:41], v[40:41]
    v_pk_mul_f32 v[114:115], v[42:43], v[42:43]
    v_pk_mul_f32 v[116:117], v[44:45], v[44:45]
    v_pk_mul_f32 v[118:119], v[46:47], v[46:47]
    v_pk_mul_f32 v[104:105], v[48:49], v[48:49]
    v_pk_fma_f32 v[108:109], v[108:109], v[162:163], v[160:161] op_sel_hi:[1,0,0]
    v_pk_fma_f32 v[110:111], v[110:111], v[162:163], v[160:161] op_sel_hi:[1,0,0]
    v_pk_fma_f32 v[112:113], v[112:113], v[162:163], v[160:161] op_sel_hi:[1,0,0]
    v_pk_fma_f32 v[114:115], v[114:115], v[162:163], v[160:161] op_sel_hi:[1,0,0]
    v_pk_fma_f32 v[116:117], v[116:117], v[162:163], v[160:161] op_sel_hi:[1,0,0]
    v_pk_fma_f32 v[118:119], v[118:119], v[162:163], v[160:161] op_sel_hi:[1,0,0]
    v_pk_fma_f32 v[104:105], v[104:105], v[162:163], v[160:161] op_sel_hi:[1,0,0]
    v_pk_mul_f32 v[108:109], v[108:109], v[36:37]
    v_pk_mul_f32 v[110:111], v[110:111], v[38:39]
    v_pk_mul_f32 v[112:113], v[112:113], v[40:41]
    v_pk_mul_f32 v[114:115], v[114:115], v[42:43]
    v_pk_mul_f32 v[116:117], v[116:117], v[44:45]
    v_pk_mul_f32 v[118:119], v[118:119], v[46:47]
    v_pk_mul_f32 v[104:105], v[104:105], v[48:49]
    v_exp_f32 v108, v108
    v_exp_f32 v109, v109
    v_exp_f32 v110, v110
    v_exp_f32 v111, v111
    v_exp_f32 v112, v112
    v_exp_f32 v113, v113
    v_exp_f32 v114, v114
    v_exp_f32 v115, v115
    v_exp_f32 v116, v116
    v_exp_f32 v117, v117
    v_exp_f32 v118, v118
    v_exp_f32 v119, v119
    v_exp_f32 v104, v104
    v_exp_f32 v105, v105
    v_pk_add_f32 v[108:109], v[108:109], v[164:165] op_sel_hi:[1,0]
    v_pk_add_f32 v[110:111], v[110:111], v[164:165] op_sel_hi:[1,0]
    v_pk_add_f32 v[112:113], v[112:113], v[164:165] op_sel_hi:[1,0]
    v_pk_add_f32 v[114:115], v[114:115], v[164:165] op_sel_hi:[1,0]
    v_pk_add_f32 v[116:117], v[116:117], v[164:165] op_sel_hi:[1,0]
    v_pk_add_f32 v[118:119], v[118:119], v[164:165] op_sel_hi:[1,0]
    v_pk_add_f32 v[104:105], v[104:105], v[164:165] op_sel_hi:[1,0]
    v_rcp_f32 v108, v108
    v_rcp_f32 v109, v109
    v_rcp_f32 v110, v110
    v_rcp_f32 v111, v111
    v_rcp_f32 v112, v112
    v_rcp_f32 v113, v113
    v_rcp_f32 v114, v114
    v_rcp_f32 v115, v115
    v_rcp_f32 v116, v116
    v_rcp_f32 v117, v117
    v_rcp_f32 v118, v118
    v_rcp_f32 v119, v119
    v_rcp_f32 v104, v104
    v_rcp_f32 v105, v105
    v_pk_mul_f32 v[36:37], v[36:37], v[108:109]
    v_pk_mul_f32 v[38:39], v[38:39], v[110:111]
    v_pk_mul_f32 v[40:41], v[40:41], v[112:113]
    v_pk_mul_f32 v[42:43], v[42:43], v[114:115]
    v_pk_mul_f32 v[44:45], v[44:45], v[116:117]
    v_pk_mul_f32 v[46:47], v[46:47], v[118:119]
    v_pk_mul_f32 v[48:49], v[48:49], v[104:105]
    s_mov_b32 s76, 0
L_poll1:
    buffer_load_dword v255, v254, s[8:11], s46 offen sc1
    s_add_u32 s76, s76, 1
    s_waitcnt vmcnt(0)
    s_cmp_ge_u32 s76, 20000
    s_cbranch_scc1 L_poll1_x
    v_cmp_eq_u32 vcc, s4, v255
    s_nop 1
    s_cmp_eq_u32 vcc_lo, -1
    s_cbranch_scc0 L_poll1
L_poll1_x:
    buffer_load_dwordx4 a[128:131], v250, s[8:11], s71 offen offset:0 sc1
    buffer_load_dwordx4 a[132:135], v250, s[8:11], s71 offen offset:1024 sc1
    buffer_load_dwordx4 a[136:139], v250, s[8:11], s71 offen offset:2048 sc1
    buffer_load_dwordx4 a[140:143], v250, s[8:11], s71 offen offset:3072 sc1
    buffer_load_dwordx4 a[144:147], v251, s[8:11], s71 offen offset:0 sc1
    buffer_load_dwordx4 a[148:151], v251, s[8:11], s71 offen offset:1024 sc1
    buffer_load_dwordx4 a[152:155], v251, s[8:11], s71 offen offset:2048 sc1
    buffer_load_dwordx4 a[156:159], v251, s[8:11], s71 offen offset:3072 sc1
    buffer_load_dwordx4 a[160:163], v252, s[8:11], s71 offen offset:0 sc1
    buffer_load_dwordx4 a[164:167], v252, s[8:11], s71 offen offset:1024 sc1
    buffer_load_dwordx4 a[168:171], v252, s[8:11], s71 offen offset:2048 sc1
    buffer_load_dwordx4 a[172:175], v252, s[8:11], s71 offen offset:3072 sc1
    buffer_load_dwordx4 a[176:179], v253, s[8:11], s71 offen offset:0 sc1
    buffer_load_dwordx4 a[180:183], v253, s[8:11], s71 offen offset:1024 sc1
    buffer_load_dwordx4 a[184:187], v253, s[8:11], s71 offen offset:2048 sc1
    buffer_load_dwordx4 a[188:191], v253, s[8:11], s71 offen offset:3072 sc1
    s_branch L_q
L_xlate:
    s_mov_b32 s76, 0
L_poll2:
    buffer_load_dword v255, v254, s[8:11], s47 offen sc1
    s_add_u32 s76, s76, 1
    s_waitcnt vmcnt(0)
    s_cmp_ge_u32 s76, 20000
    s_cbranch_scc1 L_poll2_x
    v_cmp_eq_u32 vcc, s4, v255
    s_nop 1
    s_or_b32 s77, vcc_hi, s78
    s_cmp_eq_u32 s77, -1
    s_cbranch_scc0 L_poll2
L_poll2_x:
    s_branch L_xok
L_x3late:
    s_branch L_it0
L_hlate:
    v_and_b32 v254, 0xf0, v250
    s_mov_b32 s76, 0
L_poll3:
    buffer_load_dword v255, v254, s[8:11], s56 offen sc1
    s_add_u32 s76, s76, 1
    s_waitcnt vmcnt(0)
    s_cmp_ge_u32 s76, 20000
    s_cbranch_scc1 L_poll3_x
    v_cmp_eq_u32 vcc, s4, v255
    s_nop 1
    s_cmp_eq_u64 vcc, -1
    s_cbranch_scc0 L_poll3
L_poll3_x:
    s_mov_b32 s76, 0
L_poll4:
    buffer_load_dword v255, v254, s[8:11], s35 offen sc1
    s_add_u32 s76, s76, 1
    s_waitcnt vmcnt(0)
    s_cmp_ge_u32 s76, 20000
    s_cbranch_scc1 L_poll4_x
    v_cmp_eq_u32 vcc, s4, v255
    s_nop 1
    s_cmp_eq_u64 vcc, -1
    s_cbranch_scc0 L_poll4
L_poll4_x:
    s_branch L_hok
L_plate:
    s_mov_b32 s77, 0
L_pretry:
    buffer_load_dwordx2 v[180:181], v182, s[8:11], s67 offen sc1
    buffer_load_dwordx4 v[160:163], v250, s[8:11], s66 offen offset:0 sc1
    buffer_load_dwordx4 v[164:167], v250, s[8:11], s66 offen offset:1024 sc1
    buffer_load_dwordx4 v[168:171], v250, s[8:11], s66 offen offset:2048 sc1
    buffer_load_dwordx4 v[172:175], v250, s[8:11], s66 offen offset:3072 sc1
    s_add_u32 s77, s77, 1
    s_waitcnt vmcnt(0)
    s_cmp_ge_u32 s77, 20000
    s_cbranch_scc1 L_pok
    v_add_u32 v189, s4, v181
    v_add3_u32 v189, v189, v160, v161
    v_add3_u32 v189, v189, v162, v163
    v_add3_u32 v189, v189, v164, v165
    v_add3_u32 v189, v189, v166, v167
    v_add3_u32 v189, v189, v168, v169
    v_add3_u32 v189, v189, v170, v171
    v_add3_u32 v189, v189, v172, v173
    v_add3_u32 v189, v189, v174, v175
    v_cmp_eq_u32 vcc, v189, v180
    s_nop 1
    s_cmp_eq_u64 vcc, -1
    s_cbranch_scc0 L_pretry
    v_mov_b32 v176, v181
    v_mov_b32 v178, v181
    s_nop 1
    v_permlane32_swap_b32 v176, v178
    v_mov_b32 v177, v176
    v_mov_b32 v179, v178
    s_nop 1
    v_permlane16_swap_b32 v176, v177
    v_permlane16_swap_b32 v178, v179
    v_cmp_eq_u32 vcc, v246, v178
    v_cmp_eq_u32 s[62:63], v247, v179
    s_nop 1
    s_and_b64 vcc, vcc, s[62:63]
    s_cmp_eq_u64 vcc, -1
    s_cbranch_scc1 L_pok
    v_min_f32 v186, v246, v178
    v_sub_f32 v187, v186, v246
    v_sub_f32 v188, v186, v178
    v_exp_f32 v187, v187
    v_exp_f32 v188, v188
    s_nop 0
    v_mul_f32 v248, v248, v187
    v_mul_f32 v176, v176, v188
    v_mul_f32 v208, v208, v187
    v_mul_f32 v209, v209, v187
    v_mul_f32 v210, v210, v187
    v_mul_f32 v211, v211, v187
    v_mul_f32 v212, v212, v187
    v_mul_f32 v213, v213, v187
    v_mul_f32 v214, v214, v187
    v_mul_f32 v215, v215, v187
    v_mul_f32 v216, v216, v187
    v_mul_f32 v217, v217, v187
    v_mul_f32 v218, v218, v187
    v_mul_f32 v219, v219, v187
    v_mul_f32 v220, v220, v187
    v_mul_f32 v221, v221, v187
    v_mul_f32 v222, v222, v187
    v_mul_f32 v223, v223, v187
    v_lshlrev_b32 v190, 16, v160
    v_and_b32 v191, s101, v160
    v_mul_f32 v190, v190, v188
    v_mul_f32 v191, v191, v188
    v_cvt_pk_bf16_f32 v160, v190, v191
    v_lshlrev_b32 v190, 16, v161
    v_and_b32 v191, s101, v161
    v_mul_f32 v190, v190, v188
    v_mul_f32 v191, v191, v188
    v_cvt_pk_bf16_f32 v161, v190, v191
    v_lshlrev_b32 v190, 16, v162
    v_and_b32 v191, s101, v162
    v_mul_f32 v190, v190, v188
    v_mul_f32 v191, v191, v188
    v_cvt_pk_bf16_f32 v162, v190, v191
    v_lshlrev_b32 v190, 16, v163
    v_and_b32 v191, s101, v163
    v_mul_f32 v190, v190, v188
    v_mul_f32 v191, v191, v188
    v_cvt_pk_bf16_f32 v163, v190, v191
    v_lshlrev_b32 v190, 16, v164
    v_and_b32 v191, s101, v164
    v_mul_f32 v190, v190, v188
    v_mul_f32 v191, v191, v188
    v_cvt_pk_bf16_f32 v164, v190, v191
    v_lshlrev_b32 v190, 16, v165
    v_and_b32 v191, s101, v165
    v_mul_f32 v190, v190, v188
    v_mul_f32 v191, v191, v188
    v_cvt_pk_bf16_f32 v165, v190, v191
    v_lshlrev_b32 v190, 16, v166
    v_and_b32 v191, s101, v166
    v_mul_f32 v190, v190, v188
    v_mul_f32 v191, v191, v188
    v_cvt_pk_bf16_f32 v166, v190, v191
    v_lshlrev_b32 v190, 16, v167
    v_and_b32 v191, s101, v167
    v_mul_f32 v190, v190, v188
    v_mul_f32 v191, v191, v188
    v_cvt_pk_bf16_f32 v167, v190, v191
    v_min_f32 v186, v247, v179
    v_sub_f32 v187, v186, v247
    v_sub_f32 v188, v186, v179
    v_exp_f32 v187, v187
    v_exp_f32 v188, v188
    s_nop 0
    v_mul_f32 v249, v249, v187
    v_mul_f32 v177, v177, v188
    v_mul_f32 v224, v224, v187
    v_mul_f32 v225, v225, v187
    v_mul_f32 v226, v226, v187
    v_mul_f32 v227, v227, v187
    v_mul_f32 v228, v228, v187
    v_mul_f32 v229, v229, v187
    v_mul_f32 v230, v230, v187
    v_mul_f32 v231, v231, v187
    v_mul_f32 v232, v232, v187
    v_mul_f32 v233, v233, v187
    v_mul_f32 v234, v234, v187
    v_mul_f32 v235, v235, v187
    v_mul_f32 v236, v236, v187
    v_mul_f32 v237, v237, v187
    v_mul_f32 v238, v238, v187
    v_mul_f32 v239, v239, v187
    v_lshlrev_b32 v190, 16, v168
    v_and_b32 v191, s101, v168
    v_mul_f32 v190, v190, v188
    v_mul_f32 v191, v191, v188
    v_cvt_pk_bf16_f32 v168, v190, v191
    v_lshlrev_b32 v190, 16, v169
    v_and_b32 v191, s101, v169
    v_mul_f32 v190, v190, v188
    v_mul_f32 v191, v191, v188
    v_cvt_pk_bf16_f32 v169, v190, v191
    v_lshlrev_b32 v190, 16, v170
    v_and_b32 v191, s101, v170
    v_mul_f32 v190, v190, v188
    v_mul_f32 v191, v191, v188
    v_cvt_pk_bf16_f32 v170, v190, v191
    v_lshlrev_b32 v190, 16, v171
    v_and_b32 v191, s101, v171
    v_mul_f32 v190, v190, v188
    v_mul_f32 v191, v191, v188
    v_cvt_pk_bf16_f32 v171, v190, v191
    v_lshlrev_b32 v190, 16, v172
    v_and_b32 v191, s101, v172
    v_mul_f32 v190, v190, v188
    v_mul_f32 v191, v191, v188
    v_cvt_pk_bf16_f32 v172, v190, v191
    v_lshlrev_b32 v190, 16, v173
    v_and_b32 v191, s101, v173
    v_mul_f32 v190, v190, v188
    v_mul_f32 v191, v191, v188
    v_cvt_pk_bf16_f32 v173, v190, v191
    v_lshlrev_b32 v190, 16, v174
    v_and_b32 v191, s101, v174
    v_mul_f32 v190, v190, v188
    v_mul_f32 v191, v191, v188
    v_cvt_pk_bf16_f32 v174, v190, v191
    v_lshlrev_b32 v190, 16, v175
    v_and_b32 v191, s101, v175
    v_mul_f32 v190, v190, v188
    v_mul_f32 v191, v191, v188
    v_cvt_pk_bf16_f32 v175, v190, v191
    s_nop 1
    s_branch L_pok
L_fallback:
    s_mov_b32 s5, 1
    s_waitcnt vmcnt(0) lgkmcnt(0)
    s_barrier
    s_branch L_restart
L_maxpass:
    s_waitcnt vmcnt(0) lgkmcnt(0)
    s_barrier
    v_mov_b32 v176, 0xff7fffff
    v_mov_b32 v177, 0xff7fffff
    v_mov_b32 v178, 0xff7fffff
    v_mov_b32 v179, 0xff7fffff
    s_mov_b32 s65, s66
L_maxloop:
    s_mov_b32 m0, s60
    s_nop 0
    s_nop 0
    buffer_load_dwordx4 v250, s[8:11], s65 offen offset:0 sc1 lds
    buffer_load_dwordx4 v250, s[8:11], s65 offen offset:1024 sc1 lds
    buffer_load_dwordx4 v250, s[8:11], s65 offen offset:2048 sc1 lds
    buffer_load_dwordx4 v250, s[8:11], s65 offen offset:3072 sc1 lds
    s_add_u32 m0, s60, 0x1000
    s_nop 0
    buffer_load_dwordx4 v251, s[8:11], s65 offen offset:0 sc1 lds
    buffer_load_dwordx4 v251, s[8:11], s65 offen offset:1024 sc1 lds
    buffer_load_dwordx4 v251, s[8:11], s65 offen offset:2048 sc1 lds
    buffer_load_dwordx4 v251, s[8:11], s65 offen offset:3072 sc1 lds
    s_mov_b32 m0, s61
    s_nop 0
    s_nop 0
    buffer_load_dwordx4 v252, s[8:11], s65 offen offset:0 sc1 lds
    buffer_load_dwordx4 v252, s[8:11], s65 offen offset:1024 sc1 lds
    buffer_load_dwordx4 v252, s[8:11], s65 offen offset:2048 sc1 lds
    buffer_load_dwordx4 v252, s[8:11], s65 offen offset:3072 sc1 lds
    s_add_u32 m0, s61, 0x1000
    s_nop 0
    buffer_load_dwordx4 v253, s[8:11], s65 offen offset:0 sc1 lds
    buffer_load_dwordx4 v253, s[8:11], s65 offen offset:1024 sc1 lds
    buffer_load_dwordx4 v253, s[8:11], s65 offen offset:2048 sc1 lds
    buffer_load_dwordx4 v253, s[8:11], s65 offen offset:3072 sc1 lds
    s_waitcnt vmcnt(0)
    ds_read_b128 a[0:3], v244 offset:0
    ds_read_b128 a[4:7], v244 offset:1024
    ds_read_b128 a[8:11], v244 offset:2048
    ds_read_b128 a[12:15], v244 offset:3072
    ds_read_b128 a[64:67], v244 offset:4096
    ds_read_b128 a[68:71], v244 offset:5120
    ds_read_b128 a[72:75], v244 offset:6144
    ds_read_b128 a[76:79], v244 offset:7168
    s_waitcnt lgkmcnt(0)
    v_mfma_f32_16x16x32_bf16 v[128:131], a[0:3], a[128:131], v[160:163]
    v_mfma_f32_16x16x32_bf16 v[128:131], a[4:7], a[132:135], v[128:131]
    v_mfma_f32_16x16x32_bf16 v[132:135], a[4:7], a[164:167], v[164:167]
    v_mfma_f32_16x16x32_bf16 v[132:135], a[0:3], a[160:163], v[132:135]
    v_mfma_f32_16x16x32_bf16 v[136:139], a[0:3], a[192:195], v[168:171]
    v_mfma_f32_16x16x32_bf16 v[136:139], a[4:7], a[196:199], v[136:139]
    v_mfma_f32_16x16x32_bf16 v[140:143], a[4:7], a[228:231], v[172:175]
    v_mfma_f32_16x16x32_bf16 v[140:143], a[0:3], a[224:227], v[140:143]
    v_mfma_f32_16x16x32_bf16 v[128:131], a[8:11], a[136:139], v[128:131]
    v_mfma_f32_16x16x32_bf16 v[128:131], a[12:15], a[140:143], v[128:131]
    v_mfma_f32_16x16x32_bf16 v[132:135], a[12:15], a[172:175], v[132:135]
    v_mfma_f32_16x16x32_bf16 v[132:135], a[8:11], a[168:171], v[132:135]
    v_mfma_f32_16x16x32_bf16 v[136:139], a[8:11], a[200:203], v[136:139]
    v_mfma_f32_16x16x32_bf16 v[136:139], a[12:15], a[204:207], v[136:139]
    v_mfma_f32_16x16x32_bf16 v[140:143], a[12:15], a[236:239], v[140:143]
    v_mfma_f32_16x16x32_bf16 v[140:143], a[8:11], a[232:235], v[140:143]
    v_mfma_f32_16x16x32_bf16 v[128:131], a[64:67], a[144:147], v[128:131]
    v_mfma_f32_16x16x32_bf16 v[128:131], a[68:71], a[148:151], v[128:131]
    v_mfma_f32_16x16x32_bf16 v[132:135], a[68:71], a[180:183], v[132:135]
    v_mfma_f32_16x16x32_bf16 v[132:135], a[64:67], a[176:179], v[132:135]
    v_mfma_f32_16x16x32_bf16 v[136:139], a[64:67], a[208:211], v[136:139]
    v_mfma_f32_16x16x32_bf16 v[136:139], a[68:71], a[212:215], v[136:139]
    v_mfma_f32_16x16x32_bf16 v[140:143], a[68:71], a[244:247], v[140:143]
    v_mfma_f32_16x16x32_bf16 v[140:143], a[64:67], a[240:243], v[140:143]
    v_mfma_f32_16x16x32_bf16 v[128:131], a[72:75], a[152:155], v[128:131]
    v_mfma_f32_16x16x32_bf16 v[128:131], a[76:79], a[156:159], v[128:131]
    v_mfma_f32_16x16x32_bf16 v[132:135], a[76:79], a[188:191], v[132:135]
    v_mfma_f32_16x16x32_bf16 v[132:135], a[72:75], a[184:187], v[132:135]
    v_mfma_f32_16x16x32_bf16 v[136:139], a[72:75], a[216:219], v[136:139]
    v_mfma_f32_16x16x32_bf16 v[136:139], a[76:79], a[220:223], v[136:139]
    v_mfma_f32_16x16x32_bf16 v[140:143], a[76:79], a[252:255], v[140:143]
    v_mfma_f32_16x16x32_bf16 v[140:143], a[72:75], a[248:251], v[140:143]
    s_nop 0
    ds_read_b128 a[0:3], v245 offset:0
    ds_read_b128 a[4:7], v245 offset:1024
    ds_read_b128 a[8:11], v245 offset:2048
    ds_read_b128 a[12:15], v245 offset:3072
    ds_read_b128 a[64:67], v245 offset:4096
    ds_read_b128 a[68:71], v245 offset:5120
    ds_read_b128 a[72:75], v245 offset:6144
    ds_read_b128 a[76:79], v245 offset:7168
    s_waitcnt lgkmcnt(0)
    v_mfma_f32_16x16x32_bf16 v[144:147], a[0:3], a[128:131], v[160:163]
    v_mfma_f32_16x16x32_bf16 v[144:147], a[4:7], a[132:135], v[144:147]
    v_mfma_f32_16x16x32_bf16 v[148:151], a[4:7], a[164:167], v[164:167]
    v_mfma_f32_16x16x32_bf16 v[148:151], a[0:3], a[160:163], v[148:151]
    v_mfma_f32_16x16x32_bf16 v[152:155], a[0:3], a[192:195], v[168:171]
    v_mfma_f32_16x16x32_bf16 v[152:155], a[4:7], a[196:199], v[152:155]
    v_mfma_f32_16x16x32_bf16 v[156:159], a[4:7], a[228:231], v[172:175]
    v_mfma_f32_16x16x32_bf16 v[156:159], a[0:3], a[224:227], v[156:159]
    v_mfma_f32_16x16x32_bf16 v[144:147], a[8:11], a[136:139], v[144:147]
    v_mfma_f32_16x16x32_bf16 v[144:147], a[12:15], a[140:143], v[144:147]
    v_mfma_f32_16x16x32_bf16 v[148:151], a[12:15], a[172:175], v[148:151]
    v_mfma_f32_16x16x32_bf16 v[148:151], a[8:11], a[168:171], v[148:151]
    v_mfma_f32_16x16x32_bf16 v[152:155], a[8:11], a[200:203], v[152:155]
    v_mfma_f32_16x16x32_bf16 v[152:155], a[12:15], a[204:207], v[152:155]
    v_mfma_f32_16x16x32_bf16 v[156:159], a[12:15], a[236:239], v[156:159]
    v_mfma_f32_16x16x32_bf16 v[156:159], a[8:11], a[232:235], v[156:159]
    v_mfma_f32_16x16x32_bf16 v[144:147], a[64:67], a[144:147], v[144:147]
    v_mfma_f32_16x16x32_bf16 v[144:147], a[68:71], a[148:151], v[144:147]
    v_mfma_f32_16x16x32_bf16 v[148:151], a[68:71], a[180:183], v[148:151]
    v_mfma_f32_16x16x32_bf16 v[148:151], a[64:67], a[176:179], v[148:151]
    v_mfma_f32_16x16x32_bf16 v[152:155], a[64:67], a[208:211], v[152:155]
    v_mfma_f32_16x16x32_bf16 v[152:155], a[68:71], a[212:215], v[152:155]
    v_mfma_f32_16x16x32_bf16 v[156:159], a[68:71], a[244:247], v[156:159]
    v_mfma_f32_16x16x32_bf16 v[156:159], a[64:67], a[240:243], v[156:159]
    v_mfma_f32_16x16x32_bf16 v[144:147], a[72:75], a[152:155], v[144:147]
    v_mfma_f32_16x16x32_bf16 v[144:147], a[76:79], a[156:159], v[144:147]
    v_mfma_f32_16x16x32_bf16 v[148:151], a[76:79], a[188:191], v[148:151]
    v_mfma_f32_16x16x32_bf16 v[148:151], a[72:75], a[184:187], v[148:151]
    v_mfma_f32_16x16x32_bf16 v[152:155], a[72:75], a[216:219], v[152:155]
    v_mfma_f32_16x16x32_bf16 v[152:155], a[76:79], a[220:223], v[152:155]
    v_mfma_f32_16x16x32_bf16 v[156:159], a[76:79], a[252:255], v[156:159]
    v_mfma_f32_16x16x32_bf16 v[156:159], a[72:75], a[248:251], v[156:159]
    s_nop 7
    v_max3_f32 v176, v176, v128, v129
    v_max3_f32 v176, v176, v130, v131
    v_max3_f32 v176, v176, v144, v145
    v_max3_f32 v176, v176, v146, v147
    v_max3_f32 v177, v177, v132, v133
    v_max3_f32 v177, v177, v134, v135
    v_max3_f32 v177, v177, v148, v149
    v_max3_f32 v177, v177, v150, v151
    v_max3_f32 v178, v178, v136, v137
    v_max3_f32 v178, v178, v138, v139
    v_max3_f32 v178, v178, v152, v153
    v_max3_f32 v178, v178, v154, v155
    v_max3_f32 v179, v179, v140, v141
    v_max3_f32 v179, v179, v142, v143
    v_max3_f32 v179, v179, v156, v157
    v_max3_f32 v179, v179, v158, v159
    s_add_u32 s65, s65, 0x10000
    s_cmp_lt_u32 s65, s67
    s_cbranch_scc1 L_maxloop
    v_mov_b32 v128, v176
    v_mov_b32 v129, v177
    v_mov_b32 v130, v178
    v_mov_b32 v131, v179
    s_nop 0
    v_permlane32_swap_b32 v128, v176
    v_permlane32_swap_b32 v129, v177
    v_permlane32_swap_b32 v130, v178
    v_permlane32_swap_b32 v131, v179
    v_max_f32 v176, v176, v128
    v_max_f32 v177, v177, v129
    v_max_f32 v178, v178, v130
    v_max_f32 v179, v179, v131
    v_mov_b32 v128, v176
    v_mov_b32 v129, v177
    v_mov_b32 v130, v178
    v_mov_b32 v131, v179
    s_nop 0
    v_permlane16_swap_b32 v128, v176
    v_permlane16_swap_b32 v129, v177
    v_permlane16_swap_b32 v130, v178
    v_permlane16_swap_b32 v131, v179
    v_max_f32 v176, v176, v128
    v_max_f32 v177, v177, v129
    v_max_f32 v178, v178, v130
    v_max_f32 v179, v179, v131
    v_add_u32 v246, s74, v250
    v_add_u32 v247, 131072, v250
    ds_write_b128 v246, v[176:179]
    s_waitcnt lgkmcnt(0)
    s_barrier
    ds_read_b128 v[128:131], v247 offset:0
    ds_read_b128 v[132:135], v247 offset:8192
    ds_read_b128 v[136:139], v247 offset:16384
    ds_read_b128 v[140:143], v247 offset:24576
    s_waitcnt lgkmcnt(0)
    v_max3_f32 v128, v128, v132, v136
    v_max_f32 v128, v128, v140
    v_sub_f32 v160, 0, v128
    v_sub_f32 v161, 0, v128
    v_sub_f32 v162, 0, v128
    v_sub_f32 v163, 0, v128
    v_max3_f32 v129, v129, v133, v137
    v_max_f32 v129, v129, v141
    v_sub_f32 v164, 0, v129
    v_sub_f32 v165, 0, v129
    v_sub_f32 v166, 0, v129
    v_sub_f32 v167, 0, v129
    v_max3_f32 v130, v130, v134, v138
    v_max_f32 v130, v130, v142
    v_sub_f32 v168, 0, v130
    v_sub_f32 v169, 0, v130
    v_sub_f32 v170, 0, v130
    v_sub_f32 v171, 0, v130
    v_max3_f32 v131, v131, v135, v139
    v_max_f32 v131, v131, v143
    v_sub_f32 v172, 0, v131
    v_sub_f32 v173, 0, v131
    v_sub_f32 v174, 0, v131
    v_sub_f32 v175, 0, v131
    s_mov_b32 s65, s66
    s_mov_b32 m0, s60
    s_nop 0
    s_nop 0
    buffer_load_dwordx4 v250, s[8:11], s65 offen offset:0 sc1 lds
    buffer_load_dwordx4 v250, s[8:11], s65 offen offset:1024 sc1 lds
    buffer_load_dwordx4 v250, s[8:11], s65 offen offset:2048 sc1 lds
    buffer_load_dwordx4 v250, s[8:11], s65 offen offset:3072 sc1 lds
    s_add_u32 m0, s60, 0x1000
    s_nop 0
    buffer_load_dwordx4 v251, s[8:11], s65 offen offset:0 sc1 lds
    buffer_load_dwordx4 v251, s[8:11], s65 offen offset:1024 sc1 lds
    buffer_load_dwordx4 v251, s[8:11], s65 offen offset:2048 sc1 lds
    buffer_load_dwordx4 v251, s[8:11], s65 offen offset:3072 sc1 lds
    s_mov_b32 m0, s61
    s_nop 0
    s_nop 0
    buffer_load_dwordx4 v252, s[8:11], s65 offen offset:0 sc1 lds
    buffer_load_dwordx4 v252, s[8:11], s65 offen offset:1024 sc1 lds
    buffer_load_dwordx4 v252, s[8:11], s65 offen offset:2048 sc1 lds
    buffer_load_dwordx4 v252, s[8:11], s65 offen offset:3072 sc1 lds
    s_add_u32 m0, s61, 0x1000
    s_nop 0
    s_nop 0
    buffer_load_dwordx4 v253, s[8:11], s65 offen offset:0 sc1 lds
    buffer_load_dwordx4 v253, s[8:11], s65 offen offset:1024 sc1 lds
    buffer_load_dwordx4 v253, s[8:11], s65 offen offset:2048 sc1 lds
    buffer_load_dwordx4 v253, s[8:11], s65 offen offset:3072 sc1 lds
    s_add_u32 s65, s65, 0x10000
    s_mov_b32 m0, s62
    s_nop 0
    buffer_load_dwordx4 v250, s[8:11], s65 offen offset:0 sc1 lds
    buffer_load_dwordx4 v250, s[8:11], s65 offen offset:1024 sc1 lds
    buffer_load_dwordx4 v250, s[8:11], s65 offen offset:2048 sc1 lds
    buffer_load_dwordx4 v250, s[8:11], s65 offen offset:3072 sc1 lds
    s_add_u32 m0, s62, 0x1000
    s_nop 0
    buffer_load_dwordx4 v251, s[8:11], s65 offen offset:0 sc1 lds
    buffer_load_dwordx4 v251, s[8:11], s65 offen offset:1024 sc1 lds
    buffer_load_dwordx4 v251, s[8:11], s65 offen offset:2048 sc1 lds
    buffer_load_dwordx4 v251, s[8:11], s65 offen offset:3072 sc1 lds
    s_waitcnt vmcnt(0)
    ds_read_b128 a[0:3], v244 offset:0
    ds_read_b128 a[4:7], v244 offset:1024
    s_branch L_maxdone
L_spare:
    s_cmp_eq_u32 s79, 1
    s_cbranch_scc0 L_nomb2
    s_barrier
L_nomb2:
    s_cmp_eq_u32 s79, 2
    s_cbranch_scc0 L_spare1
    v_and_b32 v71, 15, v64
    v_lshrrev_b32 v72, 4, v64
    v_lshrrev_b32 v70, 3, v71
    v_lshlrev_b32 v70, 1, v70
    v_xor_b32 v70, v70, v72
    v_lshlrev_b32 v70, 4, v70
    v_lshl_add_u32 v70, v71, 6, v70
    v_add_u32 v96, s74, v70
    v_add_u32 v68, s73, v70
    v_lshl_add_u32 v102, v72, 4, s73
    s_waitcnt vmcnt(0)
    s_nop 0
    ds_read_b128 a[128:131], v96 offset:0
    ds_read_b128 a[140:143], v102 offset:0
    ds_read_b128 a[132:135], v68 offset:16384
    ds_read_b128 a[136:139], v68 offset:24576
    ds_read_b128 a[144:147], v96 offset:1024
    ds_read_b128 a[156:159], v102 offset:64
    ds_read_b128 a[148:151], v68 offset:17408
    ds_read_b128 a[152:155], v68 offset:25600
    ds_read_b128 a[160:163], v96 offset:2048
    ds_read_b128 a[172:175], v102 offset:128
    ds_read_b128 a[164:167], v68 offset:18432
    ds_read_b128 a[168:171], v68 offset:26624
    s_waitcnt lgkmcnt(8)
    v_mfma_f32_16x16x32_bf16 v[80:83], a[132:135], a[128:131], 0
    v_mfma_f32_16x16x32_bf16 v[84:87], a[136:139], a[128:131], 0
    v_mfma_f32_16x16x32_bf16 v[104:107], a[132:135], a[140:143], 0
    v_mfma_f32_16x16x32_bf16 v[108:111], a[136:139], a[140:143], 0
    ds_read_b128 a[176:179], v96 offset:3072
    ds_read_b128 a[188:191], v102 offset:192
    ds_read_b128 a[180:183], v68 offset:19456
    ds_read_b128 a[184:187], v68 offset:27648
    s_waitcnt lgkmcnt(8)
    v_mfma_f32_16x16x32_bf16 v[80:83], a[148:151], a[144:147], v[80:83]
    v_mfma_f32_16x16x32_bf16 v[84:87], a[152:155], a[144:147], v[84:87]
    v_mfma_f32_16x16x32_bf16 v[104:107], a[148:151], a[156:159], v[104:107]
    v_mfma_f32_16x16x32_bf16 v[108:111], a[152:155], a[156:159], v[108:111]
    ds_read_b128 a[192:195], v96 offset:4096
    ds_read_b128 a[204:207], v102 offset:256
    ds_read_b128 a[196:199], v68 offset:20480
    ds_read_b128 a[200:203], v68 offset:28672
    s_waitcnt lgkmcnt(8)
    v_mfma_f32_16x16x32_bf16 v[80:83], a[164:167], a[160:163], v[80:83]
    v_mfma_f32_16x16x32_bf16 v[84:87], a[168:171], a[160:163], v[84:87]
    v_mfma_f32_16x16x32_bf16 v[104:107], a[164:167], a[172:175], v[104:107]
    v_mfma_f32_16x16x32_bf16 v[108:111], a[168:171], a[172:175], v[108:111]
    ds_read_b128 a[208:211], v96 offset:5120
    ds_read_b128 a[220:223], v102 offset:320
    ds_read_b128 a[212:215], v68 offset:21504
    ds_read_b128 a[216:219], v68 offset:29696
    s_waitcnt lgkmcnt(8)
    v_mfma_f32_16x16x32_bf16 v[80:83], a[180:183], a[176:179], v[80:83]
    v_mfma_f32_16x16x32_bf16 v[84:87], a[184:187], a[176:179], v[84:87]
    v_mfma_f32_16x16x32_bf16 v[104:107], a[180:183], a[188:191], v[104:107]
    v_mfma_f32_16x16x32_bf16 v[108:111], a[184:187], a[188:191], v[108:111]
    ds_read_b128 a[224:227], v96 offset:6144
    ds_read_b128 a[236:239], v102 offset:384
    ds_read_b128 a[228:231], v68 offset:22528
    ds_read_b128 a[232:235], v68 offset:30720
    s_waitcnt lgkmcnt(8)
    v_mfma_f32_16x16x32_bf16 v[80:83], a[196:199], a[192:195], v[80:83]
    v_mfma_f32_16x16x32_bf16 v[84:87], a[200:203], a[192:195], v[84:87]
    v_mfma_f32_16x16x32_bf16 v[104:107], a[196:199], a[204:207], v[104:107]
    v_mfma_f32_16x16x32_bf16 v[108:111], a[200:203], a[204:207], v[108:111]
    ds_read_b128 a[240:243], v96 offset:7168
    ds_read_b128 a[252:255], v102 offset:448
    ds_read_b128 a[244:247], v68 offset:23552
    ds_read_b128 a[248:251], v68 offset:31744
    s_waitcnt lgkmcnt(8)
    v_mfma_f32_16x16x32_bf16 v[80:83], a[212:215], a[208:211], v[80:83]
    v_mfma_f32_16x16x32_bf16 v[84:87], a[216:219], a[208:211], v[84:87]
    v_mfma_f32_16x16x32_bf16 v[104:107], a[212:215], a[220:223], v[104:107]
    v_mfma_f32_16x16x32_bf16 v[108:111], a[216:219], a[220:223], v[108:111]
    s_waitcnt lgkmcnt(4)
    v_mfma_f32_16x16x32_bf16 v[80:83], a[228:231], a[224:227], v[80:83]
    v_mfma_f32_16x16x32_bf16 v[84:87], a[232:235], a[224:227], v[84:87]
    v_mfma_f32_16x16x32_bf16 v[104:107], a[228:231], a[236:239], v[104:107]
    v_mfma_f32_16x16x32_bf16 v[108:111], a[232:235], a[236:239], v[108:111]
    s_waitcnt lgkmcnt(0)
    v_mfma_f32_16x16x32_bf16 v[80:83], a[244:247], a[240:243], v[80:83]
    v_mfma_f32_16x16x32_bf16 v[84:87], a[248:251], a[240:243], v[84:87]
    v_mfma_f32_16x16x32_bf16 v[104:107], a[244:247], a[252:255], v[104:107]
    v_mfma_f32_16x16x32_bf16 v[108:111], a[248:251], a[252:255], v[108:111]
    s_mov_b32 s69, 0x3db8aa3b
    s_lshl_b32 s68, s76, 10
    s_add_u32 s68, s68, 524288
    s_nop 4
    v_sub_f32 v80, v80, v104
    v_sub_f32 v81, v81, v105
    v_sub_f32 v82, v82, v106
    v_sub_f32 v83, v83, v107
    v_sub_f32 v84, v84, v108
    v_sub_f32 v85, v85, v109
    v_sub_f32 v86, v86, v110
    v_sub_f32 v87, v87, v111
    v_mul_f32 v80, s69, v80
    v_mul_f32 v81, s69, v81
    v_mul_f32 v82, s69, v82
    v_mul_f32 v83, s69, v83
    v_mul_f32 v84, s69, v84
    v_mul_f32 v85, s69, v85
    v_mul_f32 v86, s69, v86
    v_mul_f32 v87, s69, v87
    v_cvt_pk_bf16_f32 v92, v80, v81
    v_cvt_pk_bf16_f32 v93, v82, v83
    v_cvt_pk_bf16_f32 v94, v84, v85
    v_cvt_pk_bf16_f32 v95, v86, v87
    buffer_store_dwordx4 v[92:95], v250, s[8:11], s68 offen sc1
    s_waitcnt lgkmcnt(0)
    s_add_u32 s4, s100, 0x9e3779b9
    s_lshl_b32 s34, s76, 5
    s_add_u32 s34, s34, 131072
    s_waitcnt vmcnt(0)
    v_mov_b32 v68, s4
    s_mov_b64 exec, 1
    buffer_store_dword v68, v250, s[8:11], s34 offen sc1
    s_mov_b64 exec, -1
L_spare1:
    s_barrier
    v_and_b32 v65, 15, v64
    v_lshrrev_b32 v66, 4, v64
    s_lshl_b32 s78, s6, 1
    s_add_u32 s78, s78, s7
    s_lshl_b32 s33, s78, 2
    s_add_u32 s33, s33, s3
    s_mov_b64 s[20:21], s[52:53]
    s_mov_b32 s22, 262144
    s_mov_b32 s23, 0x20000
    v_lshrrev_b32 v67, 3, v64
    v_and_b32 v68, 7, v64
    v_lshlrev_b32 v68, 4, v68
    v_lshl_add_u32 v67, v67, 9, v68
    s_lshl_b32 s35, s78, 7
    s_lshl_b32 s68, s3, 16
    s_add_u32 s35, s35, s68
    s_lshl_b32 s68, s3, 14
    s_add_u32 m0, s68, 65536
    s_add_u32 s69, s35, 0
    buffer_load_dwordx4 v67, s[20:23], s69 offen lds
    s_add_u32 m0, s68, 66560
    s_add_u32 s69, s35, 4096
    buffer_load_dwordx4 v67, s[20:23], s69 offen lds
    s_add_u32 m0, s68, 67584
    s_add_u32 s69, s35, 8192
    buffer_load_dwordx4 v67, s[20:23], s69 offen lds
    s_add_u32 m0, s68, 68608
    s_add_u32 s69, s35, 12288
    buffer_load_dwordx4 v67, s[20:23], s69 offen lds
    s_add_u32 m0, s68, 69632
    s_add_u32 s69, s35, 16384
    buffer_load_dwordx4 v67, s[20:23], s69 offen lds
    s_add_u32 m0, s68, 70656
    s_add_u32 s69, s35, 20480
    buffer_load_dwordx4 v67, s[20:23], s69 offen lds
    s_add_u32 m0, s68, 71680
    s_add_u32 s69, s35, 24576
    buffer_load_dwordx4 v67, s[20:23], s69 offen lds
    s_add_u32 m0, s68, 72704
    s_add_u32 s69, s35, 28672
    buffer_load_dwordx4 v67, s[20:23], s69 offen lds
    s_add_u32 m0, s68, 73728
    s_add_u32 s69, s35, 32768
    buffer_load_dwordx4 v67, s[20:23], s69 offen lds
    s_add_u32 m0, s68, 74752
    s_add_u32 s69, s35, 36864
    buffer_load_dwordx4 v67, s[20:23], s69 offen lds
    s_add_u32 m0, s68, 75776
    s_add_u32 s69, s35, 40960
    buffer_load_dwordx4 v67, s[20:23], s69 offen lds
    s_add_u32 m0, s68, 76800
    s_add_u32 s69, s35, 45056
    buffer_load_dwordx4 v67, s[20:23], s69 offen lds
    s_add_u32 m0, s68, 77824
    s_add_u32 s69, s35, 49152
    buffer_load_dwordx4 v67, s[20:23], s69 offen lds
    s_add_u32 m0, s68, 78848
    s_add_u32 s69, s35, 53248
    buffer_load_dwordx4 v67, s[20:23], s69 offen lds
    s_add_u32 m0, s68, 79872
    s_add_u32 s69, s35, 57344
    buffer_load_dwordx4 v67, s[20:23], s69 offen lds
    s_add_u32 m0, s68, 80896
    s_add_u32 s69, s35, 61440
    buffer_load_dwordx4 v67, s[20:23], s69 offen lds
    s_mov_b64 s[28:29], s[48:49]
    s_mov_b32 s30, 7680
    s_mov_b32 s31, 0x20000
    v_lshlrev_b32 v68, 1, v64
    s_lshl_b32 s35, s78, 7
    s_add_u32 s68, s35, 4096
    v_mov_b32 v96, 0
    v_mov_b32_e64 v112, 0
    buffer_load_ushort v97, v68, s[28:31], s35 offen offset:0
    buffer_load_ushort v98, v68, s[28:31], s35 offen offset:512
    buffer_load_ushort v99, v68, s[28:31], s35 offen offset:1024
    buffer_load_ushort v100, v68, s[28:31], s35 offen offset:1536
    buffer_load_ushort v101, v68, s[28:31], s35 offen offset:2048
    buffer_load_ushort v102, v68, s[28:31], s35 offen offset:2560
    buffer_load_ushort v103, v68, s[28:31], s35 offen offset:3072
    buffer_load_ushort v104, v68, s[28:31], s35 offen offset:3584
    buffer_load_ushort v105, v68, s[28:31], s68 offen offset:0
    buffer_load_ushort v106, v68, s[28:31], s68 offen offset:512
    buffer_load_ushort v107, v68, s[28:31], s68 offen offset:1024
    buffer_load_ushort v108, v68, s[28:31], s68 offen offset:1536
    buffer_load_ushort v109, v68, s[28:31], s68 offen offset:2048
    buffer_load_ushort v110, v68, s[28:31], s68 offen offset:2560
    buffer_load_ushort v111, v68, s[28:31], s68 offen offset:3072
    v_bfe_u32 v67, v64, 2, 2
    v_lshl_add_u32 v67, v66, 3, v67
    v_lshlrev_b32 v67, 7, v67
    v_and_b32 v68, 3, v64
    v_lshl_add_u32 v67, v68, 3, v67
    s_lshl_b32 s35, s3, 5
    s_add_u32 s35, s35, 0x10000
    v_add_u32 v67, s35, v67
    v_lshrrev_b32 v69, 2, v64
    v_and_b32 v70, 3, v64
    v_lshrrev_b32 v71, 3, v69
    v_lshlrev_b32 v71, 1, v71
    v_xor_b32 v71, v71, v70
    v_lshlrev_b32 v71, 4, v71
    v_lshrrev_b32 v73, 2, v69
    v_lshlrev_b32 v73, 3, v73
    v_and_b32 v74, 3, v69
    v_add_u32 v73, v73, v74
    v_lshl_add_u32 v73, v73, 9, v71
    s_mov_b64 s[24:25], s[42:43]
    s_mov_b32 s26, 131072
    s_mov_b32 s27, 0x20000
    s_mov_b32 m0, s74
    s_mov_b32 s35, 130560
    buffer_load_dwordx4 v250, s[24:27], s35 offen lds
    s_mov_b64 s[24:25], s[50:51]
    s_mov_b32 s71, 2048
    s_lshl_b32 s35, s3, 14
    s_add_u32 s68, s35, s71
    s_add_u32 m0, s35, 0
    s_nop 0
    buffer_load_dwordx4 v73, s[24:27], s35 offen offset:0 lds
    s_add_u32 m0, s35, 960
    s_nop 0
    buffer_load_dwordx4 v73, s[24:27], s35 offen offset:64 lds
    s_add_u32 m0, s35, 1920
    s_nop 0
    buffer_load_dwordx4 v73, s[24:27], s35 offen offset:128 lds
    s_add_u32 m0, s35, 2880
    s_nop 0
    buffer_load_dwordx4 v73, s[24:27], s35 offen offset:192 lds
    s_add_u32 m0, s35, 3840
    s_nop 0
    buffer_load_dwordx4 v73, s[24:27], s35 offen offset:256 lds
    s_add_u32 m0, s35, 4800
    s_nop 0
    buffer_load_dwordx4 v73, s[24:27], s35 offen offset:320 lds
    s_add_u32 m0, s35, 5760
    s_nop 0
    buffer_load_dwordx4 v73, s[24:27], s35 offen offset:384 lds
    s_add_u32 m0, s35, 6720
    s_nop 0
    buffer_load_dwordx4 v73, s[24:27], s35 offen offset:448 lds
    s_add_u32 m0, s35, 8192
    s_nop 0
    buffer_load_dwordx4 v73, s[24:27], s68 offen offset:0 lds
    s_add_u32 m0, s35, 9152
    s_nop 0
    buffer_load_dwordx4 v73, s[24:27], s68 offen offset:64 lds
    s_add_u32 m0, s35, 10112
    s_nop 0
    buffer_load_dwordx4 v73, s[24:27], s68 offen offset:128 lds
    s_add_u32 m0, s35, 11072
    s_nop 0
    buffer_load_dwordx4 v73, s[24:27], s68 offen offset:192 lds
    s_add_u32 m0, s35, 12032
    s_nop 0
    buffer_load_dwordx4 v73, s[24:27], s68 offen offset:256 lds
    s_add_u32 m0, s35, 12992
    s_nop 0
    buffer_load_dwordx4 v73, s[24:27], s68 offen offset:320 lds
    s_add_u32 m0, s35, 13952
    s_nop 0
    buffer_load_dwordx4 v73, s[24:27], s68 offen offset:384 lds
    s_add_u32 m0, s35, 14912
    s_nop 0
    buffer_load_dwordx4 v73, s[24:27], s68 offen offset:448 lds
    s_waitcnt vmcnt(16)
    s_barrier
    ds_read_b64_tr_b16 v[160:161], v67 offset:0
    ds_read_b64_tr_b16 v[162:163], v67 offset:512
    ds_read_b64_tr_b16 v[164:165], v67 offset:4096
    ds_read_b64_tr_b16 v[166:167], v67 offset:4608
    ds_read_b64_tr_b16 v[168:169], v67 offset:8192
    ds_read_b64_tr_b16 v[170:171], v67 offset:8704
    ds_read_b64_tr_b16 v[172:173], v67 offset:12288
    ds_read_b64_tr_b16 v[174:175], v67 offset:12800
    ds_read_b64_tr_b16 v[176:177], v67 offset:16384
    ds_read_b64_tr_b16 v[178:179], v67 offset:16896
    ds_read_b64_tr_b16 v[180:181], v67 offset:20480
    ds_read_b64_tr_b16 v[182:183], v67 offset:20992
    ds_read_b64_tr_b16 v[184:185], v67 offset:24576
    ds_read_b64_tr_b16 v[186:187], v67 offset:25088
    ds_read_b64_tr_b16 v[188:189], v67 offset:28672
    ds_read_b64_tr_b16 v[190:191], v67 offset:29184
    ds_read_b64_tr_b16 v[128:129], v67 offset:32768
    ds_read_b64_tr_b16 v[130:131], v67 offset:33280
    ds_read_b64_tr_b16 v[132:133], v67 offset:36864
    ds_read_b64_tr_b16 v[134:135], v67 offset:37376
    ds_read_b64_tr_b16 v[136:137], v67 offset:40960
    ds_read_b64_tr_b16 v[138:139], v67 offset:41472
    ds_read_b64_tr_b16 v[140:141], v67 offset:45056
    ds_read_b64_tr_b16 v[142:143], v67 offset:45568
    ds_read_b64_tr_b16 v[144:145], v67 offset:49152
    ds_read_b64_tr_b16 v[146:147], v67 offset:49664
    ds_read_b64_tr_b16 v[148:149], v67 offset:53248
    ds_read_b64_tr_b16 v[150:151], v67 offset:53760
    ds_read_b64_tr_b16 v[152:153], v67 offset:57344
    ds_read_b64_tr_b16 v[154:155], v67 offset:57856
    ds_read_b64_tr_b16 v[156:157], v67 offset:61440
    ds_read_b64_tr_b16 v[158:159], v67 offset:61952
    v_lshl_or_b32 v0, v97, 16, v96
    v_lshl_or_b32 v8, v98, 16, v97
    v_lshl_or_b32 v1, v99, 16, v98
    v_lshl_or_b32 v9, v100, 16, v99
    v_lshl_or_b32 v2, v101, 16, v100
    v_lshl_or_b32 v10, v102, 16, v101
    v_lshl_or_b32 v3, v103, 16, v102
    v_lshl_or_b32 v11, v104, 16, v103
    v_lshl_or_b32 v4, v105, 16, v104
    v_lshl_or_b32 v12, v106, 16, v105
    v_lshl_or_b32 v5, v107, 16, v106
    v_lshl_or_b32 v13, v108, 16, v107
    v_lshl_or_b32 v6, v109, 16, v108
    v_lshl_or_b32 v14, v110, 16, v109
    v_lshl_or_b32 v7, v111, 16, v110
    v_lshl_or_b32 v15, v112, 16, v111
    s_lshl_b32 s35, s78, 12
    s_add_u32 s35, s35, 917504
    s_cmp_eq_u32 s3, 0
    s_cselect_b32 s68, s35, 0x7fff0000
    buffer_store_dwordx4 v[0:3], v250, s[8:11], s68 offen offset:0 sc1
    s_cmp_eq_u32 s3, 1
    s_cselect_b32 s68, s35, 0x7fff0000
    buffer_store_dwordx4 v[4:7], v250, s[8:11], s68 offen offset:1024 sc1
    s_cmp_eq_u32 s3, 2
    s_cselect_b32 s68, s35, 0x7fff0000
    buffer_store_dwordx4 v[8:11], v250, s[8:11], s68 offen offset:2048 sc1
    s_cmp_eq_u32 s3, 3
    s_cselect_b32 s68, s35, 0x7fff0000
    buffer_store_dwordx4 v[12:15], v250, s[8:11], s68 offen offset:3072 sc1
    v_lshrrev_b32 v72, 3, v65
    v_lshlrev_b32 v72, 1, v72
    v_xor_b32 v72, v72, v66
    v_lshlrev_b32 v72, 4, v72
    v_lshl_add_u32 v72, v65, 6, v72
    v_lshlrev_b32 v75, 13, v70
    v_lshl_add_u32 v75, v66, 8, v75
    v_lshrrev_b32 v68, 2, v65
    v_lshl_add_u32 v75, v68, 4, v75
    s_lshl_b32 s35, s3, 6
    v_add_u32 v75, s35, v75
    s_waitcnt lgkmcnt(0)
    s_add_u32 s4, s100, 0x9e3779b9
    v_mov_b64 v[88:89], 0
    v_mov_b64 v[90:91], 0
    s_mov_b32 s72, 0
L_fh:
    s_barrier
    s_cmp_eq_u32 s72, 5
    s_cbranch_scc1 L_fh_last
    s_cmp_eq_u32 s72, 1
    s_cbranch_scc0 L_fh_a
    s_mov_b64 s[24:25], s[44:45]
L_fh_a:
    s_cmp_eq_u32 s72, 3
    s_cbranch_scc0 L_fh_b
    s_mov_b64 s[24:25], s[42:43]
    s_mov_b32 s71, 4096
    v_lshrrev_b32 v73, 3, v69
    v_lshlrev_b32 v73, 4, v73
    v_and_b32 v74, 7, v69
    v_add_u32 v73, v73, v74
    v_lshl_add_u32 v73, v73, 9, v71
L_fh_b:
    s_andn2_b32 s35, 1, s72
    s_lshl_b32 s35, s35, 2
    s_add_u32 s35, s35, s3
    s_lshl_b32 s35, s35, 14
    s_add_u32 s68, s35, s71
    s_add_u32 m0, s35, 0
    s_nop 0
    buffer_load_dwordx4 v73, s[24:27], s35 offen offset:0 lds
    s_add_u32 m0, s35, 960
    s_nop 0
    buffer_load_dwordx4 v73, s[24:27], s35 offen offset:64 lds
    s_add_u32 m0, s35, 1920
    s_nop 0
    buffer_load_dwordx4 v73, s[24:27], s35 offen offset:128 lds
    s_add_u32 m0, s35, 2880
    s_nop 0
    buffer_load_dwordx4 v73, s[24:27], s35 offen offset:192 lds
    s_add_u32 m0, s35, 3840
    s_nop 0
    buffer_load_dwordx4 v73, s[24:27], s35 offen offset:256 lds
    s_add_u32 m0, s35, 4800
    s_nop 0
    buffer_load_dwordx4 v73, s[24:27], s35 offen offset:320 lds
    s_add_u32 m0, s35, 5760
    s_nop 0
    buffer_load_dwordx4 v73, s[24:27], s35 offen offset:384 lds
    s_add_u32 m0, s35, 6720
    s_nop 0
    buffer_load_dwordx4 v73, s[24:27], s35 offen offset:448 lds
    s_add_u32 m0, s35, 8192
    s_nop 0
    buffer_load_dwordx4 v73, s[24:27], s68 offen offset:0 lds
    s_add_u32 m0, s35, 9152
    s_nop 0
    buffer_load_dwordx4 v73, s[24:27], s68 offen offset:64 lds
    s_add_u32 m0, s35, 10112
    s_nop 0
    buffer_load_dwordx4 v73, s[24:27], s68 offen offset:128 lds
    s_add_u32 m0, s35, 11072
    s_nop 0
    buffer_load_dwordx4 v73, s[24:27], s68 offen offset:192 lds
    s_add_u32 m0, s35, 12032
    s_nop 0
    buffer_load_dwordx4 v73, s[24:27], s68 offen offset:256 lds
    s_add_u32 m0, s35, 12992
    s_nop 0
    buffer_load_dwordx4 v73, s[24:27], s68 offen offset:320 lds
    s_add_u32 m0, s35, 13952
    s_nop 0
    buffer_load_dwordx4 v73, s[24:27], s68 offen offset:384 lds
    s_add_u32 m0, s35, 14912
    s_nop 0
    buffer_load_dwordx4 v73, s[24:27], s68 offen offset:448 lds
    s_waitcnt vmcnt(16)
    s_branch L_fh_go
L_fh_last:
    s_waitcnt vmcnt(0)
L_fh_go:
    s_barrier
    s_and_b32 s35, s72, 1
    s_lshl_b32 s35, s35, 16
    v_add_u32 v74, s35, v72
    s_mov_b32 s34, 0
    ds_read_b128 v[0:3], v74 offset:0
    ds_read_b128 v[4:7], v74 offset:8192
    ds_read_b128 v[8:11], v74 offset:1024
    ds_read_b128 v[12:15], v74 offset:9216
    ds_read_b128 v[16:19], v74 offset:2048
    ds_read_b128 v[20:23], v74 offset:10240
    ds_read_b128 v[24:27], v74 offset:3072
    ds_read_b128 v[28:31], v74 offset:11264
    ds_read_b128 v[32:35], v74 offset:4096
    ds_read_b128 v[36:39], v74 offset:12288
    ds_read_b128 v[40:43], v74 offset:5120
    ds_read_b128 v[44:47], v74 offset:13312
    ds_read_b128 v[48:51], v74 offset:6144
    ds_read_b128 v[52:55], v74 offset:14336
    ds_read_b128 v[56:59], v74 offset:7168
    ds_read_b128 v[60:63], v74 offset:15360
L_fold:
    v_add_u32 v74, 0x4000, v74
    s_waitcnt lgkmcnt(14)
    v_mfma_f32_16x16x32_bf16 v[80:83], v[0:3], v[128:131], v[88:91]
    v_mfma_f32_16x16x32_bf16 v[84:87], v[4:7], v[128:131], v[88:91]
    ds_read_b128 v[0:3], v74 offset:0
    ds_read_b128 v[4:7], v74 offset:8192
    s_waitcnt lgkmcnt(14)
    v_mfma_f32_16x16x32_bf16 v[80:83], v[8:11], v[132:135], v[80:83]
    v_mfma_f32_16x16x32_bf16 v[84:87], v[12:15], v[132:135], v[84:87]
    ds_read_b128 v[8:11], v74 offset:1024
    ds_read_b128 v[12:15], v74 offset:9216
    s_waitcnt lgkmcnt(14)
    v_mfma_f32_16x16x32_bf16 v[80:83], v[16:19], v[136:139], v[80:83]
    v_mfma_f32_16x16x32_bf16 v[84:87], v[20:23], v[136:139], v[84:87]
    ds_read_b128 v[16:19], v74 offset:2048
    ds_read_b128 v[20:23], v74 offset:10240
    s_waitcnt lgkmcnt(14)
    v_mfma_f32_16x16x32_bf16 v[80:83], v[24:27], v[140:143], v[80:83]
    v_mfma_f32_16x16x32_bf16 v[84:87], v[28:31], v[140:143], v[84:87]
    ds_read_b128 v[24:27], v74 offset:3072
    ds_read_b128 v[28:31], v74 offset:11264
    s_waitcnt lgkmcnt(14)
    v_mfma_f32_16x16x32_bf16 v[80:83], v[32:35], v[144:147], v[80:83]
    v_mfma_f32_16x16x32_bf16 v[84:87], v[36:39], v[144:147], v[84:87]
    ds_read_b128 v[32:35], v74 offset:4096
    ds_read_b128 v[36:39], v74 offset:12288
    s_waitcnt lgkmcnt(14)
    v_mfma_f32_16x16x32_bf16 v[80:83], v[40:43], v[148:151], v[80:83]
    v_mfma_f32_16x16x32_bf16 v[84:87], v[44:47], v[148:151], v[84:87]
    ds_read_b128 v[40:43], v74 offset:5120
    ds_read_b128 v[44:47], v74 offset:13312
    s_waitcnt lgkmcnt(14)
    v_mfma_f32_16x16x32_bf16 v[80:83], v[48:51], v[152:155], v[80:83]
    v_mfma_f32_16x16x32_bf16 v[84:87], v[52:55], v[152:155], v[84:87]
    ds_read_b128 v[48:51], v74 offset:6144
    ds_read_b128 v[52:55], v74 offset:14336
    s_waitcnt lgkmcnt(14)
    v_mfma_f32_16x16x32_bf16 v[80:83], v[56:59], v[156:159], v[80:83]
    v_mfma_f32_16x16x32_bf16 v[84:87], v[60:63], v[156:159], v[84:87]
    ds_read_b128 v[56:59], v74 offset:7168
    ds_read_b128 v[60:63], v74 offset:15360
    v_mov_b64 v[192:193], v[196:197]
    v_mov_b64 v[194:195], v[198:199]
    v_mov_b64 v[196:197], v[200:201]
    v_mov_b64 v[198:199], v[202:203]
    v_mov_b64 v[200:201], v[204:205]
    v_mov_b64 v[202:203], v[206:207]
    v_mov_b64 v[204:205], v[208:209]
    v_mov_b64 v[206:207], v[210:211]
    v_mov_b64 v[208:209], v[212:213]
    v_mov_b64 v[210:211], v[214:215]
    v_mov_b64 v[212:213], v[216:217]
    v_mov_b64 v[214:215], v[218:219]
    v_mov_b64 v[216:217], v[220:221]
    v_mov_b64 v[218:219], v[222:223]
    s_add_u32 s34, s34, 1
    s_cmp_lt_u32 s34, 4
    v_cvt_pk_bf16_f32 v220, v80, v81
    v_cvt_pk_bf16_f32 v221, v82, v83
    v_cvt_pk_bf16_f32 v222, v84, v85
    v_cvt_pk_bf16_f32 v223, v86, v87
    s_cbranch_scc1 L_fold
    s_waitcnt lgkmcnt(0)
    s_add_u32 s72, s72, 1
    s_cmp_eq_u32 s72, 2
    s_cbranch_scc0 L_fh_c
    s_lshl_b32 s35, s78, 15
    s_add_u32 s35, s35, 786432
    s_add_u32 s68, s35, 4096
    buffer_store_dwordx4 v[192:195], v75, s[8:11], s35 offen offset:0 sc1
    buffer_store_dwordx4 v[196:199], v75, s[8:11], s35 offen offset:1024 sc1
    buffer_store_dwordx4 v[200:203], v75, s[8:11], s35 offen offset:2048 sc1
    buffer_store_dwordx4 v[204:207], v75, s[8:11], s35 offen offset:3072 sc1
    buffer_store_dwordx4 v[208:211], v75, s[8:11], s68 offen offset:0 sc1
    buffer_store_dwordx4 v[212:215], v75, s[8:11], s68 offen offset:1024 sc1
    buffer_store_dwordx4 v[216:219], v75, s[8:11], s68 offen offset:2048 sc1
    buffer_store_dwordx4 v[220:223], v75, s[8:11], s68 offen offset:3072 sc1
    v_mov_b64 v[128:129], v[160:161]
    v_mov_b64 v[130:131], v[162:163]
    v_mov_b64 v[132:133], v[164:165]
    v_mov_b64 v[134:135], v[166:167]
    v_mov_b64 v[136:137], v[168:169]
    v_mov_b64 v[138:139], v[170:171]
    v_mov_b64 v[140:141], v[172:173]
    v_mov_b64 v[142:143], v[174:175]
    v_mov_b64 v[144:145], v[176:177]
    v_mov_b64 v[146:147], v[178:179]
    v_mov_b64 v[148:149], v[180:181]
    v_mov_b64 v[150:151], v[182:183]
    v_mov_b64 v[152:153], v[184:185]
    v_mov_b64 v[154:155], v[186:187]
    v_mov_b64 v[156:157], v[188:189]
    v_mov_b64 v[158:159], v[190:191]
L_fh_c:
    s_cmp_eq_u32 s72, 4
    s_cbranch_scc0 L_fh_d
    v_lshl_add_u32 v74, v66, 4, s74
    v_mov_b64 v[128:129], v[192:193]
    v_mov_b64 v[130:131], v[194:195]
    v_mov_b64 v[132:133], v[196:197]
    v_mov_b64 v[134:135], v[198:199]
    v_mov_b64 v[136:137], v[200:201]
    v_mov_b64 v[138:139], v[202:203]
    v_mov_b64 v[140:141], v[204:205]
    v_mov_b64 v[142:143], v[206:207]
    v_mov_b64 v[144:145], v[208:209]
    v_mov_b64 v[146:147], v[210:211]
    v_mov_b64 v[148:149], v[212:213]
    v_mov_b64 v[150:151], v[214:215]
    v_mov_b64 v[152:153], v[216:217]
    v_mov_b64 v[154:155], v[218:219]
    v_mov_b64 v[156:157], v[220:221]
    v_mov_b64 v[158:159], v[222:223]
    ds_read_b128 v[0:3], v74 offset:0
    ds_read_b128 v[4:7], v74 offset:64
    ds_read_b128 v[8:11], v74 offset:128
    ds_read_b128 v[12:15], v74 offset:192
    ds_read_b128 v[16:19], v74 offset:256
    ds_read_b128 v[20:23], v74 offset:320
    ds_read_b128 v[24:27], v74 offset:384
    ds_read_b128 v[28:31], v74 offset:448
    s_waitcnt lgkmcnt(0)
    v_mfma_f32_16x16x32_bf16 v[88:91], v[0:3], v[128:131], v[88:91]
    v_mfma_f32_16x16x32_bf16 v[88:91], v[4:7], v[132:135], v[88:91]
    v_mfma_f32_16x16x32_bf16 v[88:91], v[8:11], v[136:139], v[88:91]
    v_mfma_f32_16x16x32_bf16 v[88:91], v[12:15], v[140:143], v[88:91]
    v_mfma_f32_16x16x32_bf16 v[88:91], v[16:19], v[144:147], v[88:91]
    v_mfma_f32_16x16x32_bf16 v[88:91], v[20:23], v[148:151], v[88:91]
    v_mfma_f32_16x16x32_bf16 v[88:91], v[24:27], v[152:155], v[88:91]
    v_mfma_f32_16x16x32_bf16 v[88:91], v[28:31], v[156:159], v[88:91]
    s_nop 7
    v_sub_f32 v88, 0, v88
    v_sub_f32 v89, 0, v89
    v_sub_f32 v90, 0, v90
    v_sub_f32 v91, 0, v91
L_fh_d:
    s_cmp_lt_u32 s72, 6
    s_cbranch_scc1 L_fh
    v_cmp_eq_u32 vcc, 3, v66
    v_and_b32 v74, 0xffff, v223
    s_nop 0
    v_cndmask_b32 v223, v223, v74, vcc
    s_lshl_b32 s35, s78, 15
    s_add_u32 s35, s35, 655360
    s_add_u32 s68, s35, 4096
    buffer_store_dwordx4 v[192:195], v75, s[8:11], s35 offen offset:0 sc1
    buffer_store_dwordx4 v[196:199], v75, s[8:11], s35 offen offset:1024 sc1
    buffer_store_dwordx4 v[200:203], v75, s[8:11], s35 offen offset:2048 sc1
    buffer_store_dwordx4 v[204:207], v75, s[8:11], s35 offen offset:3072 sc1
    buffer_store_dwordx4 v[208:211], v75, s[8:11], s68 offen offset:0 sc1
    buffer_store_dwordx4 v[212:215], v75, s[8:11], s68 offen offset:1024 sc1
    buffer_store_dwordx4 v[216:219], v75, s[8:11], s68 offen offset:2048 sc1
    buffer_store_dwordx4 v[220:223], v75, s[8:11], s68 offen offset:3072 sc1
    s_waitcnt vmcnt(0)
    s_mul_i32 s35, s33, 16
    s_add_u32 s35, s35, 262144
    v_mov_b32 v76, s4
    s_mov_b64 exec, 1
    buffer_store_dword v76, v250, s[8:11], s35 offen sc1
    s_mov_b64 exec, -1
    s_cmp_eq_u32 s33, 0
    s_cbranch_scc0 L_spare_end
    v_mul_u32_u24 v76, 16, v65
    v_add_u32 v76, 262144, v76
    s_mov_b32 s76, 0
L_poll5:
    buffer_load_dword v77, v76, s[8:11], 0 offen sc1
    s_add_u32 s76, s76, 1
    s_waitcnt vmcnt(0)
    s_cmp_ge_u32 s76, 20000
    s_cbranch_scc1 L_poll5_x
    v_cmp_eq_u32 vcc, s4, v77
    s_nop 1
    s_cmp_eq_u32 vcc_lo, -1
    s_cbranch_scc0 L_poll5
L_poll5_x:
    s_mov_b32 s34, 0
L_allh:
    v_lshl_add_u32 v78, s34, 6, v64
    v_and_b32 v79, 511, v78
    v_subrev_u32 v76, 8, v78
    v_cmp_lt_u32 vcc, 503, v79
    s_nop 1
    v_cndmask_b32 v78, v78, v76, vcc
    v_mul_u32_u24 v76, 16, v78
    v_add_u32 v76, 196608, v76
    s_mov_b32 s76, 0
L_poll6:
    buffer_load_dword v77, v76, s[8:11], 0 offen sc1
    s_add_u32 s76, s76, 1
    s_waitcnt vmcnt(0)
    s_cmp_ge_u32 s76, 20000
    s_cbranch_scc1 L_poll6_x
    v_cmp_eq_u32 vcc, s4, v77
    s_nop 1
    s_cmp_eq_u64 vcc, -1
    s_cbranch_scc0 L_poll6
L_poll6_x:
    s_add_u32 s34, s34, 1
    s_cmp_lt_u32 s34, 16
    s_cbranch_scc1 L_allh
    s_mov_b32 s35, 0
    v_mov_b32 v76, s4
    s_mov_b64 exec, 1
    buffer_store_dword v76, v250, s[8:11], s35 offen sc1
    s_mov_b64 exec, -1
L_spare_end:
L_end:
    s_endpgm
    .fill 1280, 4, 0xbf810000
.section .rodata,"a"
.p2align 6
.amdhsa_kernel standalone__conformer_family_branchformer__speech_kernel
  .amdhsa_next_free_vgpr 512
  .amdhsa_next_free_sgpr 102
  .amdhsa_accum_offset 256
  .amdhsa_group_segment_fixed_size 0
  .amdhsa_kernarg_size 96
  .amdhsa_user_sgpr_count 2
  .amdhsa_user_sgpr_kernarg_segment_ptr 1
  .amdhsa_system_sgpr_workgroup_id_x 1
.end_amdhsa_kernel
```
